```python
import torch

def _softmax(x, axis=-1):
    return torch.softmax(x, dim=axis)

def _gelu(x):
    return torch.nn.functional.gelu(x, approximate='tanh')

def _silu(x):
    return torch.nn.functional.silu(x)

def _sigmoid(x):
    return torch.sigmoid(x)

def _layernorm(x, axis=-1, eps=1e-05):
    m = x.mean(dim=axis, keepdim=True)
    v = x.var(dim=axis, keepdim=True, unbiased=False)
    return (x - m) / torch.sqrt(v + eps)

def _scatter_add(tgt, idx, src, axis=0):
    return tgt.clone().index_add_(axis, idx, src)

def _segment_sum(src, seg, n):
    out = torch.zeros((n,) + src.shape[1:], dtype=src.dtype)
    return out.index_add_(0, seg, src)

def _pad(x, pw):
    flat = tuple((v for pair in reversed(pw) for v in pair))
    return torch.nn.functional.pad(x, flat)
kernel_name = 'recurrent_scan__memory_aug_recurrent_mem_tr__dense_activation_mish__prompt'

def setup_inputs():

    _w = lambda a: (lambda t: t.to(torch.bfloat16) if t.is_floating_point() else t)(torch.as_tensor(a))

    def _A_setup():
        B, S, Dm = (1, 2048, 512)
        H, Dh = (32, 128)
        M, seg = (8, 32)
        seg = min(seg, S)
        S = S // seg * seg
        return {'x': _w((lambda *s: torch.randn(*s, dtype=torch.bfloat16) * 0.05)(B, S, Dm)), 'mem0': _w((lambda *s: torch.randn(*s, dtype=torch.bfloat16) * 0.8)(B, M, Dm)), 'Wq': _w((lambda *s: torch.randn(*s, dtype=torch.bfloat16) * 1.6)(Dm, H, Dh) * Dm ** (-0.5)), 'Wk': _w((lambda *s: torch.randn(*s, dtype=torch.bfloat16) * 1.6)(Dm, H, Dh) * Dm ** (-0.5)), 'Wv': _w((lambda *s: torch.randn(*s, dtype=torch.bfloat16) * 0.8)(Dm, H, Dh) * Dm ** (-0.5)), 'Wo': _w((lambda *s: torch.randn(*s, dtype=torch.bfloat16) * 0.8)(H, Dh, Dm) * (H * Dh) ** (-0.5)), 'seg_len': seg}
    _A_in = _A_setup()

    def _B_setup():
        B, S, D, F = (1, 2048, 512, 1792)
        return {'x': _w((lambda *s: torch.randn(*s, dtype=torch.bfloat16) * 0.05)(B, S, D)), 'w1': _w((lambda *s: torch.randn(*s, dtype=torch.bfloat16) * 0.8)(D, F) * D ** (-0.5)), 'b1': _w((lambda *s: torch.randn(*s, dtype=torch.bfloat16) * 0.2)(F)), 'w2': _w((lambda *s: torch.randn(*s, dtype=torch.bfloat16) * 0.2)(F, D) * F ** (-0.5))}
    _B_in = _B_setup()
    return {'A_x': _A_in['x'], 'A_mem0': _A_in['mem0'], 'A_Wq': _A_in['Wq'], 'A_Wk': _A_in['Wk'], 'A_Wv': _A_in['Wv'], 'A_Wo': _A_in['Wo'], 'A_seg_len': _A_in['seg_len'], 'B_x': _B_in['x'], 'B_w1': _B_in['w1'], 'B_b1': _B_in['b1'], 'B_w2': _B_in['w2']}

def reference(A_x, A_mem0, A_Wq, A_Wk, A_Wv, A_Wo, A_seg_len, B_x, B_w1, B_b1, B_w2):

    def _A_ref(x, mem0, Wq, Wk, Wv, Wo, seg_len):
        B, S, Dm = x.shape
        H, Dh = (Wq.shape[1], Wq.shape[2])
        M = mem0.shape[1]
        scale = Dh ** (-0.5)
        n_seg = S // seg_len
        L = M + seg_len
        idx = torch.arange(L)
        mask = (idx[:, None] < M) | (idx[:, None] >= idx[None, :])
        mem = mem0
        outs = []
        for s in range(n_seg):
            xs = x[:, s * seg_len:(s + 1) * seg_len, :].clone()
            h = torch.concatenate([mem, xs], axis=1)
            q = torch.einsum('btd,dhe->bhte', h, Wq)
            k = torch.einsum('btd,dhe->bhte', h, Wk)
            v = torch.einsum('btd,dhe->bhte', h, Wv)
            scores = torch.einsum('bhqe,bhke->bhqk', q, k) * scale
            scores = torch.where(mask[None, None], scores, -1000000000.0)
            p = _softmax(scores, axis=-1)
            o = torch.einsum('bhqk,bhke->bhqe', p, v)
            o = torch.einsum('bhte,hed->btd', o, Wo)
            mem = o[:, :M, :].clone()
            outs.append(o[:, M:, :])
        return torch.concatenate(outs, axis=1)

    def _B_ref(x, w1, b1, w2):
        h = torch.einsum('bsd,df->bsf', x, w1) + b1
        sp = torch.log1p(torch.exp(-torch.abs(h))) + torch.where(h > 0, h, torch.zeros_like(h))
        act = h * torch.tanh(sp)
        return torch.einsum('bsf,fd->bsd', act, w2)
    x = A_x
    xn = _layernorm(x, axis=-1)
    s = _A_ref(xn, A_mem0, A_Wq, A_Wk, A_Wv, A_Wo, A_seg_len)
    g = _silu(_B_ref(xn, B_w1, B_b1, B_w2))
    return x + s * g
```

```asm
; @launch grid=(256,1,1) block=(256,1,1) lds=163840
.amdgcn_target "amdgcn-amd-amdhsa--gfx950"
.text
.globl recurrent_scan__memory_aug_recurrent_mem_tr__dense_activation_mish__prompt_kernel
.p2align 8
.type recurrent_scan__memory_aug_recurrent_mem_tr__dense_activation_mish__prompt_kernel,@function
recurrent_scan__memory_aug_recurrent_mem_tr__dense_activation_mish__prompt_kernel:
  s_cmp_ge_u32 s2, 0x100
  s_cbranch_scc1 L_end
  s_load_dwordx16 s[24:39], s[0:1], 0
  s_load_dwordx8 s[40:47], s[0:1], 64
  s_load_dwordx4 s[48:51], s[0:1], 96
  s_getreg_b32 s53, hwreg(HW_REG_XCC_ID)
  v_lshrrev_b32 v1, 6, v0
  v_and_b32 v0, 63, v0
  v_readfirstlane_b32 s54, v1
  s_and_b32 s53, s53, 15
  s_mov_b32 s70, 0x400000
  s_mov_b32 s55, 0
  s_waitcnt lgkmcnt(0)
  s_mov_b32 s4, s50
  s_and_b32 s5, s51, 0xffff
  s_mov_b32 s6, 0x10000000
  s_mov_b32 s7, 0x20000
  s_mov_b32 s16, s48
  s_and_b32 s17, s49, 0xffff
  s_mov_b32 s18, 0x100
  s_mov_b32 s19, 0x20000
  s_cmp_eq_u32 s54, 0
  s_cbranch_scc0 L_rank_bcast
  s_and_b32 s3, s53, 7
  s_lshl_b32 s20, s3, 4
  s_add_u32 s20, s20, 112
  s_cmp_eq_u32 s3, 0
  s_cselect_b32 s20, 0, s20
  v_mov_b32 v2, s20
  s_cmp_ge_u32 s53, 8
  s_cselect_b32 s3, 0x41, 1
  v_mov_b32 v3, s3
  s_mov_b64 exec, 1
  buffer_atomic_add v3, v2, s[16:19], 0 offen sc0
  s_mov_b64 exec, 0xff
  s_lshl_b32 s3, s2, 7
  s_add_u32 s3, s3, 0x42d0000
  v_lshlrev_b32 v8, 4, v0
  v_mov_b32 v4, 0
  v_mov_b32 v5, 0
  v_mov_b32 v6, 0
  v_mov_b32 v7, 0
  buffer_store_dwordx4 v[4:7], v8, s[4:7], s3 offen sc1
  s_waitcnt vmcnt(1)
  v_readfirstlane_b32 s52, v3
  s_nop 3
  s_min_u32 s52, s52, 63
  s_lshl_b32 s3, s53, 8
  s_or_b32 s3, s3, s52
  s_mov_b64 exec, -1
  s_cmp_eq_u32 s53, 6
  s_cbranch_scc0 L_nosent
  s_cmp_lt_u32 s52, 32
  s_cbranch_scc0 L_nosent
  v_lshlrev_b32 v8, 4, v0
  v_mov_b32 v4, -1
  v_mov_b32 v5, -1
  v_mov_b32 v6, -1
  v_mov_b32 v7, -1
  s_lshl_b32 s21, s52, 12
  s_add_u32 s22, s21, 0x39e0000
  buffer_store_dwordx4 v[4:7], v8, s[4:7], s22 offen offset:0 sc1
  buffer_store_dwordx4 v[4:7], v8, s[4:7], s22 offen offset:1024 sc1
  buffer_store_dwordx4 v[4:7], v8, s[4:7], s22 offen offset:2048 sc1
  buffer_store_dwordx4 v[4:7], v8, s[4:7], s22 offen offset:3072 sc1
  s_add_u32 s22, s21, 0x41e0000
  buffer_store_dwordx4 v[4:7], v8, s[4:7], s22 offen offset:0 sc1
  buffer_store_dwordx4 v[4:7], v8, s[4:7], s22 offen offset:1024 sc1
  buffer_store_dwordx4 v[4:7], v8, s[4:7], s22 offen offset:2048 sc1
  buffer_store_dwordx4 v[4:7], v8, s[4:7], s22 offen offset:3072 sc1
L_nosent:
  v_mov_b32 v2, 0x27ff0
  v_mov_b32 v3, s3
  ds_write_b32 v2, v3
  s_waitcnt lgkmcnt(0)
L_rank_bcast:
  s_barrier
  v_mov_b32 v2, 0x27ff0
  ds_read_b32 v3, v2
  s_waitcnt lgkmcnt(0)
  v_readfirstlane_b32 s3, v3
  s_nop 3
  s_and_b32 s52, s3, 63
  s_lshr_b32 s53, s3, 8
  s_cmp_eq_u32 s54, 0
  s_cbranch_scc0 L_clr_done
  s_waitcnt vmcnt(0)
  s_mov_b64 exec, 1
  s_add_u32 s20, s20, 4
  v_mov_b32 v2, s20
  v_mov_b32 v3, 1
  buffer_atomic_add v3, v2, s[16:19], 0 offen
  s_mov_b64 exec, -1
L_clr_done:
  s_barrier
  s_cmp_ge_u32 s52, 32
  s_cbranch_scc1 L_overflow
  s_cmp_ge_u32 s53, 8
  s_cbranch_scc1 L_overflow
L_dispatch:
  s_cmp_eq_u32 s53, 0
  s_cbranch_scc1 L_role_chain
  s_cmp_le_u32 s53, 2
  s_cbranch_scc1 L_proj
  v_lshlrev_b32 v1, 4, v0
  s_sub_u32 s63, s53, 3
  s_lshl_b32 s63, s63, 5
  s_add_u32 s63, s63, s52
  s_cmp_lt_u32 s63, 128
  s_cbranch_scc0 L_noln
  s_cmp_eq_u32 s54, 0
  s_cbranch_scc0 L_noln
  s_mov_b32 s8, s24
  s_and_b32 s9, s25, 0xffff
  s_mov_b32 s10, 0x200000
  s_mov_b32 s11, 0x20000
  v_and_b32 v80, 15, v0
  v_lshlrev_b32 v80, 10, v80
  v_lshrrev_b32 v127, 4, v0
  v_and_b32 v127, 3, v127
  v_lshlrev_b32 v127, 4, v127
  v_add_u32 v80, v80, v127
  s_lshl_b32 s73, s63, 14
  buffer_load_dwordx4 v[16:19], v80, s[8:11], s73 offen offset:0
  buffer_load_dwordx4 v[20:23], v80, s[8:11], s73 offen offset:64
  buffer_load_dwordx4 v[24:27], v80, s[8:11], s73 offen offset:128
  buffer_load_dwordx4 v[28:31], v80, s[8:11], s73 offen offset:192
  buffer_load_dwordx4 v[32:35], v80, s[8:11], s73 offen offset:256
  buffer_load_dwordx4 v[36:39], v80, s[8:11], s73 offen offset:320
  buffer_load_dwordx4 v[40:43], v80, s[8:11], s73 offen offset:384
  buffer_load_dwordx4 v[44:47], v80, s[8:11], s73 offen offset:448
  buffer_load_dwordx4 v[48:51], v80, s[8:11], s73 offen offset:512
  buffer_load_dwordx4 v[52:55], v80, s[8:11], s73 offen offset:576
  buffer_load_dwordx4 v[56:59], v80, s[8:11], s73 offen offset:640
  buffer_load_dwordx4 v[60:63], v80, s[8:11], s73 offen offset:704
  buffer_load_dwordx4 v[64:67], v80, s[8:11], s73 offen offset:768
  buffer_load_dwordx4 v[68:71], v80, s[8:11], s73 offen offset:832
  buffer_load_dwordx4 v[72:75], v80, s[8:11], s73 offen offset:896
  buffer_load_dwordx4 v[76:79], v80, s[8:11], s73 offen offset:960
  v_mov_b32 v81, 0x3f803f80
  v_mov_b32 v82, 0
  v_mov_b32 v83, 0
  v_mov_b32 v84, 0
  v_mov_b32 v85, 0
  s_waitcnt vmcnt(15)
  v_dot2_f32_bf16 v82, v16, v81, v82
  v_dot2_f32_bf16 v84, v16, v16, v84
  v_dot2_f32_bf16 v83, v17, v81, v83
  v_dot2_f32_bf16 v85, v17, v17, v85
  v_dot2_f32_bf16 v82, v18, v81, v82
  v_dot2_f32_bf16 v84, v18, v18, v84
  v_dot2_f32_bf16 v83, v19, v81, v83
  v_dot2_f32_bf16 v85, v19, v19, v85
  s_waitcnt vmcnt(14)
  v_dot2_f32_bf16 v82, v20, v81, v82
  v_dot2_f32_bf16 v84, v20, v20, v84
  v_dot2_f32_bf16 v83, v21, v81, v83
  v_dot2_f32_bf16 v85, v21, v21, v85
  v_dot2_f32_bf16 v82, v22, v81, v82
  v_dot2_f32_bf16 v84, v22, v22, v84
  v_dot2_f32_bf16 v83, v23, v81, v83
  v_dot2_f32_bf16 v85, v23, v23, v85
  s_waitcnt vmcnt(13)
  v_dot2_f32_bf16 v82, v24, v81, v82
  v_dot2_f32_bf16 v84, v24, v24, v84
  v_dot2_f32_bf16 v83, v25, v81, v83
  v_dot2_f32_bf16 v85, v25, v25, v85
  v_dot2_f32_bf16 v82, v26, v81, v82
  v_dot2_f32_bf16 v84, v26, v26, v84
  v_dot2_f32_bf16 v83, v27, v81, v83
  v_dot2_f32_bf16 v85, v27, v27, v85
  s_waitcnt vmcnt(12)
  v_dot2_f32_bf16 v82, v28, v81, v82
  v_dot2_f32_bf16 v84, v28, v28, v84
  v_dot2_f32_bf16 v83, v29, v81, v83
  v_dot2_f32_bf16 v85, v29, v29, v85
  v_dot2_f32_bf16 v82, v30, v81, v82
  v_dot2_f32_bf16 v84, v30, v30, v84
  v_dot2_f32_bf16 v83, v31, v81, v83
  v_dot2_f32_bf16 v85, v31, v31, v85
  s_waitcnt vmcnt(11)
  v_dot2_f32_bf16 v82, v32, v81, v82
  v_dot2_f32_bf16 v84, v32, v32, v84
  v_dot2_f32_bf16 v83, v33, v81, v83
  v_dot2_f32_bf16 v85, v33, v33, v85
  v_dot2_f32_bf16 v82, v34, v81, v82
  v_dot2_f32_bf16 v84, v34, v34, v84
  v_dot2_f32_bf16 v83, v35, v81, v83
  v_dot2_f32_bf16 v85, v35, v35, v85
  s_waitcnt vmcnt(10)
  v_dot2_f32_bf16 v82, v36, v81, v82
  v_dot2_f32_bf16 v84, v36, v36, v84
  v_dot2_f32_bf16 v83, v37, v81, v83
  v_dot2_f32_bf16 v85, v37, v37, v85
  v_dot2_f32_bf16 v82, v38, v81, v82
  v_dot2_f32_bf16 v84, v38, v38, v84
  v_dot2_f32_bf16 v83, v39, v81, v83
  v_dot2_f32_bf16 v85, v39, v39, v85
  s_waitcnt vmcnt(9)
  v_dot2_f32_bf16 v82, v40, v81, v82
  v_dot2_f32_bf16 v84, v40, v40, v84
  v_dot2_f32_bf16 v83, v41, v81, v83
  v_dot2_f32_bf16 v85, v41, v41, v85
  v_dot2_f32_bf16 v82, v42, v81, v82
  v_dot2_f32_bf16 v84, v42, v42, v84
  v_dot2_f32_bf16 v83, v43, v81, v83
  v_dot2_f32_bf16 v85, v43, v43, v85
  s_waitcnt vmcnt(8)
  v_dot2_f32_bf16 v82, v44, v81, v82
  v_dot2_f32_bf16 v84, v44, v44, v84
  v_dot2_f32_bf16 v83, v45, v81, v83
  v_dot2_f32_bf16 v85, v45, v45, v85
  v_dot2_f32_bf16 v82, v46, v81, v82
  v_dot2_f32_bf16 v84, v46, v46, v84
  v_dot2_f32_bf16 v83, v47, v81, v83
  v_dot2_f32_bf16 v85, v47, v47, v85
  s_waitcnt vmcnt(7)
  v_dot2_f32_bf16 v82, v48, v81, v82
  v_dot2_f32_bf16 v84, v48, v48, v84
  v_dot2_f32_bf16 v83, v49, v81, v83
  v_dot2_f32_bf16 v85, v49, v49, v85
  v_dot2_f32_bf16 v82, v50, v81, v82
  v_dot2_f32_bf16 v84, v50, v50, v84
  v_dot2_f32_bf16 v83, v51, v81, v83
  v_dot2_f32_bf16 v85, v51, v51, v85
  s_waitcnt vmcnt(6)
  v_dot2_f32_bf16 v82, v52, v81, v82
  v_dot2_f32_bf16 v84, v52, v52, v84
  v_dot2_f32_bf16 v83, v53, v81, v83
  v_dot2_f32_bf16 v85, v53, v53, v85
  v_dot2_f32_bf16 v82, v54, v81, v82
  v_dot2_f32_bf16 v84, v54, v54, v84
  v_dot2_f32_bf16 v83, v55, v81, v83
  v_dot2_f32_bf16 v85, v55, v55, v85
  s_waitcnt vmcnt(5)
  v_dot2_f32_bf16 v82, v56, v81, v82
  v_dot2_f32_bf16 v84, v56, v56, v84
  v_dot2_f32_bf16 v83, v57, v81, v83
  v_dot2_f32_bf16 v85, v57, v57, v85
  v_dot2_f32_bf16 v82, v58, v81, v82
  v_dot2_f32_bf16 v84, v58, v58, v84
  v_dot2_f32_bf16 v83, v59, v81, v83
  v_dot2_f32_bf16 v85, v59, v59, v85
  s_waitcnt vmcnt(4)
  v_dot2_f32_bf16 v82, v60, v81, v82
  v_dot2_f32_bf16 v84, v60, v60, v84
  v_dot2_f32_bf16 v83, v61, v81, v83
  v_dot2_f32_bf16 v85, v61, v61, v85
  v_dot2_f32_bf16 v82, v62, v81, v82
  v_dot2_f32_bf16 v84, v62, v62, v84
  v_dot2_f32_bf16 v83, v63, v81, v83
  v_dot2_f32_bf16 v85, v63, v63, v85
  s_waitcnt vmcnt(3)
  v_dot2_f32_bf16 v82, v64, v81, v82
  v_dot2_f32_bf16 v84, v64, v64, v84
  v_dot2_f32_bf16 v83, v65, v81, v83
  v_dot2_f32_bf16 v85, v65, v65, v85
  v_dot2_f32_bf16 v82, v66, v81, v82
  v_dot2_f32_bf16 v84, v66, v66, v84
  v_dot2_f32_bf16 v83, v67, v81, v83
  v_dot2_f32_bf16 v85, v67, v67, v85
  s_waitcnt vmcnt(2)
  v_dot2_f32_bf16 v82, v68, v81, v82
  v_dot2_f32_bf16 v84, v68, v68, v84
  v_dot2_f32_bf16 v83, v69, v81, v83
  v_dot2_f32_bf16 v85, v69, v69, v85
  v_dot2_f32_bf16 v82, v70, v81, v82
  v_dot2_f32_bf16 v84, v70, v70, v84
  v_dot2_f32_bf16 v83, v71, v81, v83
  v_dot2_f32_bf16 v85, v71, v71, v85
  s_waitcnt vmcnt(1)
  v_dot2_f32_bf16 v82, v72, v81, v82
  v_dot2_f32_bf16 v84, v72, v72, v84
  v_dot2_f32_bf16 v83, v73, v81, v83
  v_dot2_f32_bf16 v85, v73, v73, v85
  v_dot2_f32_bf16 v82, v74, v81, v82
  v_dot2_f32_bf16 v84, v74, v74, v84
  v_dot2_f32_bf16 v83, v75, v81, v83
  v_dot2_f32_bf16 v85, v75, v75, v85
  s_waitcnt vmcnt(0)
  v_dot2_f32_bf16 v82, v76, v81, v82
  v_dot2_f32_bf16 v84, v76, v76, v84
  v_dot2_f32_bf16 v83, v77, v81, v83
  v_dot2_f32_bf16 v85, v77, v77, v85
  v_dot2_f32_bf16 v82, v78, v81, v82
  v_dot2_f32_bf16 v84, v78, v78, v84
  v_dot2_f32_bf16 v83, v79, v81, v83
  v_dot2_f32_bf16 v85, v79, v79, v85
  s_nop 1
  v_add_f32 v82, v82, v83
  v_add_f32 v84, v84, v85
  v_mov_b32 v86, v82
  s_nop 1
  v_permlane16_swap_b32 v82, v86
  v_add_f32 v82, v82, v86
  v_mov_b32 v86, v84
  s_nop 1
  v_permlane16_swap_b32 v84, v86
  v_add_f32 v84, v84, v86
  v_mov_b32 v86, v82
  s_nop 1
  v_permlane32_swap_b32 v82, v86
  v_add_f32 v82, v82, v86
  v_mov_b32 v86, v84
  s_nop 1
  v_permlane32_swap_b32 v84, v86
  v_add_f32 v84, v84, v86
  v_mul_f32 v82, 0x3b000000, v82
  v_mul_f32 v84, 0x3b000000, v84
  v_fma_f32 v84, -v82, v82, v84
  v_max_f32 v84, 0, v84
  v_cvt_pk_bf16_f32 v82, v82, v82
  v_lshlrev_b32 v82, 16, v82
  v_cvt_pk_bf16_f32 v84, v84, v84
  v_lshlrev_b32 v84, 16, v84
  v_add_f32 v84, 0x3727c5ac, v84
  v_cvt_pk_bf16_f32 v84, v84, v84
  v_lshlrev_b32 v84, 16, v84
  v_sqrt_f32 v84, v84
  s_nop 0
  v_cvt_pk_bf16_f32 v84, v84, v84
  v_lshlrev_b32 v84, 16, v84
  v_rcp_f32 v84, v84
  s_add_u32 s73, s73, 0x0
  v_lshlrev_b32 v86, 16, v16
  v_and_b32 v87, 0xffff0000, v16
  v_sub_f32 v86, v86, v82
  v_sub_f32 v87, v87, v82
  v_cvt_pk_bf16_f32 v16, v86, v87
  v_lshlrev_b32 v86, 16, v16
  v_and_b32 v87, 0xffff0000, v16
  v_mul_f32 v86, v86, v84
  v_mul_f32 v87, v87, v84
  v_cvt_pk_bf16_f32 v16, v86, v87
  v_lshlrev_b32 v86, 16, v17
  v_and_b32 v87, 0xffff0000, v17
  v_sub_f32 v86, v86, v82
  v_sub_f32 v87, v87, v82
  v_cvt_pk_bf16_f32 v17, v86, v87
  v_lshlrev_b32 v86, 16, v17
  v_and_b32 v87, 0xffff0000, v17
  v_mul_f32 v86, v86, v84
  v_mul_f32 v87, v87, v84
  v_cvt_pk_bf16_f32 v17, v86, v87
  v_lshlrev_b32 v86, 16, v18
  v_and_b32 v87, 0xffff0000, v18
  v_sub_f32 v86, v86, v82
  v_sub_f32 v87, v87, v82
  v_cvt_pk_bf16_f32 v18, v86, v87
  v_lshlrev_b32 v86, 16, v18
  v_and_b32 v87, 0xffff0000, v18
  v_mul_f32 v86, v86, v84
  v_mul_f32 v87, v87, v84
  v_cvt_pk_bf16_f32 v18, v86, v87
  v_lshlrev_b32 v86, 16, v19
  v_and_b32 v87, 0xffff0000, v19
  v_sub_f32 v86, v86, v82
  v_sub_f32 v87, v87, v82
  v_cvt_pk_bf16_f32 v19, v86, v87
  v_lshlrev_b32 v86, 16, v19
  v_and_b32 v87, 0xffff0000, v19
  v_mul_f32 v86, v86, v84
  v_mul_f32 v87, v87, v84
  v_cvt_pk_bf16_f32 v19, v86, v87
  buffer_store_dwordx4 v[16:19], v1, s[4:7], s73 offen offset:0 sc1
  v_lshlrev_b32 v86, 16, v20
  v_and_b32 v87, 0xffff0000, v20
  v_sub_f32 v86, v86, v82
  v_sub_f32 v87, v87, v82
  v_cvt_pk_bf16_f32 v20, v86, v87
  v_lshlrev_b32 v86, 16, v20
  v_and_b32 v87, 0xffff0000, v20
  v_mul_f32 v86, v86, v84
  v_mul_f32 v87, v87, v84
  v_cvt_pk_bf16_f32 v20, v86, v87
  v_lshlrev_b32 v86, 16, v21
  v_and_b32 v87, 0xffff0000, v21
  v_sub_f32 v86, v86, v82
  v_sub_f32 v87, v87, v82
  v_cvt_pk_bf16_f32 v21, v86, v87
  v_lshlrev_b32 v86, 16, v21
  v_and_b32 v87, 0xffff0000, v21
  v_mul_f32 v86, v86, v84
  v_mul_f32 v87, v87, v84
  v_cvt_pk_bf16_f32 v21, v86, v87
  v_lshlrev_b32 v86, 16, v22
  v_and_b32 v87, 0xffff0000, v22
  v_sub_f32 v86, v86, v82
  v_sub_f32 v87, v87, v82
  v_cvt_pk_bf16_f32 v22, v86, v87
  v_lshlrev_b32 v86, 16, v22
  v_and_b32 v87, 0xffff0000, v22
  v_mul_f32 v86, v86, v84
  v_mul_f32 v87, v87, v84
  v_cvt_pk_bf16_f32 v22, v86, v87
  v_lshlrev_b32 v86, 16, v23
  v_and_b32 v87, 0xffff0000, v23
  v_sub_f32 v86, v86, v82
  v_sub_f32 v87, v87, v82
  v_cvt_pk_bf16_f32 v23, v86, v87
  v_lshlrev_b32 v86, 16, v23
  v_and_b32 v87, 0xffff0000, v23
  v_mul_f32 v86, v86, v84
  v_mul_f32 v87, v87, v84
  v_cvt_pk_bf16_f32 v23, v86, v87
  buffer_store_dwordx4 v[20:23], v1, s[4:7], s73 offen offset:1024 sc1
  v_lshlrev_b32 v86, 16, v24
  v_and_b32 v87, 0xffff0000, v24
  v_sub_f32 v86, v86, v82
  v_sub_f32 v87, v87, v82
  v_cvt_pk_bf16_f32 v24, v86, v87
  v_lshlrev_b32 v86, 16, v24
  v_and_b32 v87, 0xffff0000, v24
  v_mul_f32 v86, v86, v84
  v_mul_f32 v87, v87, v84
  v_cvt_pk_bf16_f32 v24, v86, v87
  v_lshlrev_b32 v86, 16, v25
  v_and_b32 v87, 0xffff0000, v25
  v_sub_f32 v86, v86, v82
  v_sub_f32 v87, v87, v82
  v_cvt_pk_bf16_f32 v25, v86, v87
  v_lshlrev_b32 v86, 16, v25
  v_and_b32 v87, 0xffff0000, v25
  v_mul_f32 v86, v86, v84
  v_mul_f32 v87, v87, v84
  v_cvt_pk_bf16_f32 v25, v86, v87
  v_lshlrev_b32 v86, 16, v26
  v_and_b32 v87, 0xffff0000, v26
  v_sub_f32 v86, v86, v82
  v_sub_f32 v87, v87, v82
  v_cvt_pk_bf16_f32 v26, v86, v87
  v_lshlrev_b32 v86, 16, v26
  v_and_b32 v87, 0xffff0000, v26
  v_mul_f32 v86, v86, v84
  v_mul_f32 v87, v87, v84
  v_cvt_pk_bf16_f32 v26, v86, v87
  v_lshlrev_b32 v86, 16, v27
  v_and_b32 v87, 0xffff0000, v27
  v_sub_f32 v86, v86, v82
  v_sub_f32 v87, v87, v82
  v_cvt_pk_bf16_f32 v27, v86, v87
  v_lshlrev_b32 v86, 16, v27
  v_and_b32 v87, 0xffff0000, v27
  v_mul_f32 v86, v86, v84
  v_mul_f32 v87, v87, v84
  v_cvt_pk_bf16_f32 v27, v86, v87
  buffer_store_dwordx4 v[24:27], v1, s[4:7], s73 offen offset:2048 sc1
  v_lshlrev_b32 v86, 16, v28
  v_and_b32 v87, 0xffff0000, v28
  v_sub_f32 v86, v86, v82
  v_sub_f32 v87, v87, v82
  v_cvt_pk_bf16_f32 v28, v86, v87
  v_lshlrev_b32 v86, 16, v28
  v_and_b32 v87, 0xffff0000, v28
  v_mul_f32 v86, v86, v84
  v_mul_f32 v87, v87, v84
  v_cvt_pk_bf16_f32 v28, v86, v87
  v_lshlrev_b32 v86, 16, v29
  v_and_b32 v87, 0xffff0000, v29
  v_sub_f32 v86, v86, v82
  v_sub_f32 v87, v87, v82
  v_cvt_pk_bf16_f32 v29, v86, v87
  v_lshlrev_b32 v86, 16, v29
  v_and_b32 v87, 0xffff0000, v29
  v_mul_f32 v86, v86, v84
  v_mul_f32 v87, v87, v84
  v_cvt_pk_bf16_f32 v29, v86, v87
  v_lshlrev_b32 v86, 16, v30
  v_and_b32 v87, 0xffff0000, v30
  v_sub_f32 v86, v86, v82
  v_sub_f32 v87, v87, v82
  v_cvt_pk_bf16_f32 v30, v86, v87
  v_lshlrev_b32 v86, 16, v30
  v_and_b32 v87, 0xffff0000, v30
  v_mul_f32 v86, v86, v84
  v_mul_f32 v87, v87, v84
  v_cvt_pk_bf16_f32 v30, v86, v87
  v_lshlrev_b32 v86, 16, v31
  v_and_b32 v87, 0xffff0000, v31
  v_sub_f32 v86, v86, v82
  v_sub_f32 v87, v87, v82
  v_cvt_pk_bf16_f32 v31, v86, v87
  v_lshlrev_b32 v86, 16, v31
  v_and_b32 v87, 0xffff0000, v31
  v_mul_f32 v86, v86, v84
  v_mul_f32 v87, v87, v84
  v_cvt_pk_bf16_f32 v31, v86, v87
  buffer_store_dwordx4 v[28:31], v1, s[4:7], s73 offen offset:3072 sc1
  v_lshlrev_b32 v86, 16, v32
  v_and_b32 v87, 0xffff0000, v32
  v_sub_f32 v86, v86, v82
  v_sub_f32 v87, v87, v82
  v_cvt_pk_bf16_f32 v32, v86, v87
  v_lshlrev_b32 v86, 16, v32
  v_and_b32 v87, 0xffff0000, v32
  v_mul_f32 v86, v86, v84
  v_mul_f32 v87, v87, v84
  v_cvt_pk_bf16_f32 v32, v86, v87
  v_lshlrev_b32 v86, 16, v33
  v_and_b32 v87, 0xffff0000, v33
  v_sub_f32 v86, v86, v82
  v_sub_f32 v87, v87, v82
  v_cvt_pk_bf16_f32 v33, v86, v87
  v_lshlrev_b32 v86, 16, v33
  v_and_b32 v87, 0xffff0000, v33
  v_mul_f32 v86, v86, v84
  v_mul_f32 v87, v87, v84
  v_cvt_pk_bf16_f32 v33, v86, v87
  v_lshlrev_b32 v86, 16, v34
  v_and_b32 v87, 0xffff0000, v34
  v_sub_f32 v86, v86, v82
  v_sub_f32 v87, v87, v82
  v_cvt_pk_bf16_f32 v34, v86, v87
  v_lshlrev_b32 v86, 16, v34
  v_and_b32 v87, 0xffff0000, v34
  v_mul_f32 v86, v86, v84
  v_mul_f32 v87, v87, v84
  v_cvt_pk_bf16_f32 v34, v86, v87
  v_lshlrev_b32 v86, 16, v35
  v_and_b32 v87, 0xffff0000, v35
  v_sub_f32 v86, v86, v82
  v_sub_f32 v87, v87, v82
  v_cvt_pk_bf16_f32 v35, v86, v87
  v_lshlrev_b32 v86, 16, v35
  v_and_b32 v87, 0xffff0000, v35
  v_mul_f32 v86, v86, v84
  v_mul_f32 v87, v87, v84
  v_cvt_pk_bf16_f32 v35, v86, v87
  s_add_u32 s73, s73, 4096
  buffer_store_dwordx4 v[32:35], v1, s[4:7], s73 offen offset:0 sc1
  v_lshlrev_b32 v86, 16, v36
  v_and_b32 v87, 0xffff0000, v36
  v_sub_f32 v86, v86, v82
  v_sub_f32 v87, v87, v82
  v_cvt_pk_bf16_f32 v36, v86, v87
  v_lshlrev_b32 v86, 16, v36
  v_and_b32 v87, 0xffff0000, v36
  v_mul_f32 v86, v86, v84
  v_mul_f32 v87, v87, v84
  v_cvt_pk_bf16_f32 v36, v86, v87
  v_lshlrev_b32 v86, 16, v37
  v_and_b32 v87, 0xffff0000, v37
  v_sub_f32 v86, v86, v82
  v_sub_f32 v87, v87, v82
  v_cvt_pk_bf16_f32 v37, v86, v87
  v_lshlrev_b32 v86, 16, v37
  v_and_b32 v87, 0xffff0000, v37
  v_mul_f32 v86, v86, v84
  v_mul_f32 v87, v87, v84
  v_cvt_pk_bf16_f32 v37, v86, v87
  v_lshlrev_b32 v86, 16, v38
  v_and_b32 v87, 0xffff0000, v38
  v_sub_f32 v86, v86, v82
  v_sub_f32 v87, v87, v82
  v_cvt_pk_bf16_f32 v38, v86, v87
  v_lshlrev_b32 v86, 16, v38
  v_and_b32 v87, 0xffff0000, v38
  v_mul_f32 v86, v86, v84
  v_mul_f32 v87, v87, v84
  v_cvt_pk_bf16_f32 v38, v86, v87
  v_lshlrev_b32 v86, 16, v39
  v_and_b32 v87, 0xffff0000, v39
  v_sub_f32 v86, v86, v82
  v_sub_f32 v87, v87, v82
  v_cvt_pk_bf16_f32 v39, v86, v87
  v_lshlrev_b32 v86, 16, v39
  v_and_b32 v87, 0xffff0000, v39
  v_mul_f32 v86, v86, v84
  v_mul_f32 v87, v87, v84
  v_cvt_pk_bf16_f32 v39, v86, v87
  buffer_store_dwordx4 v[36:39], v1, s[4:7], s73 offen offset:1024 sc1
  v_lshlrev_b32 v86, 16, v40
  v_and_b32 v87, 0xffff0000, v40
  v_sub_f32 v86, v86, v82
  v_sub_f32 v87, v87, v82
  v_cvt_pk_bf16_f32 v40, v86, v87
  v_lshlrev_b32 v86, 16, v40
  v_and_b32 v87, 0xffff0000, v40
  v_mul_f32 v86, v86, v84
  v_mul_f32 v87, v87, v84
  v_cvt_pk_bf16_f32 v40, v86, v87
  v_lshlrev_b32 v86, 16, v41
  v_and_b32 v87, 0xffff0000, v41
  v_sub_f32 v86, v86, v82
  v_sub_f32 v87, v87, v82
  v_cvt_pk_bf16_f32 v41, v86, v87
  v_lshlrev_b32 v86, 16, v41
  v_and_b32 v87, 0xffff0000, v41
  v_mul_f32 v86, v86, v84
  v_mul_f32 v87, v87, v84
  v_cvt_pk_bf16_f32 v41, v86, v87
  v_lshlrev_b32 v86, 16, v42
  v_and_b32 v87, 0xffff0000, v42
  v_sub_f32 v86, v86, v82
  v_sub_f32 v87, v87, v82
  v_cvt_pk_bf16_f32 v42, v86, v87
  v_lshlrev_b32 v86, 16, v42
  v_and_b32 v87, 0xffff0000, v42
  v_mul_f32 v86, v86, v84
  v_mul_f32 v87, v87, v84
  v_cvt_pk_bf16_f32 v42, v86, v87
  v_lshlrev_b32 v86, 16, v43
  v_and_b32 v87, 0xffff0000, v43
  v_sub_f32 v86, v86, v82
  v_sub_f32 v87, v87, v82
  v_cvt_pk_bf16_f32 v43, v86, v87
  v_lshlrev_b32 v86, 16, v43
  v_and_b32 v87, 0xffff0000, v43
  v_mul_f32 v86, v86, v84
  v_mul_f32 v87, v87, v84
  v_cvt_pk_bf16_f32 v43, v86, v87
  buffer_store_dwordx4 v[40:43], v1, s[4:7], s73 offen offset:2048 sc1
  v_lshlrev_b32 v86, 16, v44
  v_and_b32 v87, 0xffff0000, v44
  v_sub_f32 v86, v86, v82
  v_sub_f32 v87, v87, v82
  v_cvt_pk_bf16_f32 v44, v86, v87
  v_lshlrev_b32 v86, 16, v44
  v_and_b32 v87, 0xffff0000, v44
  v_mul_f32 v86, v86, v84
  v_mul_f32 v87, v87, v84
  v_cvt_pk_bf16_f32 v44, v86, v87
  v_lshlrev_b32 v86, 16, v45
  v_and_b32 v87, 0xffff0000, v45
  v_sub_f32 v86, v86, v82
  v_sub_f32 v87, v87, v82
  v_cvt_pk_bf16_f32 v45, v86, v87
  v_lshlrev_b32 v86, 16, v45
  v_and_b32 v87, 0xffff0000, v45
  v_mul_f32 v86, v86, v84
  v_mul_f32 v87, v87, v84
  v_cvt_pk_bf16_f32 v45, v86, v87
  v_lshlrev_b32 v86, 16, v46
  v_and_b32 v87, 0xffff0000, v46
  v_sub_f32 v86, v86, v82
  v_sub_f32 v87, v87, v82
  v_cvt_pk_bf16_f32 v46, v86, v87
  v_lshlrev_b32 v86, 16, v46
  v_and_b32 v87, 0xffff0000, v46
  v_mul_f32 v86, v86, v84
  v_mul_f32 v87, v87, v84
  v_cvt_pk_bf16_f32 v46, v86, v87
  v_lshlrev_b32 v86, 16, v47
  v_and_b32 v87, 0xffff0000, v47
  v_sub_f32 v86, v86, v82
  v_sub_f32 v87, v87, v82
  v_cvt_pk_bf16_f32 v47, v86, v87
  v_lshlrev_b32 v86, 16, v47
  v_and_b32 v87, 0xffff0000, v47
  v_mul_f32 v86, v86, v84
  v_mul_f32 v87, v87, v84
  v_cvt_pk_bf16_f32 v47, v86, v87
  buffer_store_dwordx4 v[44:47], v1, s[4:7], s73 offen offset:3072 sc1
  v_lshlrev_b32 v86, 16, v48
  v_and_b32 v87, 0xffff0000, v48
  v_sub_f32 v86, v86, v82
  v_sub_f32 v87, v87, v82
  v_cvt_pk_bf16_f32 v48, v86, v87
  v_lshlrev_b32 v86, 16, v48
  v_and_b32 v87, 0xffff0000, v48
  v_mul_f32 v86, v86, v84
  v_mul_f32 v87, v87, v84
  v_cvt_pk_bf16_f32 v48, v86, v87
  v_lshlrev_b32 v86, 16, v49
  v_and_b32 v87, 0xffff0000, v49
  v_sub_f32 v86, v86, v82
  v_sub_f32 v87, v87, v82
  v_cvt_pk_bf16_f32 v49, v86, v87
  v_lshlrev_b32 v86, 16, v49
  v_and_b32 v87, 0xffff0000, v49
  v_mul_f32 v86, v86, v84
  v_mul_f32 v87, v87, v84
  v_cvt_pk_bf16_f32 v49, v86, v87
  v_lshlrev_b32 v86, 16, v50
  v_and_b32 v87, 0xffff0000, v50
  v_sub_f32 v86, v86, v82
  v_sub_f32 v87, v87, v82
  v_cvt_pk_bf16_f32 v50, v86, v87
  v_lshlrev_b32 v86, 16, v50
  v_and_b32 v87, 0xffff0000, v50
  v_mul_f32 v86, v86, v84
  v_mul_f32 v87, v87, v84
  v_cvt_pk_bf16_f32 v50, v86, v87
  v_lshlrev_b32 v86, 16, v51
  v_and_b32 v87, 0xffff0000, v51
  v_sub_f32 v86, v86, v82
  v_sub_f32 v87, v87, v82
  v_cvt_pk_bf16_f32 v51, v86, v87
  v_lshlrev_b32 v86, 16, v51
  v_and_b32 v87, 0xffff0000, v51
  v_mul_f32 v86, v86, v84
  v_mul_f32 v87, v87, v84
  v_cvt_pk_bf16_f32 v51, v86, v87
  s_add_u32 s73, s73, 4096
  buffer_store_dwordx4 v[48:51], v1, s[4:7], s73 offen offset:0 sc1
  v_lshlrev_b32 v86, 16, v52
  v_and_b32 v87, 0xffff0000, v52
  v_sub_f32 v86, v86, v82
  v_sub_f32 v87, v87, v82
  v_cvt_pk_bf16_f32 v52, v86, v87
  v_lshlrev_b32 v86, 16, v52
  v_and_b32 v87, 0xffff0000, v52
  v_mul_f32 v86, v86, v84
  v_mul_f32 v87, v87, v84
  v_cvt_pk_bf16_f32 v52, v86, v87
  v_lshlrev_b32 v86, 16, v53
  v_and_b32 v87, 0xffff0000, v53
  v_sub_f32 v86, v86, v82
  v_sub_f32 v87, v87, v82
  v_cvt_pk_bf16_f32 v53, v86, v87
  v_lshlrev_b32 v86, 16, v53
  v_and_b32 v87, 0xffff0000, v53
  v_mul_f32 v86, v86, v84
  v_mul_f32 v87, v87, v84
  v_cvt_pk_bf16_f32 v53, v86, v87
  v_lshlrev_b32 v86, 16, v54
  v_and_b32 v87, 0xffff0000, v54
  v_sub_f32 v86, v86, v82
  v_sub_f32 v87, v87, v82
  v_cvt_pk_bf16_f32 v54, v86, v87
  v_lshlrev_b32 v86, 16, v54
  v_and_b32 v87, 0xffff0000, v54
  v_mul_f32 v86, v86, v84
  v_mul_f32 v87, v87, v84
  v_cvt_pk_bf16_f32 v54, v86, v87
  v_lshlrev_b32 v86, 16, v55
  v_and_b32 v87, 0xffff0000, v55
  v_sub_f32 v86, v86, v82
  v_sub_f32 v87, v87, v82
  v_cvt_pk_bf16_f32 v55, v86, v87
  v_lshlrev_b32 v86, 16, v55
  v_and_b32 v87, 0xffff0000, v55
  v_mul_f32 v86, v86, v84
  v_mul_f32 v87, v87, v84
  v_cvt_pk_bf16_f32 v55, v86, v87
  buffer_store_dwordx4 v[52:55], v1, s[4:7], s73 offen offset:1024 sc1
  v_lshlrev_b32 v86, 16, v56
  v_and_b32 v87, 0xffff0000, v56
  v_sub_f32 v86, v86, v82
  v_sub_f32 v87, v87, v82
  v_cvt_pk_bf16_f32 v56, v86, v87
  v_lshlrev_b32 v86, 16, v56
  v_and_b32 v87, 0xffff0000, v56
  v_mul_f32 v86, v86, v84
  v_mul_f32 v87, v87, v84
  v_cvt_pk_bf16_f32 v56, v86, v87
  v_lshlrev_b32 v86, 16, v57
  v_and_b32 v87, 0xffff0000, v57
  v_sub_f32 v86, v86, v82
  v_sub_f32 v87, v87, v82
  v_cvt_pk_bf16_f32 v57, v86, v87
  v_lshlrev_b32 v86, 16, v57
  v_and_b32 v87, 0xffff0000, v57
  v_mul_f32 v86, v86, v84
  v_mul_f32 v87, v87, v84
  v_cvt_pk_bf16_f32 v57, v86, v87
  v_lshlrev_b32 v86, 16, v58
  v_and_b32 v87, 0xffff0000, v58
  v_sub_f32 v86, v86, v82
  v_sub_f32 v87, v87, v82
  v_cvt_pk_bf16_f32 v58, v86, v87
  v_lshlrev_b32 v86, 16, v58
  v_and_b32 v87, 0xffff0000, v58
  v_mul_f32 v86, v86, v84
  v_mul_f32 v87, v87, v84
  v_cvt_pk_bf16_f32 v58, v86, v87
  v_lshlrev_b32 v86, 16, v59
  v_and_b32 v87, 0xffff0000, v59
  v_sub_f32 v86, v86, v82
  v_sub_f32 v87, v87, v82
  v_cvt_pk_bf16_f32 v59, v86, v87
  v_lshlrev_b32 v86, 16, v59
  v_and_b32 v87, 0xffff0000, v59
  v_mul_f32 v86, v86, v84
  v_mul_f32 v87, v87, v84
  v_cvt_pk_bf16_f32 v59, v86, v87
  buffer_store_dwordx4 v[56:59], v1, s[4:7], s73 offen offset:2048 sc1
  v_lshlrev_b32 v86, 16, v60
  v_and_b32 v87, 0xffff0000, v60
  v_sub_f32 v86, v86, v82
  v_sub_f32 v87, v87, v82
  v_cvt_pk_bf16_f32 v60, v86, v87
  v_lshlrev_b32 v86, 16, v60
  v_and_b32 v87, 0xffff0000, v60
  v_mul_f32 v86, v86, v84
  v_mul_f32 v87, v87, v84
  v_cvt_pk_bf16_f32 v60, v86, v87
  v_lshlrev_b32 v86, 16, v61
  v_and_b32 v87, 0xffff0000, v61
  v_sub_f32 v86, v86, v82
  v_sub_f32 v87, v87, v82
  v_cvt_pk_bf16_f32 v61, v86, v87
  v_lshlrev_b32 v86, 16, v61
  v_and_b32 v87, 0xffff0000, v61
  v_mul_f32 v86, v86, v84
  v_mul_f32 v87, v87, v84
  v_cvt_pk_bf16_f32 v61, v86, v87
  v_lshlrev_b32 v86, 16, v62
  v_and_b32 v87, 0xffff0000, v62
  v_sub_f32 v86, v86, v82
  v_sub_f32 v87, v87, v82
  v_cvt_pk_bf16_f32 v62, v86, v87
  v_lshlrev_b32 v86, 16, v62
  v_and_b32 v87, 0xffff0000, v62
  v_mul_f32 v86, v86, v84
  v_mul_f32 v87, v87, v84
  v_cvt_pk_bf16_f32 v62, v86, v87
  v_lshlrev_b32 v86, 16, v63
  v_and_b32 v87, 0xffff0000, v63
  v_sub_f32 v86, v86, v82
  v_sub_f32 v87, v87, v82
  v_cvt_pk_bf16_f32 v63, v86, v87
  v_lshlrev_b32 v86, 16, v63
  v_and_b32 v87, 0xffff0000, v63
  v_mul_f32 v86, v86, v84
  v_mul_f32 v87, v87, v84
  v_cvt_pk_bf16_f32 v63, v86, v87
  buffer_store_dwordx4 v[60:63], v1, s[4:7], s73 offen offset:3072 sc1
  v_lshlrev_b32 v86, 16, v64
  v_and_b32 v87, 0xffff0000, v64
  v_sub_f32 v86, v86, v82
  v_sub_f32 v87, v87, v82
  v_cvt_pk_bf16_f32 v64, v86, v87
  v_lshlrev_b32 v86, 16, v64
  v_and_b32 v87, 0xffff0000, v64
  v_mul_f32 v86, v86, v84
  v_mul_f32 v87, v87, v84
  v_cvt_pk_bf16_f32 v64, v86, v87
  v_lshlrev_b32 v86, 16, v65
  v_and_b32 v87, 0xffff0000, v65
  v_sub_f32 v86, v86, v82
  v_sub_f32 v87, v87, v82
  v_cvt_pk_bf16_f32 v65, v86, v87
  v_lshlrev_b32 v86, 16, v65
  v_and_b32 v87, 0xffff0000, v65
  v_mul_f32 v86, v86, v84
  v_mul_f32 v87, v87, v84
  v_cvt_pk_bf16_f32 v65, v86, v87
  v_lshlrev_b32 v86, 16, v66
  v_and_b32 v87, 0xffff0000, v66
  v_sub_f32 v86, v86, v82
  v_sub_f32 v87, v87, v82
  v_cvt_pk_bf16_f32 v66, v86, v87
  v_lshlrev_b32 v86, 16, v66
  v_and_b32 v87, 0xffff0000, v66
  v_mul_f32 v86, v86, v84
  v_mul_f32 v87, v87, v84
  v_cvt_pk_bf16_f32 v66, v86, v87
  v_lshlrev_b32 v86, 16, v67
  v_and_b32 v87, 0xffff0000, v67
  v_sub_f32 v86, v86, v82
  v_sub_f32 v87, v87, v82
  v_cvt_pk_bf16_f32 v67, v86, v87
  v_lshlrev_b32 v86, 16, v67
  v_and_b32 v87, 0xffff0000, v67
  v_mul_f32 v86, v86, v84
  v_mul_f32 v87, v87, v84
  v_cvt_pk_bf16_f32 v67, v86, v87
  s_add_u32 s73, s73, 4096
  buffer_store_dwordx4 v[64:67], v1, s[4:7], s73 offen offset:0 sc1
  v_lshlrev_b32 v86, 16, v68
  v_and_b32 v87, 0xffff0000, v68
  v_sub_f32 v86, v86, v82
  v_sub_f32 v87, v87, v82
  v_cvt_pk_bf16_f32 v68, v86, v87
  v_lshlrev_b32 v86, 16, v68
  v_and_b32 v87, 0xffff0000, v68
  v_mul_f32 v86, v86, v84
  v_mul_f32 v87, v87, v84
  v_cvt_pk_bf16_f32 v68, v86, v87
  v_lshlrev_b32 v86, 16, v69
  v_and_b32 v87, 0xffff0000, v69
  v_sub_f32 v86, v86, v82
  v_sub_f32 v87, v87, v82
  v_cvt_pk_bf16_f32 v69, v86, v87
  v_lshlrev_b32 v86, 16, v69
  v_and_b32 v87, 0xffff0000, v69
  v_mul_f32 v86, v86, v84
  v_mul_f32 v87, v87, v84
  v_cvt_pk_bf16_f32 v69, v86, v87
  v_lshlrev_b32 v86, 16, v70
  v_and_b32 v87, 0xffff0000, v70
  v_sub_f32 v86, v86, v82
  v_sub_f32 v87, v87, v82
  v_cvt_pk_bf16_f32 v70, v86, v87
  v_lshlrev_b32 v86, 16, v70
  v_and_b32 v87, 0xffff0000, v70
  v_mul_f32 v86, v86, v84
  v_mul_f32 v87, v87, v84
  v_cvt_pk_bf16_f32 v70, v86, v87
  v_lshlrev_b32 v86, 16, v71
  v_and_b32 v87, 0xffff0000, v71
  v_sub_f32 v86, v86, v82
  v_sub_f32 v87, v87, v82
  v_cvt_pk_bf16_f32 v71, v86, v87
  v_lshlrev_b32 v86, 16, v71
  v_and_b32 v87, 0xffff0000, v71
  v_mul_f32 v86, v86, v84
  v_mul_f32 v87, v87, v84
  v_cvt_pk_bf16_f32 v71, v86, v87
  buffer_store_dwordx4 v[68:71], v1, s[4:7], s73 offen offset:1024 sc1
  v_lshlrev_b32 v86, 16, v72
  v_and_b32 v87, 0xffff0000, v72
  v_sub_f32 v86, v86, v82
  v_sub_f32 v87, v87, v82
  v_cvt_pk_bf16_f32 v72, v86, v87
  v_lshlrev_b32 v86, 16, v72
  v_and_b32 v87, 0xffff0000, v72
  v_mul_f32 v86, v86, v84
  v_mul_f32 v87, v87, v84
  v_cvt_pk_bf16_f32 v72, v86, v87
  v_lshlrev_b32 v86, 16, v73
  v_and_b32 v87, 0xffff0000, v73
  v_sub_f32 v86, v86, v82
  v_sub_f32 v87, v87, v82
  v_cvt_pk_bf16_f32 v73, v86, v87
  v_lshlrev_b32 v86, 16, v73
  v_and_b32 v87, 0xffff0000, v73
  v_mul_f32 v86, v86, v84
  v_mul_f32 v87, v87, v84
  v_cvt_pk_bf16_f32 v73, v86, v87
  v_lshlrev_b32 v86, 16, v74
  v_and_b32 v87, 0xffff0000, v74
  v_sub_f32 v86, v86, v82
  v_sub_f32 v87, v87, v82
  v_cvt_pk_bf16_f32 v74, v86, v87
  v_lshlrev_b32 v86, 16, v74
  v_and_b32 v87, 0xffff0000, v74
  v_mul_f32 v86, v86, v84
  v_mul_f32 v87, v87, v84
  v_cvt_pk_bf16_f32 v74, v86, v87
  v_lshlrev_b32 v86, 16, v75
  v_and_b32 v87, 0xffff0000, v75
  v_sub_f32 v86, v86, v82
  v_sub_f32 v87, v87, v82
  v_cvt_pk_bf16_f32 v75, v86, v87
  v_lshlrev_b32 v86, 16, v75
  v_and_b32 v87, 0xffff0000, v75
  v_mul_f32 v86, v86, v84
  v_mul_f32 v87, v87, v84
  v_cvt_pk_bf16_f32 v75, v86, v87
  buffer_store_dwordx4 v[72:75], v1, s[4:7], s73 offen offset:2048 sc1
  v_lshlrev_b32 v86, 16, v76
  v_and_b32 v87, 0xffff0000, v76
  v_sub_f32 v86, v86, v82
  v_sub_f32 v87, v87, v82
  v_cvt_pk_bf16_f32 v76, v86, v87
  v_lshlrev_b32 v86, 16, v76
  v_and_b32 v87, 0xffff0000, v76
  v_mul_f32 v86, v86, v84
  v_mul_f32 v87, v87, v84
  v_cvt_pk_bf16_f32 v76, v86, v87
  v_lshlrev_b32 v86, 16, v77
  v_and_b32 v87, 0xffff0000, v77
  v_sub_f32 v86, v86, v82
  v_sub_f32 v87, v87, v82
  v_cvt_pk_bf16_f32 v77, v86, v87
  v_lshlrev_b32 v86, 16, v77
  v_and_b32 v87, 0xffff0000, v77
  v_mul_f32 v86, v86, v84
  v_mul_f32 v87, v87, v84
  v_cvt_pk_bf16_f32 v77, v86, v87
  v_lshlrev_b32 v86, 16, v78
  v_and_b32 v87, 0xffff0000, v78
  v_sub_f32 v86, v86, v82
  v_sub_f32 v87, v87, v82
  v_cvt_pk_bf16_f32 v78, v86, v87
  v_lshlrev_b32 v86, 16, v78
  v_and_b32 v87, 0xffff0000, v78
  v_mul_f32 v86, v86, v84
  v_mul_f32 v87, v87, v84
  v_cvt_pk_bf16_f32 v78, v86, v87
  v_lshlrev_b32 v86, 16, v79
  v_and_b32 v87, 0xffff0000, v79
  v_sub_f32 v86, v86, v82
  v_sub_f32 v87, v87, v82
  v_cvt_pk_bf16_f32 v79, v86, v87
  v_lshlrev_b32 v86, 16, v79
  v_and_b32 v87, 0xffff0000, v79
  v_mul_f32 v86, v86, v84
  v_mul_f32 v87, v87, v84
  v_cvt_pk_bf16_f32 v79, v86, v87
  buffer_store_dwordx4 v[76:79], v1, s[4:7], s73 offen offset:3072 sc1
  s_waitcnt vmcnt(0)
  s_cmp_eq_u32 s54, 0
  s_cbranch_scc0 L_ln_clr_ok
  s_mov_b64 exec, 0xff
  v_lshlrev_b32 v12, 4, v0
  v_add_u32 v12, 112, v12
  v_cmp_eq_u32 vcc, 0, v0
  s_nop 1
  v_cndmask_b32 v12, v12, 0, vcc
L_ln_clr:
  buffer_load_dwordx2 v[14:15], v12, s[16:19], 0 offen sc1
  s_waitcnt vmcnt(0)
  v_readlane_b32 s96, v15, 0
  v_readlane_b32 s97, v15, 1
  v_readlane_b32 s98, v15, 2
  v_readlane_b32 s99, v15, 3
  v_readlane_b32 s100, v15, 4
  v_readlane_b32 s101, v15, 5
  v_readlane_b32 s22, v15, 6
  v_readlane_b32 s23, v15, 7
  s_nop 3
  s_add_u32 s3, s96, s97
  s_add_u32 s3, s3, s98
  s_add_u32 s3, s3, s99
  s_add_u32 s3, s3, s100
  s_add_u32 s3, s3, s101
  s_add_u32 s3, s3, s22
  s_add_u32 s3, s3, s23
  s_cmp_ge_u32 s3, 0x100
  s_cbranch_scc1 L_ln_clr_d
  s_sub_u32 s70, s70, 64
  s_cselect_b32 s70, 0, s70
  s_cbranch_scc1 L_ln_clr_d
  s_sleep 4
  s_branch L_ln_clr
L_ln_clr_d:
  s_mov_b64 exec, -1
L_ln_clr_ok:
  s_lshl_b32 s73, s63, 2
  s_add_u32 s73, s73, 0x42d0000
  s_mov_b64 exec, 1
  v_mov_b32 v15, 0
  v_mov_b32 v127, 1
  buffer_store_dword v127, v15, s[4:7], s73 offen sc1
  s_mov_b64 exec, -1
L_noln:
  s_cmp_eq_u32 s55, 0
  s_cbranch_scc0 L_tail_s
L_tail_f:
  v_lshlrev_b32 v1, 4, v0
  s_cmp_eq_u32 s54, 0
  s_cbranch_scc0 L_tl_clr0_f_ok
  s_mov_b64 exec, 0xff
  v_lshlrev_b32 v12, 4, v0
  v_add_u32 v12, 112, v12
  v_cmp_eq_u32 vcc, 0, v0
  s_nop 1
  v_cndmask_b32 v12, v12, 0, vcc
L_tl_clr0_f:
  buffer_load_dwordx2 v[14:15], v12, s[16:19], 0 offen sc1
  s_waitcnt vmcnt(0)
  v_readlane_b32 s96, v15, 0
  v_readlane_b32 s97, v15, 1
  v_readlane_b32 s98, v15, 2
  v_readlane_b32 s99, v15, 3
  v_readlane_b32 s100, v15, 4
  v_readlane_b32 s101, v15, 5
  v_readlane_b32 s22, v15, 6
  v_readlane_b32 s23, v15, 7
  s_nop 3
  s_add_u32 s3, s96, s97
  s_add_u32 s3, s3, s98
  s_add_u32 s3, s3, s99
  s_add_u32 s3, s3, s100
  s_add_u32 s3, s3, s101
  s_add_u32 s3, s3, s22
  s_add_u32 s3, s3, s23
  s_cmp_ge_u32 s3, 0x100
  s_cbranch_scc1 L_tl_clr0_f_d
  s_sub_u32 s70, s70, 64
  s_cselect_b32 s70, 0, s70
  s_cbranch_scc1 L_tl_clr0_f_d
  s_sleep 4
  s_branch L_tl_clr0_f
L_tl_clr0_f_d:
  v_readlane_b32 s96, v14, 0
  v_readlane_b32 s97, v14, 1
  v_readlane_b32 s98, v14, 2
  v_readlane_b32 s99, v14, 3
  v_readlane_b32 s100, v14, 4
  v_readlane_b32 s101, v14, 5
  v_readlane_b32 s22, v14, 6
  v_readlane_b32 s23, v14, 7
  s_nop 3
  s_mov_b32 s3, 0
  s_cmp_eq_u32 s96, 32
  s_cselect_b32 s3, s3, 1
  s_cmp_eq_u32 s97, 32
  s_cselect_b32 s3, s3, 1
  s_cmp_eq_u32 s98, 32
  s_cselect_b32 s3, s3, 1
  s_cmp_eq_u32 s99, 32
  s_cselect_b32 s3, s3, 1
  s_cmp_eq_u32 s100, 32
  s_cselect_b32 s3, s3, 1
  s_cmp_eq_u32 s101, 32
  s_cselect_b32 s3, s3, 1
  s_cmp_eq_u32 s22, 32
  s_cselect_b32 s3, s3, 1
  s_cmp_eq_u32 s23, 32
  s_cselect_b32 s3, s3, 1
  s_cmp_eq_u32 s55, 0
  s_cselect_b32 s3, s3, 0
  s_mov_b64 exec, -1
  v_mov_b32 v12, 0x27ff0
  v_mov_b32 v13, s3
  ds_write_b32 v12, v13
  s_waitcnt lgkmcnt(0)
  s_mov_b64 exec, -1
L_tl_clr0_f_ok:
  s_barrier
  v_mov_b32 v12, 0x27ff0
  ds_read_b32 v13, v12
  s_waitcnt lgkmcnt(0)
  v_readfirstlane_b32 s3, v13
  s_nop 3
  s_cmp_eq_u32 s3, 0
  s_cbranch_scc0 L_fallback
  s_lshl_b32 s62, s52, 7
  s_add_u32 s62, s62, 0x42d1000
  s_cmp_eq_u32 s54, 0
  s_cbranch_scc0 L_tl_go_f_bar
  s_mov_b64 exec, 1
L_tl_go_f:
  buffer_load_dword v12, off, s[4:7], s62 sc1
  s_waitcnt vmcnt(0)
  v_readfirstlane_b32 s72, v12
  s_nop 3
  s_cmp_ge_u32 s72, 1
  s_cbranch_scc1 L_tl_go_f_ok
  s_sub_u32 s70, s70, 16
  s_cselect_b32 s70, 0, s70
  s_cbranch_scc1 L_tl_go_f_ok
  s_sleep 16
  s_branch L_tl_go_f
L_tl_go_f_ok:
  s_mov_b64 exec, -1
L_tl_go_f_bar:
  s_barrier
  s_lshl_b32 s73, s54, 13
  s_add_u32 s73, s73, 0x10000
  v_lshrrev_b32 v104, 1, v0
  v_and_b32 v104, 7, v104
  v_lshrrev_b32 v15, 4, v0
  v_and_b32 v15, 3, v15
  v_xor_b32 v104, v104, v15
  v_lshlrev_b32 v104, 5, v104
  v_lshrrev_b32 v15, 4, v0
  v_and_b32 v15, 3, v15
  v_lshlrev_b32 v15, 8, v15
  v_and_b32 v127, 1, v0
  v_lshlrev_b32 v127, 4, v127
  v_add_u32 v15, v15, v127
  v_add_u32 v104, v104, v15
  v_add_u32 v104, s73, v104
  v_xor_b32 v115, 0x80, v104
  v_lshrrev_b32 v105, 2, v0
  v_and_b32 v105, 3, v105
  v_lshrrev_b32 v127, 4, v0
  v_and_b32 v127, 1, v127
  v_lshlrev_b32 v127, 2, v127
  v_add_u32 v105, v105, v127
  s_lshl_b32 s72, s54, 1
  v_xor_b32 v105, s72, v105
  v_lshlrev_b32 v105, 5, v105
  v_lshrrev_b32 v15, 4, v0
  v_and_b32 v15, 3, v15
  v_lshlrev_b32 v15, 11, v15
  v_lshrrev_b32 v127, 2, v0
  v_and_b32 v127, 3, v127
  v_lshlrev_b32 v127, 8, v127
  v_add_u32 v15, v15, v127
  v_and_b32 v127, 3, v0
  v_lshlrev_b32 v127, 3, v127
  v_add_u32 v15, v15, v127
  v_add_u32 v15, 0x10000, v15
  v_add_u32 v105, v105, v15
  v_xor_b32 v106, 32, v105
  v_lshrrev_b32 v107, 1, v0
  v_and_b32 v107, 3, v107
  v_lshrrev_b32 v15, 4, v0
  v_and_b32 v15, 3, v15
  v_xor_b32 v107, v107, v15
  v_lshlrev_b32 v107, 5, v107
  v_lshrrev_b32 v15, 3, v0
  v_and_b32 v15, 7, v15
  v_lshlrev_b32 v15, 7, v15
  v_and_b32 v127, 1, v0
  v_lshlrev_b32 v127, 4, v127
  v_add_u32 v15, v15, v127
  v_add_u32 v107, v107, v15
  v_add_u32 v107, s73, v107
  v_lshrrev_b32 v108, 4, v0
  v_and_b32 v108, 1, v108
  v_lshlrev_b32 v108, 1, v108
  v_lshrrev_b32 v127, 3, v0
  v_and_b32 v127, 1, v127
  v_add_u32 v108, v108, v127
  v_lshlrev_b32 v108, 5, v108
  v_lshrrev_b32 v15, 4, v0
  v_and_b32 v15, 3, v15
  v_lshlrev_b32 v15, 9, v15
  v_lshrrev_b32 v127, 2, v0
  v_and_b32 v127, 3, v127
  v_lshlrev_b32 v127, 7, v127
  v_add_u32 v15, v15, v127
  v_and_b32 v127, 3, v0
  v_lshlrev_b32 v127, 3, v127
  v_add_u32 v15, v15, v127
  v_add_u32 v108, v108, v15
  v_add_u32 v108, s73, v108
  v_lshrrev_b32 v109, 1, v0
  v_and_b32 v109, 31, v109
  v_lshlrev_b32 v109, 5, v109
  v_lshrrev_b32 v15, 4, v0
  v_and_b32 v15, 1, v15
  v_lshlrev_b32 v15, 7, v15
  v_xor_b32 v109, v109, v15
  v_and_b32 v15, 1, v0
  v_lshlrev_b32 v15, 4, v15
  v_add_u32 v109, v109, v15
  v_add_u32 v109, s73, v109
  v_lshrrev_b32 v110, 4, v0
  v_and_b32 v110, 3, v110
  v_lshlrev_b32 v110, 8, v110
  v_lshrrev_b32 v127, 4, v0
  v_and_b32 v127, 1, v127
  v_lshlrev_b32 v127, 7, v127
  v_add_u32 v110, v110, v127
  v_lshrrev_b32 v127, 2, v0
  v_and_b32 v127, 3, v127
  v_lshlrev_b32 v127, 5, v127
  v_add_u32 v110, v110, v127
  v_and_b32 v127, 3, v0
  v_lshlrev_b32 v127, 3, v127
  v_add_u32 v110, v110, v127
  v_add_u32 v110, s73, v110
  v_xor_b32 v111, 0x80, v110
  v_lshrrev_b32 v112, 3, v0
  v_and_b32 v112, 7, v112
  v_lshlrev_b32 v112, 10, v112
  v_and_b32 v127, 7, v0
  v_lshlrev_b32 v127, 4, v127
  v_add_u32 v112, v112, v127
  s_lshl_b32 s72, s54, 8
  v_add_u32 v112, s72, v112
  s_lshl_b32 s72, s52, 16
  v_add_u32 v113, s72, v112
  s_lshl_b32 s72, s52, 17
  v_add_u32 v112, s72, v112
  v_lshrrev_b32 v114, 1, v0
  v_mul_u32_u24 v114, 3584, v114
  v_and_b32 v15, 1, v0
  v_lshlrev_b32 v15, 4, v15
  v_add_u32 v114, v114, v15
  s_lshl_b32 s72, s54, 5
  v_add_u32 v114, s72, v114
  s_lshl_b32 s72, s52, 7
  v_add_u32 v114, s72, v114
  s_cmp_lt_u32 s52, 28
  s_cbranch_scc0 L_tl_nofw_f
  s_mov_b32 s8, s40
  s_and_b32 s9, s41, 0xffff
  s_mov_b32 s10, 0x1c0000
  s_mov_b32 s11, 0x20000
  s_mov_b32 s74, 0x0
  buffer_load_dwordx4 a[192:195], v114, s[8:11], s74 offen
  s_mov_b32 s74, 0x1c000
  buffer_load_dwordx4 a[196:199], v114, s[8:11], s74 offen
  s_mov_b32 s74, 0x38000
  buffer_load_dwordx4 a[200:203], v114, s[8:11], s74 offen
  s_mov_b32 s74, 0x54000
  buffer_load_dwordx4 a[204:207], v114, s[8:11], s74 offen
  s_mov_b32 s74, 0x70000
  buffer_load_dwordx4 a[208:211], v114, s[8:11], s74 offen
  s_mov_b32 s74, 0x8c000
  buffer_load_dwordx4 a[212:215], v114, s[8:11], s74 offen
  s_mov_b32 s74, 0xa8000
  buffer_load_dwordx4 a[216:219], v114, s[8:11], s74 offen
  s_mov_b32 s74, 0xc4000
  buffer_load_dwordx4 a[220:223], v114, s[8:11], s74 offen
  s_mov_b32 s12, s40
  s_and_b32 s13, s41, 0xffff
  s_mov_b32 s14, 0x1c0000
  s_mov_b32 s15, 0x20000
  s_mov_b32 s74, 0xe0000
  buffer_load_dwordx4 a[224:227], v114, s[12:15], s74 offen
  s_mov_b32 s74, 0xfc000
  buffer_load_dwordx4 a[228:231], v114, s[12:15], s74 offen
  s_mov_b32 s74, 0x118000
  buffer_load_dwordx4 a[232:235], v114, s[12:15], s74 offen
  s_mov_b32 s74, 0x134000
  buffer_load_dwordx4 a[236:239], v114, s[12:15], s74 offen
  s_mov_b32 s74, 0x150000
  buffer_load_dwordx4 a[240:243], v114, s[12:15], s74 offen
  s_mov_b32 s74, 0x16c000
  buffer_load_dwordx4 a[244:247], v114, s[12:15], s74 offen
  s_mov_b32 s74, 0x188000
  buffer_load_dwordx4 a[248:251], v114, s[12:15], s74 offen
  s_mov_b32 s74, 0x1a4000
  buffer_load_dwordx4 a[252:255], v114, s[12:15], s74 offen
  s_mov_b32 s8, s44
  s_and_b32 s9, s45, 0xffff
  s_mov_b32 s10, 0x1c0000
  s_mov_b32 s11, 0x20000
  s_mov_b32 s74, 0x0
  buffer_load_dwordx4 a[128:131], v113, s[8:11], s74 offen
  s_mov_b32 s74, 0x2000
  buffer_load_dwordx4 a[132:135], v113, s[8:11], s74 offen
  s_mov_b32 s74, 0x4000
  buffer_load_dwordx4 a[136:139], v113, s[8:11], s74 offen
  s_mov_b32 s74, 0x6000
  buffer_load_dwordx4 a[140:143], v113, s[8:11], s74 offen
  s_mov_b32 s74, 0x8000
  buffer_load_dwordx4 a[144:147], v113, s[8:11], s74 offen
  s_mov_b32 s74, 0xa000
  buffer_load_dwordx4 a[148:151], v113, s[8:11], s74 offen
  s_mov_b32 s74, 0xc000
  buffer_load_dwordx4 a[152:155], v113, s[8:11], s74 offen
  s_mov_b32 s74, 0xe000
  buffer_load_dwordx4 a[156:159], v113, s[8:11], s74 offen
  s_mov_b32 s12, s44
  s_and_b32 s13, s45, 0xffff
  s_mov_b32 s14, 0x1c0000
  s_mov_b32 s15, 0x20000
  s_mov_b32 s74, 0x80
  buffer_load_dwordx4 a[160:163], v113, s[12:15], s74 offen
  s_mov_b32 s74, 0x2080
  buffer_load_dwordx4 a[164:167], v113, s[12:15], s74 offen
  s_mov_b32 s74, 0x4080
  buffer_load_dwordx4 a[168:171], v113, s[12:15], s74 offen
  s_mov_b32 s74, 0x6080
  buffer_load_dwordx4 a[172:175], v113, s[12:15], s74 offen
  s_mov_b32 s74, 0x8080
  buffer_load_dwordx4 a[176:179], v113, s[12:15], s74 offen
  s_mov_b32 s74, 0xa080
  buffer_load_dwordx4 a[180:183], v113, s[12:15], s74 offen
  s_mov_b32 s74, 0xc080
  buffer_load_dwordx4 a[184:187], v113, s[12:15], s74 offen
  s_mov_b32 s74, 0xe080
  buffer_load_dwordx4 a[188:191], v113, s[12:15], s74 offen
  s_waitcnt vmcnt(24)
  ds_write_b128 v109, a[192:195] offset:0
  ds_write_b128 v109, a[196:199] offset:1024
  ds_write_b128 v109, a[200:203] offset:2048
  ds_write_b128 v109, a[204:207] offset:3072
  ds_write_b128 v109, a[208:211] offset:4096
  ds_write_b128 v109, a[212:215] offset:5120
  ds_write_b128 v109, a[216:219] offset:6144
  ds_write_b128 v109, a[220:223] offset:7168
  s_waitcnt lgkmcnt(0)
  ds_read_b64_tr_b16 a[192:193], v110 offset:0
  ds_read_b64_tr_b16 a[194:195], v111 offset:0
  ds_read_b64_tr_b16 a[196:197], v110 offset:1024
  ds_read_b64_tr_b16 a[198:199], v111 offset:1024
  ds_read_b64_tr_b16 a[200:201], v110 offset:2048
  ds_read_b64_tr_b16 a[202:203], v111 offset:2048
  ds_read_b64_tr_b16 a[204:205], v110 offset:3072
  ds_read_b64_tr_b16 a[206:207], v111 offset:3072
  s_waitcnt lgkmcnt(0)
  ds_read_b64_tr_b16 a[208:209], v110 offset:4096
  ds_read_b64_tr_b16 a[210:211], v111 offset:4096
  ds_read_b64_tr_b16 a[212:213], v110 offset:5120
  ds_read_b64_tr_b16 a[214:215], v111 offset:5120
  ds_read_b64_tr_b16 a[216:217], v110 offset:6144
  ds_read_b64_tr_b16 a[218:219], v111 offset:6144
  ds_read_b64_tr_b16 a[220:221], v110 offset:7168
  ds_read_b64_tr_b16 a[222:223], v111 offset:7168
  s_waitcnt lgkmcnt(0)
  s_waitcnt vmcnt(16)
  ds_write_b128 v109, a[224:227] offset:0
  ds_write_b128 v109, a[228:231] offset:1024
  ds_write_b128 v109, a[232:235] offset:2048
  ds_write_b128 v109, a[236:239] offset:3072
  ds_write_b128 v109, a[240:243] offset:4096
  ds_write_b128 v109, a[244:247] offset:5120
  ds_write_b128 v109, a[248:251] offset:6144
  ds_write_b128 v109, a[252:255] offset:7168
  s_waitcnt lgkmcnt(0)
  ds_read_b64_tr_b16 a[224:225], v110 offset:0
  ds_read_b64_tr_b16 a[226:227], v111 offset:0
  ds_read_b64_tr_b16 a[228:229], v110 offset:1024
  ds_read_b64_tr_b16 a[230:231], v111 offset:1024
  ds_read_b64_tr_b16 a[232:233], v110 offset:2048
  ds_read_b64_tr_b16 a[234:235], v111 offset:2048
  ds_read_b64_tr_b16 a[236:237], v110 offset:3072
  ds_read_b64_tr_b16 a[238:239], v111 offset:3072
  s_waitcnt lgkmcnt(0)
  ds_read_b64_tr_b16 a[240:241], v110 offset:4096
  ds_read_b64_tr_b16 a[242:243], v111 offset:4096
  ds_read_b64_tr_b16 a[244:245], v110 offset:5120
  ds_read_b64_tr_b16 a[246:247], v111 offset:5120
  ds_read_b64_tr_b16 a[248:249], v110 offset:6144
  ds_read_b64_tr_b16 a[250:251], v111 offset:6144
  ds_read_b64_tr_b16 a[252:253], v110 offset:7168
  ds_read_b64_tr_b16 a[254:255], v111 offset:7168
  s_waitcnt lgkmcnt(0)
  s_waitcnt vmcnt(8)
  ds_write_b128 v107, a[128:131] offset:0
  ds_write_b128 v107, a[132:135] offset:1024
  ds_write_b128 v107, a[136:139] offset:2048
  ds_write_b128 v107, a[140:143] offset:3072
  ds_write_b128 v107, a[144:147] offset:4096
  ds_write_b128 v107, a[148:151] offset:5120
  ds_write_b128 v107, a[152:155] offset:6144
  ds_write_b128 v107, a[156:159] offset:7168
  s_waitcnt lgkmcnt(0)
  ds_read_b64_tr_b16 a[128:129], v108 offset:0
  ds_read_b64_tr_b16 a[130:131], v108 offset:2048
  ds_read_b64_tr_b16 a[132:133], v108 offset:4096
  ds_read_b64_tr_b16 a[134:135], v108 offset:6144
  v_xor_b32 v15, 32, v108
  ds_read_b64_tr_b16 a[136:137], v15 offset:0
  ds_read_b64_tr_b16 a[138:139], v15 offset:2048
  ds_read_b64_tr_b16 a[140:141], v15 offset:4096
  ds_read_b64_tr_b16 a[142:143], v15 offset:6144
  s_waitcnt lgkmcnt(0)
  v_xor_b32 v15, 64, v108
  ds_read_b64_tr_b16 a[144:145], v15 offset:0
  ds_read_b64_tr_b16 a[146:147], v15 offset:2048
  ds_read_b64_tr_b16 a[148:149], v15 offset:4096
  ds_read_b64_tr_b16 a[150:151], v15 offset:6144
  v_xor_b32 v15, 96, v108
  ds_read_b64_tr_b16 a[152:153], v15 offset:0
  ds_read_b64_tr_b16 a[154:155], v15 offset:2048
  ds_read_b64_tr_b16 a[156:157], v15 offset:4096
  ds_read_b64_tr_b16 a[158:159], v15 offset:6144
  s_waitcnt lgkmcnt(0)
  s_waitcnt vmcnt(0)
  ds_write_b128 v107, a[160:163] offset:0
  ds_write_b128 v107, a[164:167] offset:1024
  ds_write_b128 v107, a[168:171] offset:2048
  ds_write_b128 v107, a[172:175] offset:3072
  ds_write_b128 v107, a[176:179] offset:4096
  ds_write_b128 v107, a[180:183] offset:5120
  ds_write_b128 v107, a[184:187] offset:6144
  ds_write_b128 v107, a[188:191] offset:7168
  s_waitcnt lgkmcnt(0)
  ds_read_b64_tr_b16 a[160:161], v108 offset:0
  ds_read_b64_tr_b16 a[162:163], v108 offset:2048
  ds_read_b64_tr_b16 a[164:165], v108 offset:4096
  ds_read_b64_tr_b16 a[166:167], v108 offset:6144
  v_xor_b32 v15, 32, v108
  ds_read_b64_tr_b16 a[168:169], v15 offset:0
  ds_read_b64_tr_b16 a[170:171], v15 offset:2048
  ds_read_b64_tr_b16 a[172:173], v15 offset:4096
  ds_read_b64_tr_b16 a[174:175], v15 offset:6144
  s_waitcnt lgkmcnt(0)
  v_xor_b32 v15, 64, v108
  ds_read_b64_tr_b16 a[176:177], v15 offset:0
  ds_read_b64_tr_b16 a[178:179], v15 offset:2048
  ds_read_b64_tr_b16 a[180:181], v15 offset:4096
  ds_read_b64_tr_b16 a[182:183], v15 offset:6144
  v_xor_b32 v15, 96, v108
  ds_read_b64_tr_b16 a[184:185], v15 offset:0
  ds_read_b64_tr_b16 a[186:187], v15 offset:2048
  ds_read_b64_tr_b16 a[188:189], v15 offset:4096
  ds_read_b64_tr_b16 a[190:191], v15 offset:6144
  s_waitcnt lgkmcnt(0)
  s_mov_b32 s8, s42
  s_and_b32 s9, s43, 0xffff
  s_mov_b32 s10, 0xe00
  s_mov_b32 s11, 0x20000
  v_lshrrev_b32 v15, 4, v0
  v_and_b32 v15, 3, v15
  v_lshlrev_b32 v15, 3, v15
  s_lshl_b32 s72, s52, 7
  v_add_u32 v15, s72, v15
  s_lshl_b32 s72, s54, 5
  v_add_u32 v15, s72, v15
  buffer_load_dwordx2 v[12:13], v15, s[8:11], 0 offen
  s_waitcnt vmcnt(0)
  v_lshlrev_b32 v20, 16, v12
  v_and_b32 v21, 0xffff0000, v12
  v_lshlrev_b32 v22, 16, v13
  v_and_b32 v23, 0xffff0000, v13
L_tl_nofw_f:
  s_mov_b32 s8, s34
  s_and_b32 s9, s35, 0xffff
  s_mov_b32 s10, 0x400000
  s_mov_b32 s11, 0x20000
  s_mov_b32 s74, 0x0
  buffer_load_dwordx4 a[0:3], v112, s[8:11], s74 offen
  s_mov_b32 s74, 0x2000
  buffer_load_dwordx4 a[4:7], v112, s[8:11], s74 offen
  s_mov_b32 s74, 0x4000
  buffer_load_dwordx4 a[8:11], v112, s[8:11], s74 offen
  s_mov_b32 s74, 0x6000
  buffer_load_dwordx4 a[12:15], v112, s[8:11], s74 offen
  s_mov_b32 s74, 0x8000
  buffer_load_dwordx4 a[16:19], v112, s[8:11], s74 offen
  s_mov_b32 s74, 0xa000
  buffer_load_dwordx4 a[20:23], v112, s[8:11], s74 offen
  s_mov_b32 s74, 0xc000
  buffer_load_dwordx4 a[24:27], v112, s[8:11], s74 offen
  s_mov_b32 s74, 0xe000
  buffer_load_dwordx4 a[28:31], v112, s[8:11], s74 offen
  s_mov_b32 s12, s34
  s_and_b32 s13, s35, 0xffff
  s_mov_b32 s14, 0x400000
  s_mov_b32 s15, 0x20000
  s_mov_b32 s74, 0x80
  buffer_load_dwordx4 a[32:35], v112, s[12:15], s74 offen
  s_mov_b32 s74, 0x2080
  buffer_load_dwordx4 a[36:39], v112, s[12:15], s74 offen
  s_mov_b32 s74, 0x4080
  buffer_load_dwordx4 a[40:43], v112, s[12:15], s74 offen
  s_mov_b32 s74, 0x6080
  buffer_load_dwordx4 a[44:47], v112, s[12:15], s74 offen
  s_mov_b32 s74, 0x8080
  buffer_load_dwordx4 a[48:51], v112, s[12:15], s74 offen
  s_mov_b32 s74, 0xa080
  buffer_load_dwordx4 a[52:55], v112, s[12:15], s74 offen
  s_mov_b32 s74, 0xc080
  buffer_load_dwordx4 a[56:59], v112, s[12:15], s74 offen
  s_mov_b32 s74, 0xe080
  buffer_load_dwordx4 a[60:63], v112, s[12:15], s74 offen
  s_mov_b32 s8, s34
  s_and_b32 s9, s35, 0xffff
  s_mov_b32 s10, 0x400000
  s_mov_b32 s11, 0x20000
  s_mov_b32 s74, 0x10000
  buffer_load_dwordx4 a[64:67], v112, s[8:11], s74 offen
  s_mov_b32 s74, 0x12000
  buffer_load_dwordx4 a[68:71], v112, s[8:11], s74 offen
  s_mov_b32 s74, 0x14000
  buffer_load_dwordx4 a[72:75], v112, s[8:11], s74 offen
  s_mov_b32 s74, 0x16000
  buffer_load_dwordx4 a[76:79], v112, s[8:11], s74 offen
  s_mov_b32 s74, 0x18000
  buffer_load_dwordx4 a[80:83], v112, s[8:11], s74 offen
  s_mov_b32 s74, 0x1a000
  buffer_load_dwordx4 a[84:87], v112, s[8:11], s74 offen
  s_mov_b32 s74, 0x1c000
  buffer_load_dwordx4 a[88:91], v112, s[8:11], s74 offen
  s_mov_b32 s74, 0x1e000
  buffer_load_dwordx4 a[92:95], v112, s[8:11], s74 offen
  s_mov_b32 s12, s34
  s_and_b32 s13, s35, 0xffff
  s_mov_b32 s14, 0x400000
  s_mov_b32 s15, 0x20000
  s_mov_b32 s74, 0x10080
  buffer_load_dwordx4 a[96:99], v112, s[12:15], s74 offen
  s_mov_b32 s74, 0x12080
  buffer_load_dwordx4 a[100:103], v112, s[12:15], s74 offen
  s_mov_b32 s74, 0x14080
  buffer_load_dwordx4 a[104:107], v112, s[12:15], s74 offen
  s_mov_b32 s74, 0x16080
  buffer_load_dwordx4 a[108:111], v112, s[12:15], s74 offen
  s_mov_b32 s74, 0x18080
  buffer_load_dwordx4 a[112:115], v112, s[12:15], s74 offen
  s_mov_b32 s74, 0x1a080
  buffer_load_dwordx4 a[116:119], v112, s[12:15], s74 offen
  s_mov_b32 s74, 0x1c080
  buffer_load_dwordx4 a[120:123], v112, s[12:15], s74 offen
  s_mov_b32 s74, 0x1e080
  buffer_load_dwordx4 a[124:127], v112, s[12:15], s74 offen
  s_waitcnt vmcnt(24)
  ds_write_b128 v107, a[0:3] offset:0
  ds_write_b128 v107, a[4:7] offset:1024
  ds_write_b128 v107, a[8:11] offset:2048
  ds_write_b128 v107, a[12:15] offset:3072
  ds_write_b128 v107, a[16:19] offset:4096
  ds_write_b128 v107, a[20:23] offset:5120
  ds_write_b128 v107, a[24:27] offset:6144
  ds_write_b128 v107, a[28:31] offset:7168
  s_waitcnt lgkmcnt(0)
  ds_read_b64_tr_b16 a[0:1], v108 offset:0
  ds_read_b64_tr_b16 a[2:3], v108 offset:2048
  ds_read_b64_tr_b16 a[4:5], v108 offset:4096
  ds_read_b64_tr_b16 a[6:7], v108 offset:6144
  v_xor_b32 v15, 32, v108
  ds_read_b64_tr_b16 a[8:9], v15 offset:0
  ds_read_b64_tr_b16 a[10:11], v15 offset:2048
  ds_read_b64_tr_b16 a[12:13], v15 offset:4096
  ds_read_b64_tr_b16 a[14:15], v15 offset:6144
  s_waitcnt lgkmcnt(0)
  v_xor_b32 v15, 64, v108
  ds_read_b64_tr_b16 a[16:17], v15 offset:0
  ds_read_b64_tr_b16 a[18:19], v15 offset:2048
  ds_read_b64_tr_b16 a[20:21], v15 offset:4096
  ds_read_b64_tr_b16 a[22:23], v15 offset:6144
  v_xor_b32 v15, 96, v108
  ds_read_b64_tr_b16 a[24:25], v15 offset:0
  ds_read_b64_tr_b16 a[26:27], v15 offset:2048
  ds_read_b64_tr_b16 a[28:29], v15 offset:4096
  ds_read_b64_tr_b16 a[30:31], v15 offset:6144
  s_waitcnt lgkmcnt(0)
  s_waitcnt vmcnt(16)
  ds_write_b128 v107, a[32:35] offset:0
  ds_write_b128 v107, a[36:39] offset:1024
  ds_write_b128 v107, a[40:43] offset:2048
  ds_write_b128 v107, a[44:47] offset:3072
  ds_write_b128 v107, a[48:51] offset:4096
  ds_write_b128 v107, a[52:55] offset:5120
  ds_write_b128 v107, a[56:59] offset:6144
  ds_write_b128 v107, a[60:63] offset:7168
  s_waitcnt lgkmcnt(0)
  ds_read_b64_tr_b16 a[32:33], v108 offset:0
  ds_read_b64_tr_b16 a[34:35], v108 offset:2048
  ds_read_b64_tr_b16 a[36:37], v108 offset:4096
  ds_read_b64_tr_b16 a[38:39], v108 offset:6144
  v_xor_b32 v15, 32, v108
  ds_read_b64_tr_b16 a[40:41], v15 offset:0
  ds_read_b64_tr_b16 a[42:43], v15 offset:2048
  ds_read_b64_tr_b16 a[44:45], v15 offset:4096
  ds_read_b64_tr_b16 a[46:47], v15 offset:6144
  s_waitcnt lgkmcnt(0)
  v_xor_b32 v15, 64, v108
  ds_read_b64_tr_b16 a[48:49], v15 offset:0
  ds_read_b64_tr_b16 a[50:51], v15 offset:2048
  ds_read_b64_tr_b16 a[52:53], v15 offset:4096
  ds_read_b64_tr_b16 a[54:55], v15 offset:6144
  v_xor_b32 v15, 96, v108
  ds_read_b64_tr_b16 a[56:57], v15 offset:0
  ds_read_b64_tr_b16 a[58:59], v15 offset:2048
  ds_read_b64_tr_b16 a[60:61], v15 offset:4096
  ds_read_b64_tr_b16 a[62:63], v15 offset:6144
  s_waitcnt lgkmcnt(0)
  s_waitcnt vmcnt(8)
  ds_write_b128 v107, a[64:67] offset:0
  ds_write_b128 v107, a[68:71] offset:1024
  ds_write_b128 v107, a[72:75] offset:2048
  ds_write_b128 v107, a[76:79] offset:3072
  ds_write_b128 v107, a[80:83] offset:4096
  ds_write_b128 v107, a[84:87] offset:5120
  ds_write_b128 v107, a[88:91] offset:6144
  ds_write_b128 v107, a[92:95] offset:7168
  s_waitcnt lgkmcnt(0)
  ds_read_b64_tr_b16 a[64:65], v108 offset:0
  ds_read_b64_tr_b16 a[66:67], v108 offset:2048
  ds_read_b64_tr_b16 a[68:69], v108 offset:4096
  ds_read_b64_tr_b16 a[70:71], v108 offset:6144
  v_xor_b32 v15, 32, v108
  ds_read_b64_tr_b16 a[72:73], v15 offset:0
  ds_read_b64_tr_b16 a[74:75], v15 offset:2048
  ds_read_b64_tr_b16 a[76:77], v15 offset:4096
  ds_read_b64_tr_b16 a[78:79], v15 offset:6144
  s_waitcnt lgkmcnt(0)
  v_xor_b32 v15, 64, v108
  ds_read_b64_tr_b16 a[80:81], v15 offset:0
  ds_read_b64_tr_b16 a[82:83], v15 offset:2048
  ds_read_b64_tr_b16 a[84:85], v15 offset:4096
  ds_read_b64_tr_b16 a[86:87], v15 offset:6144
  v_xor_b32 v15, 96, v108
  ds_read_b64_tr_b16 a[88:89], v15 offset:0
  ds_read_b64_tr_b16 a[90:91], v15 offset:2048
  ds_read_b64_tr_b16 a[92:93], v15 offset:4096
  ds_read_b64_tr_b16 a[94:95], v15 offset:6144
  s_waitcnt lgkmcnt(0)
  s_waitcnt vmcnt(0)
  ds_write_b128 v107, a[96:99] offset:0
  ds_write_b128 v107, a[100:103] offset:1024
  ds_write_b128 v107, a[104:107] offset:2048
  ds_write_b128 v107, a[108:111] offset:3072
  ds_write_b128 v107, a[112:115] offset:4096
  ds_write_b128 v107, a[116:119] offset:5120
  ds_write_b128 v107, a[120:123] offset:6144
  ds_write_b128 v107, a[124:127] offset:7168
  s_waitcnt lgkmcnt(0)
  ds_read_b64_tr_b16 a[96:97], v108 offset:0
  ds_read_b64_tr_b16 a[98:99], v108 offset:2048
  ds_read_b64_tr_b16 a[100:101], v108 offset:4096
  ds_read_b64_tr_b16 a[102:103], v108 offset:6144
  v_xor_b32 v15, 32, v108
  ds_read_b64_tr_b16 a[104:105], v15 offset:0
  ds_read_b64_tr_b16 a[106:107], v15 offset:2048
  ds_read_b64_tr_b16 a[108:109], v15 offset:4096
  ds_read_b64_tr_b16 a[110:111], v15 offset:6144
  s_waitcnt lgkmcnt(0)
  v_xor_b32 v15, 64, v108
  ds_read_b64_tr_b16 a[112:113], v15 offset:0
  ds_read_b64_tr_b16 a[114:115], v15 offset:2048
  ds_read_b64_tr_b16 a[116:117], v15 offset:4096
  ds_read_b64_tr_b16 a[118:119], v15 offset:6144
  v_xor_b32 v15, 96, v108
  ds_read_b64_tr_b16 a[120:121], v15 offset:0
  ds_read_b64_tr_b16 a[122:123], v15 offset:2048
  ds_read_b64_tr_b16 a[124:125], v15 offset:4096
  ds_read_b64_tr_b16 a[126:127], v15 offset:6144
  s_waitcnt lgkmcnt(0)
  v_mov_b32 v2, v1
  s_lshr_b32 s72, s54, 1
  s_lshl_b32 s72, s72, 10
  s_and_b32 s73, s54, 1
  s_lshl_b32 s73, s73, 3
  s_add_u32 s72, s72, s73
  s_add_u32 s72, s72, 0x8000
  v_add_u32 v3, s72, v1
  v_add_u32 v4, 0x8000, v1
  s_and_b32 s72, s54, 1
  s_lshl_b32 s72, s72, 12
  s_lshr_b32 s73, s54, 1
  s_lshl_b32 s73, s73, 11
  s_add_u32 s72, s72, s73
  s_add_u32 s72, s72, 0x9000
  v_add_u32 v5, s72, v1
  s_lshl_b32 s72, s54, 17
  s_lshl_b32 s73, s52, 10
  s_add_u32 s72, s72, s73
  v_add_u32 v6, s72, v1
  v_lshrrev_b32 v7, 4, v0
  v_and_b32 v7, 3, v7
  v_lshlrev_b32 v7, 10, v7
  v_and_b32 v127, 15, v0
  v_lshlrev_b32 v127, 4, v127
  v_add_u32 v7, v7, v127
  s_lshl_b32 s72, s54, 8
  s_lshl_b32 s73, s52, 15
  s_add_u32 s72, s72, s73
  v_add_u32 v7, s72, v7
  v_and_b32 v8, 15, v0
  v_lshlrev_b32 v8, 10, v8
  v_lshrrev_b32 v127, 4, v0
  v_and_b32 v127, 1, v127
  v_lshlrev_b32 v127, 5, v127
  v_add_u32 v8, v8, v127
  s_lshr_b32 s72, s52, 4
  s_lshl_b32 s72, s72, 14
  s_and_b32 s73, s52, 15
  s_lshl_b32 s73, s73, 6
  s_add_u32 s72, s72, s73
  s_lshl_b32 s73, s54, 3
  s_add_u32 s72, s72, s73
  v_add_u32 v8, s72, v8
  v_and_b32 v15, 1, v0
  v_lshlrev_b32 v15, 4, v15
  v_mov_b32 v12, 0x3f80
  v_lshlrev_b32 v12, v15, v12
  v_lshrrev_b32 v15, 1, v0
  v_and_b32 v15, 7, v15
  v_cmp_eq_u32 vcc, 0, v15
  s_nop 1
  v_cndmask_b32 v16, 0, v12, vcc
  v_cmp_eq_u32 vcc, 1, v15
  s_nop 1
  v_cndmask_b32 v17, 0, v12, vcc
  v_cmp_eq_u32 vcc, 2, v15
  s_nop 1
  v_cndmask_b32 v18, 0, v12, vcc
  v_cmp_eq_u32 vcc, 3, v15
  s_nop 1
  v_cndmask_b32 v19, 0, v12, vcc
  v_and_b32 v12, 15, v0
  s_and_b32 s72, s54, 1
  s_lshl_b32 s72, s72, 4
  v_add_u32 v12, s72, v12
  v_lshrrev_b32 v13, 4, v0
  v_and_b32 v13, 3, v13
  v_lshlrev_b32 v13, 2, v13
  v_add_u32 v14, 0, v13
  v_cmp_le_u32 s[80:81], v14, v12
  v_add_u32 v14, 1, v13
  v_cmp_le_u32 s[82:83], v14, v12
  v_add_u32 v14, 2, v13
  v_cmp_le_u32 s[84:85], v14, v12
  v_add_u32 v14, 3, v13
  v_cmp_le_u32 s[86:87], v14, v12
  v_add_u32 v14, 16, v13
  v_cmp_le_u32 s[88:89], v14, v12
  v_add_u32 v14, 17, v13
  v_cmp_le_u32 s[90:91], v14, v12
  v_add_u32 v14, 18, v13
  v_cmp_le_u32 s[92:93], v14, v12
  v_add_u32 v14, 19, v13
  v_cmp_le_u32 s[94:95], v14, v12
  s_sub_u32 s56, s53, 3
  s_lshl_b32 s59, s56, 21
  s_add_u32 s59, s59, 0x4300000
  s_add_u32 s60, s59, 0x100000
  s_lshl_b32 s58, s53, 7
  s_add_u32 s58, s58, 0x42d7400
  s_mov_b32 s57, 0
  s_mov_b32 s64, 0x3e0293ee
  s_mov_b32 s67, 0xbfb8aa3b
  s_waitcnt vmcnt(0) lgkmcnt(0)
  s_barrier
  v_lshlrev_b32 v127, 3, v0
  s_mov_b32 s73, 0x42d0000
L_tl_x0_f:
  buffer_load_dwordx2 v[12:13], v127, s[4:7], s73 offen sc1
  s_waitcnt vmcnt(0)
  v_min_u32 v12, v12, v13
  v_cmp_eq_u32 vcc, 0, v12
  s_nop 0
  s_cbranch_vccz L_tl_x0_f_ok
  s_sub_u32 s70, s70, 16
  s_cselect_b32 s70, 0, s70
  s_cbranch_scc1 L_tl_x0_f_ok
  s_sleep 8
  s_branch L_tl_x0_f
L_tl_x0_f_ok:
  s_lshl_b32 s73, s56, 15
  s_lshl_b32 s74, s54, 13
  s_add_u32 s73, s73, s74
  s_add_u32 m0, s74, 0
  s_add_u32 s72, s73, 0
  buffer_load_dwordx4 v1, s[4:7], s72 offen sc1 lds
  s_add_u32 m0, s74, 1024
  s_add_u32 s72, s73, 1024
  buffer_load_dwordx4 v1, s[4:7], s72 offen sc1 lds
  s_add_u32 m0, s74, 2048
  s_add_u32 s72, s73, 2048
  buffer_load_dwordx4 v1, s[4:7], s72 offen sc1 lds
  s_add_u32 m0, s74, 3072
  s_add_u32 s72, s73, 3072
  buffer_load_dwordx4 v1, s[4:7], s72 offen sc1 lds
  s_add_u32 m0, s74, 4096
  s_add_u32 s72, s73, 4096
  buffer_load_dwordx4 v1, s[4:7], s72 offen sc1 lds
  s_add_u32 m0, s74, 5120
  s_add_u32 s72, s73, 5120
  buffer_load_dwordx4 v1, s[4:7], s72 offen sc1 lds
  s_add_u32 m0, s74, 6144
  s_add_u32 s72, s73, 6144
  buffer_load_dwordx4 v1, s[4:7], s72 offen sc1 lds
  s_add_u32 m0, s74, 7168
  s_add_u32 s72, s73, 7168
  buffer_load_dwordx4 v1, s[4:7], s72 offen sc1 lds
L_tl_loop_f:
  s_waitcnt vmcnt(0)
  s_barrier
  s_cmp_lt_u32 s52, 28
  s_cbranch_scc0 L_tl_noffn_f
  ds_read_b128 v[32:35], v2 offset:0
  ds_read_b128 v[36:39], v2 offset:16384
  ds_read_b128 v[40:43], v2 offset:1024
  ds_read_b128 v[44:47], v2 offset:17408
  s_waitcnt lgkmcnt(3)
  v_mfma_f32_16x16x32_bf16 v[48:51], a[192:195], v[32:35], 0
  ds_read_b128 v[32:35], v2 offset:2048
  s_waitcnt lgkmcnt(3)
  v_mfma_f32_16x16x32_bf16 v[52:55], a[192:195], v[36:39], 0
  ds_read_b128 v[36:39], v2 offset:18432
  s_waitcnt lgkmcnt(3)
  v_mfma_f32_16x16x32_bf16 v[48:51], a[196:199], v[40:43], v[48:51]
  ds_read_b128 v[40:43], v2 offset:3072
  s_waitcnt lgkmcnt(3)
  v_mfma_f32_16x16x32_bf16 v[52:55], a[196:199], v[44:47], v[52:55]
  ds_read_b128 v[44:47], v2 offset:19456
  s_waitcnt lgkmcnt(3)
  v_mfma_f32_16x16x32_bf16 v[48:51], a[200:203], v[32:35], v[48:51]
  ds_read_b128 v[32:35], v2 offset:4096
  s_waitcnt lgkmcnt(3)
  v_mfma_f32_16x16x32_bf16 v[52:55], a[200:203], v[36:39], v[52:55]
  ds_read_b128 v[36:39], v2 offset:20480
  s_waitcnt lgkmcnt(3)
  v_mfma_f32_16x16x32_bf16 v[48:51], a[204:207], v[40:43], v[48:51]
  ds_read_b128 v[40:43], v2 offset:5120
  s_waitcnt lgkmcnt(3)
  v_mfma_f32_16x16x32_bf16 v[52:55], a[204:207], v[44:47], v[52:55]
  ds_read_b128 v[44:47], v2 offset:21504
  s_waitcnt lgkmcnt(3)
  v_mfma_f32_16x16x32_bf16 v[48:51], a[208:211], v[32:35], v[48:51]
  ds_read_b128 v[32:35], v2 offset:6144
  s_waitcnt lgkmcnt(3)
  v_mfma_f32_16x16x32_bf16 v[52:55], a[208:211], v[36:39], v[52:55]
  ds_read_b128 v[36:39], v2 offset:22528
  s_waitcnt lgkmcnt(3)
  v_mfma_f32_16x16x32_bf16 v[48:51], a[212:215], v[40:43], v[48:51]
  ds_read_b128 v[40:43], v2 offset:7168
  s_waitcnt lgkmcnt(3)
  v_mfma_f32_16x16x32_bf16 v[52:55], a[212:215], v[44:47], v[52:55]
  ds_read_b128 v[44:47], v2 offset:23552
  s_waitcnt lgkmcnt(3)
  v_mfma_f32_16x16x32_bf16 v[48:51], a[216:219], v[32:35], v[48:51]
  ds_read_b128 v[32:35], v2 offset:8192
  s_waitcnt lgkmcnt(3)
  v_mfma_f32_16x16x32_bf16 v[52:55], a[216:219], v[36:39], v[52:55]
  ds_read_b128 v[36:39], v2 offset:24576
  s_waitcnt lgkmcnt(3)
  v_mfma_f32_16x16x32_bf16 v[48:51], a[220:223], v[40:43], v[48:51]
  ds_read_b128 v[40:43], v2 offset:9216
  s_waitcnt lgkmcnt(3)
  v_mfma_f32_16x16x32_bf16 v[52:55], a[220:223], v[44:47], v[52:55]
  ds_read_b128 v[44:47], v2 offset:25600
  s_waitcnt lgkmcnt(3)
  v_mfma_f32_16x16x32_bf16 v[48:51], a[224:227], v[32:35], v[48:51]
  ds_read_b128 v[32:35], v2 offset:10240
  s_waitcnt lgkmcnt(3)
  v_mfma_f32_16x16x32_bf16 v[52:55], a[224:227], v[36:39], v[52:55]
  ds_read_b128 v[36:39], v2 offset:26624
  s_waitcnt lgkmcnt(3)
  v_mfma_f32_16x16x32_bf16 v[48:51], a[228:231], v[40:43], v[48:51]
  ds_read_b128 v[40:43], v2 offset:11264
  s_waitcnt lgkmcnt(3)
  v_mfma_f32_16x16x32_bf16 v[52:55], a[228:231], v[44:47], v[52:55]
  ds_read_b128 v[44:47], v2 offset:27648
  s_waitcnt lgkmcnt(3)
  v_mfma_f32_16x16x32_bf16 v[48:51], a[232:235], v[32:35], v[48:51]
  ds_read_b128 v[32:35], v2 offset:12288
  s_waitcnt lgkmcnt(3)
  v_mfma_f32_16x16x32_bf16 v[52:55], a[232:235], v[36:39], v[52:55]
  ds_read_b128 v[36:39], v2 offset:28672
  s_waitcnt lgkmcnt(3)
  v_mfma_f32_16x16x32_bf16 v[48:51], a[236:239], v[40:43], v[48:51]
  ds_read_b128 v[40:43], v2 offset:13312
  s_waitcnt lgkmcnt(3)
  v_mfma_f32_16x16x32_bf16 v[52:55], a[236:239], v[44:47], v[52:55]
  ds_read_b128 v[44:47], v2 offset:29696
  s_waitcnt lgkmcnt(3)
  v_mfma_f32_16x16x32_bf16 v[48:51], a[240:243], v[32:35], v[48:51]
  ds_read_b128 v[32:35], v2 offset:14336
  s_waitcnt lgkmcnt(3)
  v_mfma_f32_16x16x32_bf16 v[52:55], a[240:243], v[36:39], v[52:55]
  ds_read_b128 v[36:39], v2 offset:30720
  s_waitcnt lgkmcnt(3)
  v_mfma_f32_16x16x32_bf16 v[48:51], a[244:247], v[40:43], v[48:51]
  ds_read_b128 v[40:43], v2 offset:15360
  s_waitcnt lgkmcnt(3)
  v_mfma_f32_16x16x32_bf16 v[52:55], a[244:247], v[44:47], v[52:55]
  ds_read_b128 v[44:47], v2 offset:31744
  s_waitcnt lgkmcnt(3)
  v_mfma_f32_16x16x32_bf16 v[48:51], a[248:251], v[32:35], v[48:51]
  s_waitcnt lgkmcnt(2)
  v_mfma_f32_16x16x32_bf16 v[52:55], a[248:251], v[36:39], v[52:55]
  s_waitcnt lgkmcnt(1)
  v_mfma_f32_16x16x32_bf16 v[48:51], a[252:255], v[40:43], v[48:51]
  s_waitcnt lgkmcnt(0)
  v_mfma_f32_16x16x32_bf16 v[52:55], a[252:255], v[44:47], v[52:55]
  s_nop 5
  v_cvt_pk_bf16_f32 v88, v48, v48
  v_lshlrev_b32 v48, 16, v88
  v_cvt_pk_bf16_f32 v89, v49, v49
  v_lshlrev_b32 v49, 16, v89
  v_cvt_pk_bf16_f32 v90, v50, v50
  v_lshlrev_b32 v50, 16, v90
  v_cvt_pk_bf16_f32 v91, v51, v51
  v_lshlrev_b32 v51, 16, v91
  v_cvt_pk_bf16_f32 v92, v52, v52
  v_lshlrev_b32 v52, 16, v92
  v_cvt_pk_bf16_f32 v93, v53, v53
  v_lshlrev_b32 v53, 16, v93
  v_cvt_pk_bf16_f32 v94, v54, v54
  v_lshlrev_b32 v54, 16, v94
  v_cvt_pk_bf16_f32 v95, v55, v55
  v_lshlrev_b32 v55, 16, v95
  v_add_f32 v48, v48, v20
  v_add_f32 v49, v49, v21
  v_add_f32 v50, v50, v22
  v_add_f32 v51, v51, v23
  v_add_f32 v52, v52, v20
  v_add_f32 v53, v53, v21
  v_add_f32 v54, v54, v22
  v_add_f32 v55, v55, v23
  v_cvt_pk_bf16_f32 v88, v48, v48
  v_lshlrev_b32 v48, 16, v88
  v_cvt_pk_bf16_f32 v89, v49, v49
  v_lshlrev_b32 v49, 16, v89
  v_cvt_pk_bf16_f32 v90, v50, v50
  v_lshlrev_b32 v50, 16, v90
  v_cvt_pk_bf16_f32 v91, v51, v51
  v_lshlrev_b32 v51, 16, v91
  v_cvt_pk_bf16_f32 v92, v52, v52
  v_lshlrev_b32 v52, 16, v92
  v_cvt_pk_bf16_f32 v93, v53, v53
  v_lshlrev_b32 v53, 16, v93
  v_cvt_pk_bf16_f32 v94, v54, v54
  v_lshlrev_b32 v54, 16, v94
  v_cvt_pk_bf16_f32 v95, v55, v55
  v_lshlrev_b32 v55, 16, v95
  v_mul_f32_e64 v88, |v48|, s67
  v_mul_f32_e64 v89, |v49|, s67
  v_mul_f32_e64 v90, |v50|, s67
  v_mul_f32_e64 v91, |v51|, s67
  v_mul_f32_e64 v92, |v52|, s67
  v_mul_f32_e64 v93, |v53|, s67
  v_mul_f32_e64 v94, |v54|, s67
  v_mul_f32_e64 v95, |v55|, s67
  v_exp_f32 v88, v88
  v_exp_f32 v89, v89
  v_exp_f32 v90, v90
  v_exp_f32 v91, v91
  v_exp_f32 v92, v92
  v_exp_f32 v93, v93
  v_exp_f32 v94, v94
  v_exp_f32 v95, v95
  v_mul_f32 v96, v88, v88
  v_fma_f32 v104, v88, 2.0, 1.0
  v_fma_f32 v88, v88, 2.0, v96
  v_cmp_lt_f32 vcc, 0, v48
  s_nop 1
  v_cndmask_b32 v80, v88, v104, vcc
  v_fma_f32 v104, v96, 2.0, v104
  v_add_f32 v88, 2.0, v88
  v_cndmask_b32 v88, v88, v104, vcc
  v_mul_f32 v97, v89, v89
  v_fma_f32 v105, v89, 2.0, 1.0
  v_fma_f32 v89, v89, 2.0, v97
  v_cmp_lt_f32 vcc, 0, v49
  s_nop 1
  v_cndmask_b32 v81, v89, v105, vcc
  v_fma_f32 v105, v97, 2.0, v105
  v_add_f32 v89, 2.0, v89
  v_cndmask_b32 v89, v89, v105, vcc
  v_mul_f32 v98, v90, v90
  v_fma_f32 v106, v90, 2.0, 1.0
  v_fma_f32 v90, v90, 2.0, v98
  v_cmp_lt_f32 vcc, 0, v50
  s_nop 1
  v_cndmask_b32 v82, v90, v106, vcc
  v_fma_f32 v106, v98, 2.0, v106
  v_add_f32 v90, 2.0, v90
  v_cndmask_b32 v90, v90, v106, vcc
  v_mul_f32 v99, v91, v91
  v_fma_f32 v107, v91, 2.0, 1.0
  v_fma_f32 v91, v91, 2.0, v99
  v_cmp_lt_f32 vcc, 0, v51
  s_nop 1
  v_cndmask_b32 v83, v91, v107, vcc
  v_fma_f32 v107, v99, 2.0, v107
  v_add_f32 v91, 2.0, v91
  v_cndmask_b32 v91, v91, v107, vcc
  v_mul_f32 v100, v92, v92
  v_fma_f32 v108, v92, 2.0, 1.0
  v_fma_f32 v92, v92, 2.0, v100
  v_cmp_lt_f32 vcc, 0, v52
  s_nop 1
  v_cndmask_b32 v84, v92, v108, vcc
  v_fma_f32 v108, v100, 2.0, v108
  v_add_f32 v92, 2.0, v92
  v_cndmask_b32 v92, v92, v108, vcc
  v_mul_f32 v101, v93, v93
  v_fma_f32 v109, v93, 2.0, 1.0
  v_fma_f32 v93, v93, 2.0, v101
  v_cmp_lt_f32 vcc, 0, v53
  s_nop 1
  v_cndmask_b32 v85, v93, v109, vcc
  v_fma_f32 v109, v101, 2.0, v109
  v_add_f32 v93, 2.0, v93
  v_cndmask_b32 v93, v93, v109, vcc
  v_mul_f32 v102, v94, v94
  v_fma_f32 v110, v94, 2.0, 1.0
  v_fma_f32 v94, v94, 2.0, v102
  v_cmp_lt_f32 vcc, 0, v54
  s_nop 1
  v_cndmask_b32 v86, v94, v110, vcc
  v_fma_f32 v110, v102, 2.0, v110
  v_add_f32 v94, 2.0, v94
  v_cndmask_b32 v94, v94, v110, vcc
  v_mul_f32 v103, v95, v95
  v_fma_f32 v111, v95, 2.0, 1.0
  v_fma_f32 v95, v95, 2.0, v103
  v_cmp_lt_f32 vcc, 0, v55
  s_nop 1
  v_cndmask_b32 v87, v95, v111, vcc
  v_fma_f32 v111, v103, 2.0, v111
  v_add_f32 v95, 2.0, v95
  v_cndmask_b32 v95, v95, v111, vcc
  v_rcp_f32 v88, v88
  v_rcp_f32 v89, v89
  v_rcp_f32 v90, v90
  v_rcp_f32 v91, v91
  v_rcp_f32 v92, v92
  v_rcp_f32 v93, v93
  v_rcp_f32 v94, v94
  v_rcp_f32 v95, v95
  v_mul_f32 v80, v80, v88
  v_mul_f32 v81, v81, v89
  v_mul_f32 v82, v82, v90
  v_mul_f32 v83, v83, v91
  v_mul_f32 v84, v84, v92
  v_mul_f32 v85, v85, v93
  v_mul_f32 v86, v86, v94
  v_mul_f32 v87, v87, v95
  v_mul_f32 v80, v80, v48
  v_mul_f32 v81, v81, v49
  v_mul_f32 v82, v82, v50
  v_mul_f32 v83, v83, v51
  v_mul_f32 v84, v84, v52
  v_mul_f32 v85, v85, v53
  v_mul_f32 v86, v86, v54
  v_mul_f32 v87, v87, v55
  v_cvt_pk_bf16_f32 v88, v80, v81
  v_cvt_pk_bf16_f32 v89, v82, v83
  ds_write_b64 v3, v[88:89] offset:0
  v_cvt_pk_bf16_f32 v90, v84, v85
  v_cvt_pk_bf16_f32 v91, v86, v87
  ds_write_b64 v3, v[90:91] offset:2048
  s_waitcnt lgkmcnt(0)
  s_barrier
  ds_read_b128 v[56:59], v4 offset:0
  ds_read_b128 v[60:63], v4 offset:1024
  ds_read_b128 v[64:67], v4 offset:2048
  ds_read_b128 v[68:71], v4 offset:3072
  s_waitcnt lgkmcnt(3)
  v_mfma_f32_16x16x32_bf16 v[128:131], a[128:131], v[56:59], 0
  s_waitcnt lgkmcnt(2)
  v_mfma_f32_16x16x32_bf16 v[128:131], a[132:135], v[60:63], v[128:131]
  s_waitcnt lgkmcnt(1)
  v_mfma_f32_16x16x32_bf16 v[132:135], a[128:131], v[64:67], 0
  s_waitcnt lgkmcnt(0)
  v_mfma_f32_16x16x32_bf16 v[132:135], a[132:135], v[68:71], v[132:135]
  v_mfma_f32_16x16x32_bf16 v[136:139], a[136:139], v[56:59], 0
  v_mfma_f32_16x16x32_bf16 v[136:139], a[140:143], v[60:63], v[136:139]
  v_mfma_f32_16x16x32_bf16 v[140:143], a[136:139], v[64:67], 0
  v_mfma_f32_16x16x32_bf16 v[140:143], a[140:143], v[68:71], v[140:143]
  v_mfma_f32_16x16x32_bf16 v[144:147], a[144:147], v[56:59], 0
  v_mfma_f32_16x16x32_bf16 v[144:147], a[148:151], v[60:63], v[144:147]
  v_mfma_f32_16x16x32_bf16 v[148:151], a[144:147], v[64:67], 0
  v_mfma_f32_16x16x32_bf16 v[148:151], a[148:151], v[68:71], v[148:151]
  v_mfma_f32_16x16x32_bf16 v[152:155], a[152:155], v[56:59], 0
  v_mfma_f32_16x16x32_bf16 v[152:155], a[156:159], v[60:63], v[152:155]
  v_mfma_f32_16x16x32_bf16 v[156:159], a[152:155], v[64:67], 0
  v_mfma_f32_16x16x32_bf16 v[156:159], a[156:159], v[68:71], v[156:159]
  v_mfma_f32_16x16x32_bf16 v[160:163], a[160:163], v[56:59], 0
  v_mfma_f32_16x16x32_bf16 v[160:163], a[164:167], v[60:63], v[160:163]
  v_mfma_f32_16x16x32_bf16 v[164:167], a[160:163], v[64:67], 0
  v_mfma_f32_16x16x32_bf16 v[164:167], a[164:167], v[68:71], v[164:167]
  v_mfma_f32_16x16x32_bf16 v[168:171], a[168:171], v[56:59], 0
  v_mfma_f32_16x16x32_bf16 v[168:171], a[172:175], v[60:63], v[168:171]
  v_mfma_f32_16x16x32_bf16 v[172:175], a[168:171], v[64:67], 0
  v_mfma_f32_16x16x32_bf16 v[172:175], a[172:175], v[68:71], v[172:175]
  v_mfma_f32_16x16x32_bf16 v[176:179], a[176:179], v[56:59], 0
  v_mfma_f32_16x16x32_bf16 v[176:179], a[180:183], v[60:63], v[176:179]
  v_mfma_f32_16x16x32_bf16 v[180:183], a[176:179], v[64:67], 0
  v_mfma_f32_16x16x32_bf16 v[180:183], a[180:183], v[68:71], v[180:183]
  v_mfma_f32_16x16x32_bf16 v[184:187], a[184:187], v[56:59], 0
  v_mfma_f32_16x16x32_bf16 v[184:187], a[188:191], v[60:63], v[184:187]
  v_mfma_f32_16x16x32_bf16 v[188:191], a[184:187], v[64:67], 0
  v_mfma_f32_16x16x32_bf16 v[188:191], a[188:191], v[68:71], v[188:191]
  v_cvt_pk_bf16_f32 v72, v128, v129
  v_cvt_pk_bf16_f32 v73, v130, v131
  v_cvt_pk_bf16_f32 v74, v136, v137
  v_cvt_pk_bf16_f32 v75, v138, v139
  s_add_u32 s72, s59, 0
  buffer_store_dwordx4 v[72:75], v6, s[4:7], s72 offen
  v_cvt_pk_bf16_f32 v76, v144, v145
  v_cvt_pk_bf16_f32 v77, v146, v147
  v_cvt_pk_bf16_f32 v78, v152, v153
  v_cvt_pk_bf16_f32 v79, v154, v155
  s_add_u32 s72, s59, 32768
  buffer_store_dwordx4 v[76:79], v6, s[4:7], s72 offen
  v_cvt_pk_bf16_f32 v72, v160, v161
  v_cvt_pk_bf16_f32 v73, v162, v163
  v_cvt_pk_bf16_f32 v74, v168, v169
  v_cvt_pk_bf16_f32 v75, v170, v171
  s_add_u32 s72, s59, 65536
  buffer_store_dwordx4 v[72:75], v6, s[4:7], s72 offen
  v_cvt_pk_bf16_f32 v76, v176, v177
  v_cvt_pk_bf16_f32 v77, v178, v179
  v_cvt_pk_bf16_f32 v78, v184, v185
  v_cvt_pk_bf16_f32 v79, v186, v187
  s_add_u32 s72, s59, 98304
  buffer_store_dwordx4 v[76:79], v6, s[4:7], s72 offen
  v_cvt_pk_bf16_f32 v72, v132, v133
  v_cvt_pk_bf16_f32 v73, v134, v135
  v_cvt_pk_bf16_f32 v74, v140, v141
  v_cvt_pk_bf16_f32 v75, v142, v143
  s_add_u32 s72, s59, 524288
  buffer_store_dwordx4 v[72:75], v6, s[4:7], s72 offen
  v_cvt_pk_bf16_f32 v76, v148, v149
  v_cvt_pk_bf16_f32 v77, v150, v151
  v_cvt_pk_bf16_f32 v78, v156, v157
  v_cvt_pk_bf16_f32 v79, v158, v159
  s_add_u32 s72, s59, 557056
  buffer_store_dwordx4 v[76:79], v6, s[4:7], s72 offen
  v_cvt_pk_bf16_f32 v72, v164, v165
  v_cvt_pk_bf16_f32 v73, v166, v167
  v_cvt_pk_bf16_f32 v74, v172, v173
  v_cvt_pk_bf16_f32 v75, v174, v175
  s_add_u32 s72, s59, 589824
  buffer_store_dwordx4 v[72:75], v6, s[4:7], s72 offen
  v_cvt_pk_bf16_f32 v76, v180, v181
  v_cvt_pk_bf16_f32 v77, v182, v183
  v_cvt_pk_bf16_f32 v78, v188, v189
  v_cvt_pk_bf16_f32 v79, v190, v191
  s_add_u32 s72, s59, 622592
  buffer_store_dwordx4 v[76:79], v6, s[4:7], s72 offen
  s_branch L_tl_ffn_done_f
L_tl_noffn_f:
  s_barrier
L_tl_ffn_done_f:
  s_lshl_b32 s73, s56, 5
  s_add_u32 s73, s73, s52
  s_lshl_b32 s74, s52, 7
  s_add_u32 s66, s74, 0x42d5000
  s_and_b32 s65, s56, 1
  s_lshl_b32 s65, s65, 2
  s_add_u32 s65, s65, s74
  s_add_u32 s65, s65, 0x42d1000
  s_lshr_b32 s68, s56, 1
  s_add_u32 s68, s68, 1
  s_add_u32 s69, s56, 1
  s_lshl_b32 s62, s73, 13
  s_lshl_b32 s63, s73, 12
  s_waitcnt vmcnt(0)
  s_barrier
  s_add_u32 s57, s57, 1
  s_cmp_eq_u32 s54, 0
  s_cbranch_scc0 L_xb_wg_f
  s_lshl_b32 s72, s52, 2
  s_add_u32 s72, s72, s58
  s_mov_b64 exec, 1
  v_mov_b32 v12, 0
  v_mov_b32 v13, s57
  buffer_store_dword v13, v12, s[4:7], s72 offen
  s_mov_b32 exec_lo, -1
  v_lshlrev_b32 v12, 2, v0
L_xb_pg_f:
  buffer_load_dword v13, v12, s[4:7], s58 offen sc1
  s_waitcnt vmcnt(0)
  v_cmp_gt_u32 vcc, s57, v13
  s_nop 0
  s_cbranch_vccz L_xb_okg_f
  s_sleep 1
  s_sub_u32 s70, s70, 1
  s_cbranch_scc0 L_xb_pg_f
  s_mov_b32 s70, 0
L_xb_okg_f:
  s_mov_b64 exec, -1
L_xb_wg_f:
  s_barrier
  s_add_u32 s72, s59, 0
  buffer_load_dwordx4 v[160:163], v7, s[4:7], s72 offen sc1
  s_add_u32 s72, s59, 4096
  buffer_load_dwordx4 v[164:167], v7, s[4:7], s72 offen sc1
  s_add_u32 s72, s59, 8192
  buffer_load_dwordx4 v[168:171], v7, s[4:7], s72 offen sc1
  s_add_u32 s72, s59, 12288
  buffer_load_dwordx4 v[172:175], v7, s[4:7], s72 offen sc1
  s_add_u32 s72, s59, 16384
  buffer_load_dwordx4 v[176:179], v7, s[4:7], s72 offen sc1
  s_add_u32 s72, s59, 20480
  buffer_load_dwordx4 v[180:183], v7, s[4:7], s72 offen sc1
  s_add_u32 s72, s59, 24576
  buffer_load_dwordx4 v[184:187], v7, s[4:7], s72 offen sc1
  s_waitcnt vmcnt(6)
  v_mfma_f32_16x16x32_bf16 v[192:195], v[16:19], v[160:163], 0
  s_waitcnt vmcnt(5)
  v_mfma_f32_16x16x32_bf16 v[192:195], v[16:19], v[164:167], v[192:195]
  s_waitcnt vmcnt(4)
  v_mfma_f32_16x16x32_bf16 v[192:195], v[16:19], v[168:171], v[192:195]
  s_waitcnt vmcnt(3)
  v_mfma_f32_16x16x32_bf16 v[192:195], v[16:19], v[172:175], v[192:195]
  s_waitcnt vmcnt(2)
  v_mfma_f32_16x16x32_bf16 v[192:195], v[16:19], v[176:179], v[192:195]
  s_waitcnt vmcnt(1)
  v_mfma_f32_16x16x32_bf16 v[192:195], v[16:19], v[180:183], v[192:195]
  s_waitcnt vmcnt(0)
  v_mfma_f32_16x16x32_bf16 v[192:195], v[16:19], v[184:187], v[192:195]
  s_nop 7
  v_cvt_pk_bf16_f32 v24, v192, v192
  v_lshlrev_b32 v24, 16, v24
  v_cvt_pk_bf16_f32 v25, v193, v193
  v_lshlrev_b32 v25, 16, v25
  v_cvt_pk_bf16_f32 v26, v194, v194
  v_lshlrev_b32 v26, 16, v26
  v_cvt_pk_bf16_f32 v27, v195, v195
  v_lshlrev_b32 v27, 16, v27
  v_mul_f32 v192, 0xbfb8aa3b, v24
  v_mul_f32 v193, 0xbfb8aa3b, v25
  v_mul_f32 v194, 0xbfb8aa3b, v26
  v_mul_f32 v195, 0xbfb8aa3b, v27
  v_exp_f32 v192, v192
  v_exp_f32 v193, v193
  v_exp_f32 v194, v194
  v_exp_f32 v195, v195
  v_add_f32 v192, 1.0, v192
  v_add_f32 v193, 1.0, v193
  v_add_f32 v194, 1.0, v194
  v_add_f32 v195, 1.0, v195
  v_rcp_f32 v192, v192
  v_rcp_f32 v193, v193
  v_rcp_f32 v194, v194
  v_rcp_f32 v195, v195
  v_mul_f32 v24, v24, v192
  v_mul_f32 v25, v25, v193
  v_mul_f32 v26, v26, v194
  v_mul_f32 v27, v27, v195
  v_cvt_pk_bf16_f32 v24, v24, v24
  v_lshlrev_b32 v24, 16, v24
  v_cvt_pk_bf16_f32 v25, v25, v25
  v_lshlrev_b32 v25, 16, v25
  v_cvt_pk_bf16_f32 v26, v26, v26
  v_lshlrev_b32 v26, 16, v26
  v_cvt_pk_bf16_f32 v27, v27, v27
  v_lshlrev_b32 v27, 16, v27
  s_cmp_eq_u32 s54, 0
  s_cbranch_scc0 L_tl_kv_f_bar
  s_mov_b64 exec, 1
L_tl_kv_f:
  buffer_load_dword v12, off, s[4:7], s65 sc1
  s_waitcnt vmcnt(0)
  v_readfirstlane_b32 s72, v12
  s_nop 3
  s_cmp_ge_u32 s72, s68
  s_cbranch_scc1 L_tl_kv_f_ok
  s_sub_u32 s70, s70, 16
  s_cselect_b32 s70, 0, s70
  s_cbranch_scc1 L_tl_kv_f_ok
  s_sleep 16
  s_branch L_tl_kv_f
L_tl_kv_f_ok:
  s_mov_b64 exec, -1
L_tl_kv_f_bar:
  s_barrier
  s_and_b32 s73, s54, 1
  s_lshl_b32 s73, s73, 12
  s_add_u32 s73, s73, s62
  s_add_u32 s73, s73, 0x1200000
  buffer_load_dwordx4 v[32:35], v1, s[4:7], s73 offen offset:0 sc1
  buffer_load_dwordx4 v[36:39], v1, s[4:7], s73 offen offset:1024 sc1
  buffer_load_dwordx4 v[40:43], v1, s[4:7], s73 offen offset:2048 sc1
  buffer_load_dwordx4 v[44:47], v1, s[4:7], s73 offen offset:3072 sc1
  s_add_u32 s73, s62, 0x200000
  buffer_load_dwordx4 v[48:51], v1, s[4:7], s73 offen offset:0 sc1
  buffer_load_dwordx4 v[52:55], v1, s[4:7], s73 offen offset:1024 sc1
  buffer_load_dwordx4 v[56:59], v1, s[4:7], s73 offen offset:2048 sc1
  buffer_load_dwordx4 v[60:63], v1, s[4:7], s73 offen offset:3072 sc1
  s_add_u32 s73, s73, 4096
  buffer_load_dwordx4 v[64:67], v1, s[4:7], s73 offen offset:0 sc1
  buffer_load_dwordx4 v[68:71], v1, s[4:7], s73 offen offset:1024 sc1
  buffer_load_dwordx4 v[72:75], v1, s[4:7], s73 offen offset:2048 sc1
  buffer_load_dwordx4 v[76:79], v1, s[4:7], s73 offen offset:3072 sc1
  s_lshr_b32 s73, s54, 1
  s_lshl_b32 s73, s73, 12
  s_add_u32 s73, s73, s62
  s_add_u32 s73, s73, 0x2200000
  buffer_load_dwordx4 v[96:99], v1, s[4:7], s73 offen offset:0 sc1
  buffer_load_dwordx4 v[100:103], v1, s[4:7], s73 offen offset:1024 sc1
  buffer_load_dwordx4 v[104:107], v1, s[4:7], s73 offen offset:2048 sc1
  buffer_load_dwordx4 v[108:111], v1, s[4:7], s73 offen offset:3072 sc1
  s_mov_b32 s8, s24
  s_and_b32 s9, s25, 0xffff
  s_mov_b32 s10, 0x200000
  s_mov_b32 s11, 0x20000
  s_lshl_b32 s61, s56, 15
  buffer_load_dwordx2 v[28:29], v8, s[8:11], s61 offen
  s_waitcnt vmcnt(12)
  v_mfma_f32_16x16x32_bf16 v[124:127], v[48:51], v[32:35], 0
  s_waitcnt vmcnt(11)
  v_mfma_f32_16x16x32_bf16 v[124:127], v[52:55], v[36:39], v[124:127]
  s_waitcnt vmcnt(10)
  v_mfma_f32_16x16x32_bf16 v[124:127], v[56:59], v[40:43], v[124:127]
  s_waitcnt vmcnt(9)
  v_mfma_f32_16x16x32_bf16 v[124:127], v[60:63], v[44:47], v[124:127]
  s_waitcnt vmcnt(8)
  v_mfma_f32_16x16x32_bf16 v[128:131], v[64:67], v[32:35], 0
  s_waitcnt vmcnt(7)
  v_mfma_f32_16x16x32_bf16 v[128:131], v[68:71], v[36:39], v[128:131]
  s_waitcnt vmcnt(6)
  v_mfma_f32_16x16x32_bf16 v[128:131], v[72:75], v[40:43], v[128:131]
  s_waitcnt vmcnt(5)
  v_mfma_f32_16x16x32_bf16 v[128:131], v[76:79], v[44:47], v[128:131]
  v_mov_b32 v14, 0xf149f2ca
  v_cndmask_b32 v124, v14, v124, s[80:81]
  v_cndmask_b32 v125, v14, v125, s[82:83]
  v_cndmask_b32 v126, v14, v126, s[84:85]
  v_cndmask_b32 v127, v14, v127, s[86:87]
  s_nop 2
  v_cndmask_b32 v128, v14, v128, s[88:89]
  v_cndmask_b32 v129, v14, v129, s[90:91]
  v_cndmask_b32 v130, v14, v130, s[92:93]
  v_cndmask_b32 v131, v14, v131, s[94:95]
  v_max3_f32 v30, v124, v125, v126
  v_max3_f32 v30, v30, v127, v128
  v_max3_f32 v30, v30, v129, v130
  v_max_f32 v30, v30, v131
  s_waitcnt vmcnt(0)
  s_cmp_eq_u32 s56, 63
  s_cbranch_scc1 L_tl_lastkm_f
  s_cmp_eq_u32 s54, 0
  s_cbranch_scc0 L_tl_km_f_bar
  s_mov_b64 exec, 1
L_tl_km_f:
  buffer_load_dword v12, off, s[4:7], s66 sc1
  s_waitcnt vmcnt(0)
  v_readfirstlane_b32 s72, v12
  s_nop 3
  s_cmp_ge_u32 s72, s69
  s_cbranch_scc1 L_tl_km_f_ok
  s_sub_u32 s70, s70, 16
  s_cselect_b32 s70, 0, s70
  s_cbranch_scc1 L_tl_km_f_ok
  s_sleep 4
  s_branch L_tl_km_f
L_tl_km_f_ok:
  s_mov_b64 exec, -1
L_tl_km_f_bar:
  s_barrier
  s_add_u32 s73, s63, 0x3200000
  buffer_load_dwordx4 v[80:83], v1, s[4:7], s73 offen offset:0 sc1
  buffer_load_dwordx4 v[84:87], v1, s[4:7], s73 offen offset:1024 sc1
  buffer_load_dwordx4 v[88:91], v1, s[4:7], s73 offen offset:2048 sc1
  buffer_load_dwordx4 v[92:95], v1, s[4:7], s73 offen offset:3072 sc1
  s_lshr_b32 s73, s54, 1
  s_lshl_b32 s73, s73, 11
  s_add_u32 s73, s73, s63
  s_add_u32 s73, s73, 0x3a00000
  buffer_load_dwordx4 v[112:115], v1, s[4:7], s73 offen offset:0 sc1
  buffer_load_dwordx4 v[116:119], v1, s[4:7], s73 offen offset:1024 sc1
  s_waitcnt vmcnt(0)
  s_branch L_tl_kmok_f
L_tl_lastkm_f:
  s_add_u32 s73, s63, 0x3200000
  buffer_load_dwordx4 v[80:83], v1, s[4:7], s73 offen offset:0 sc1
  buffer_load_dwordx4 v[84:87], v1, s[4:7], s73 offen offset:1024 sc1
  buffer_load_dwordx4 v[88:91], v1, s[4:7], s73 offen offset:2048 sc1
  buffer_load_dwordx4 v[92:95], v1, s[4:7], s73 offen offset:3072 sc1
  s_lshr_b32 s73, s54, 1
  s_lshl_b32 s73, s73, 11
  s_add_u32 s73, s73, s63
  s_add_u32 s73, s73, 0x3a00000
  buffer_load_dwordx4 v[112:115], v1, s[4:7], s73 offen offset:0 sc1
  buffer_load_dwordx4 v[116:119], v1, s[4:7], s73 offen offset:1024 sc1
  s_waitcnt vmcnt(0)
  v_max3_u32 v31, v80, v81, v82
  v_max3_u32 v31, v31, v83, v84
  v_max3_u32 v31, v31, v85, v86
  v_max3_u32 v31, v31, v87, v88
  v_max3_u32 v31, v31, v89, v90
  v_max3_u32 v31, v31, v91, v92
  v_max3_u32 v31, v31, v93, v94
  v_max3_u32 v31, v31, v95, v112
  v_max3_u32 v31, v31, v113, v114
  v_max3_u32 v31, v31, v115, v116
  v_max3_u32 v31, v31, v117, v118
  v_max_u32 v31, v31, v119
  v_cmp_eq_u32 vcc, -1, v31
  s_nop 0
  s_cbranch_vccz L_tl_kmok_f
  s_sub_u32 s70, s70, 4
  s_cselect_b32 s70, 0, s70
  s_cbranch_scc1 L_tl_kmok_f
  s_sleep 2
  s_branch L_tl_lastkm_f
L_tl_kmok_f:
  v_mfma_f32_16x16x32_bf16 v[120:123], v[80:83], v[32:35], 0
  v_mfma_f32_16x16x32_bf16 v[120:123], v[84:87], v[36:39], v[120:123]
  v_mfma_f32_16x16x32_bf16 v[120:123], v[88:91], v[40:43], v[120:123]
  v_mfma_f32_16x16x32_bf16 v[120:123], v[92:95], v[44:47], v[120:123]
  s_nop 7
  v_max3_f32 v12, v30, v120, v121
  v_mov_b32 v13, v12
  s_nop 1
  v_permlane16_swap_b32 v12, v13
  v_max_f32 v12, v12, v13
  v_mov_b32 v13, v12
  s_nop 1
  v_permlane32_swap_b32 v12, v13
  v_max_f32 v12, v12, v13
  v_mul_f32 v12, s64, v12
  v_fma_f32 v124, v124, s64, -v12
  v_fma_f32 v125, v125, s64, -v12
  v_fma_f32 v126, v126, s64, -v12
  v_fma_f32 v127, v127, s64, -v12
  v_fma_f32 v128, v128, s64, -v12
  v_fma_f32 v129, v129, s64, -v12
  v_fma_f32 v130, v130, s64, -v12
  v_fma_f32 v131, v131, s64, -v12
  v_fma_f32 v120, v120, s64, -v12
  v_fma_f32 v121, v121, s64, -v12
  v_exp_f32 v124, v124
  v_exp_f32 v125, v125
  v_exp_f32 v126, v126
  v_exp_f32 v127, v127
  v_exp_f32 v128, v128
  v_exp_f32 v129, v129
  v_exp_f32 v130, v130
  v_exp_f32 v131, v131
  v_exp_f32 v120, v120
  v_exp_f32 v121, v121
  v_cvt_pk_bf16_f32 v132, v124, v125
  v_cvt_pk_bf16_f32 v133, v126, v127
  v_cvt_pk_bf16_f32 v134, v128, v129
  v_cvt_pk_bf16_f32 v135, v130, v131
  v_cvt_pk_bf16_f32 v136, v120, v121
  v_cvt_pk_bf16_f32 v137, v120, v121
  v_mfma_f32_16x16x32_bf16 v[140:143], v[96:99], v[132:135], 0
  v_mfma_f32_16x16x32_bf16 v[144:147], v[100:103], v[132:135], 0
  v_mfma_f32_16x16x32_bf16 v[148:151], v[104:107], v[132:135], 0
  v_mfma_f32_16x16x32_bf16 v[152:155], v[108:111], v[132:135], 0
  v_add_f32 v12, v124, v125
  v_add_f32 v12, v12, v126
  v_add_f32 v12, v12, v127
  v_add_f32 v12, v12, v128
  v_add_f32 v12, v12, v129
  v_add_f32 v12, v12, v130
  v_add_f32 v12, v12, v131
  v_add_f32 v12, v12, v120
  v_add_f32 v12, v12, v121
  v_mfma_f32_16x16x16_bf16 v[140:143], v[112:113], v[136:137], v[140:143]
  v_mfma_f32_16x16x16_bf16 v[144:147], v[114:115], v[136:137], v[144:147]
  v_mfma_f32_16x16x16_bf16 v[148:151], v[116:117], v[136:137], v[148:151]
  v_mfma_f32_16x16x16_bf16 v[152:155], v[118:119], v[136:137], v[152:155]
  v_mov_b32 v13, v12
  s_nop 1
  v_permlane16_swap_b32 v12, v13
  v_add_f32 v12, v12, v13
  v_mov_b32 v13, v12
  s_nop 1
  v_permlane32_swap_b32 v12, v13
  v_add_f32 v12, v12, v13
  v_rcp_f32 v12, v12
  s_nop 0
  v_mul_f32 v140, v140, v12
  v_mul_f32 v141, v141, v12
  v_mul_f32 v142, v142, v12
  v_mul_f32 v143, v143, v12
  v_mul_f32 v144, v144, v12
  v_mul_f32 v145, v145, v12
  v_mul_f32 v146, v146, v12
  v_mul_f32 v147, v147, v12
  v_mul_f32 v148, v148, v12
  v_mul_f32 v149, v149, v12
  v_mul_f32 v150, v150, v12
  v_mul_f32 v151, v151, v12
  v_mul_f32 v152, v152, v12
  v_mul_f32 v153, v153, v12
  v_mul_f32 v154, v154, v12
  v_mul_f32 v155, v155, v12
  v_cvt_pk_bf16_f32 v140, v140, v141
  v_cvt_pk_bf16_f32 v141, v142, v143
  v_cvt_pk_bf16_f32 v142, v144, v145
  v_cvt_pk_bf16_f32 v143, v146, v147
  v_cvt_pk_bf16_f32 v144, v148, v149
  v_cvt_pk_bf16_f32 v145, v150, v151
  v_cvt_pk_bf16_f32 v146, v152, v153
  v_cvt_pk_bf16_f32 v147, v154, v155
  ds_write_b128 v5, v[140:143] offset:0
  ds_write_b128 v5, v[144:147] offset:1024
  s_waitcnt lgkmcnt(0)
  s_barrier
  ds_read_b128 v[160:163], v4 offset:4096
  ds_read_b128 v[164:167], v4 offset:5120
  ds_read_b128 v[168:171], v4 offset:6144
  ds_read_b128 v[172:175], v4 offset:7168
  ds_read_b128 v[176:179], v4 offset:8192
  ds_read_b128 v[180:183], v4 offset:9216
  ds_read_b128 v[184:187], v4 offset:10240
  ds_read_b128 v[188:191], v4 offset:11264
  s_waitcnt lgkmcnt(7)
  v_mfma_f32_16x16x32_bf16 v[192:195], a[0:3], v[160:163], 0
  s_waitcnt lgkmcnt(6)
  v_mfma_f32_16x16x32_bf16 v[192:195], a[4:7], v[164:167], v[192:195]
  s_waitcnt lgkmcnt(5)
  v_mfma_f32_16x16x32_bf16 v[192:195], a[64:67], v[168:171], v[192:195]
  s_waitcnt lgkmcnt(4)
  v_mfma_f32_16x16x32_bf16 v[192:195], a[68:71], v[172:175], v[192:195]
  s_waitcnt lgkmcnt(3)
  v_mfma_f32_16x16x32_bf16 v[196:199], a[0:3], v[176:179], 0
  s_waitcnt lgkmcnt(2)
  v_mfma_f32_16x16x32_bf16 v[196:199], a[4:7], v[180:183], v[196:199]
  s_waitcnt lgkmcnt(1)
  v_mfma_f32_16x16x32_bf16 v[196:199], a[64:67], v[184:187], v[196:199]
  s_waitcnt lgkmcnt(0)
  v_mfma_f32_16x16x32_bf16 v[196:199], a[68:71], v[188:191], v[196:199]
  v_mfma_f32_16x16x32_bf16 v[200:203], a[8:11], v[160:163], 0
  v_mfma_f32_16x16x32_bf16 v[200:203], a[12:15], v[164:167], v[200:203]
  v_mfma_f32_16x16x32_bf16 v[200:203], a[72:75], v[168:171], v[200:203]
  v_mfma_f32_16x16x32_bf16 v[200:203], a[76:79], v[172:175], v[200:203]
  v_mfma_f32_16x16x32_bf16 v[204:207], a[8:11], v[176:179], 0
  v_mfma_f32_16x16x32_bf16 v[204:207], a[12:15], v[180:183], v[204:207]
  v_mfma_f32_16x16x32_bf16 v[204:207], a[72:75], v[184:187], v[204:207]
  v_mfma_f32_16x16x32_bf16 v[204:207], a[76:79], v[188:191], v[204:207]
  v_mfma_f32_16x16x32_bf16 v[208:211], a[16:19], v[160:163], 0
  v_mfma_f32_16x16x32_bf16 v[208:211], a[20:23], v[164:167], v[208:211]
  v_mfma_f32_16x16x32_bf16 v[208:211], a[80:83], v[168:171], v[208:211]
  v_mfma_f32_16x16x32_bf16 v[208:211], a[84:87], v[172:175], v[208:211]
  v_mfma_f32_16x16x32_bf16 v[212:215], a[16:19], v[176:179], 0
  v_mfma_f32_16x16x32_bf16 v[212:215], a[20:23], v[180:183], v[212:215]
  v_mfma_f32_16x16x32_bf16 v[212:215], a[80:83], v[184:187], v[212:215]
  v_mfma_f32_16x16x32_bf16 v[212:215], a[84:87], v[188:191], v[212:215]
  v_mfma_f32_16x16x32_bf16 v[216:219], a[24:27], v[160:163], 0
  v_mfma_f32_16x16x32_bf16 v[216:219], a[28:31], v[164:167], v[216:219]
  v_mfma_f32_16x16x32_bf16 v[216:219], a[88:91], v[168:171], v[216:219]
  v_mfma_f32_16x16x32_bf16 v[216:219], a[92:95], v[172:175], v[216:219]
  v_mfma_f32_16x16x32_bf16 v[220:223], a[24:27], v[176:179], 0
  v_mfma_f32_16x16x32_bf16 v[220:223], a[28:31], v[180:183], v[220:223]
  v_mfma_f32_16x16x32_bf16 v[220:223], a[88:91], v[184:187], v[220:223]
  v_mfma_f32_16x16x32_bf16 v[220:223], a[92:95], v[188:191], v[220:223]
  v_mfma_f32_16x16x32_bf16 v[224:227], a[32:35], v[160:163], 0
  v_mfma_f32_16x16x32_bf16 v[224:227], a[36:39], v[164:167], v[224:227]
  v_mfma_f32_16x16x32_bf16 v[224:227], a[96:99], v[168:171], v[224:227]
  v_mfma_f32_16x16x32_bf16 v[224:227], a[100:103], v[172:175], v[224:227]
  v_mfma_f32_16x16x32_bf16 v[228:231], a[32:35], v[176:179], 0
  v_mfma_f32_16x16x32_bf16 v[228:231], a[36:39], v[180:183], v[228:231]
  v_mfma_f32_16x16x32_bf16 v[228:231], a[96:99], v[184:187], v[228:231]
  v_mfma_f32_16x16x32_bf16 v[228:231], a[100:103], v[188:191], v[228:231]
  v_mfma_f32_16x16x32_bf16 v[232:235], a[40:43], v[160:163], 0
  v_mfma_f32_16x16x32_bf16 v[232:235], a[44:47], v[164:167], v[232:235]
  v_mfma_f32_16x16x32_bf16 v[232:235], a[104:107], v[168:171], v[232:235]
  v_mfma_f32_16x16x32_bf16 v[232:235], a[108:111], v[172:175], v[232:235]
  v_mfma_f32_16x16x32_bf16 v[236:239], a[40:43], v[176:179], 0
  v_mfma_f32_16x16x32_bf16 v[236:239], a[44:47], v[180:183], v[236:239]
  v_mfma_f32_16x16x32_bf16 v[236:239], a[104:107], v[184:187], v[236:239]
  v_mfma_f32_16x16x32_bf16 v[236:239], a[108:111], v[188:191], v[236:239]
  v_mfma_f32_16x16x32_bf16 v[240:243], a[48:51], v[160:163], 0
  v_mfma_f32_16x16x32_bf16 v[240:243], a[52:55], v[164:167], v[240:243]
  v_mfma_f32_16x16x32_bf16 v[240:243], a[112:115], v[168:171], v[240:243]
  v_mfma_f32_16x16x32_bf16 v[240:243], a[116:119], v[172:175], v[240:243]
  v_mfma_f32_16x16x32_bf16 v[244:247], a[48:51], v[176:179], 0
  v_mfma_f32_16x16x32_bf16 v[244:247], a[52:55], v[180:183], v[244:247]
  v_mfma_f32_16x16x32_bf16 v[244:247], a[112:115], v[184:187], v[244:247]
  v_mfma_f32_16x16x32_bf16 v[244:247], a[116:119], v[188:191], v[244:247]
  v_mfma_f32_16x16x32_bf16 v[248:251], a[56:59], v[160:163], 0
  v_mfma_f32_16x16x32_bf16 v[248:251], a[60:63], v[164:167], v[248:251]
  v_mfma_f32_16x16x32_bf16 v[248:251], a[120:123], v[168:171], v[248:251]
  v_mfma_f32_16x16x32_bf16 v[248:251], a[124:127], v[172:175], v[248:251]
  v_mfma_f32_16x16x32_bf16 v[252:255], a[56:59], v[176:179], 0
  v_mfma_f32_16x16x32_bf16 v[252:255], a[60:63], v[180:183], v[252:255]
  v_mfma_f32_16x16x32_bf16 v[252:255], a[120:123], v[184:187], v[252:255]
  v_mfma_f32_16x16x32_bf16 v[252:255], a[124:127], v[188:191], v[252:255]
  v_cvt_pk_bf16_f32 v72, v192, v193
  v_cvt_pk_bf16_f32 v73, v194, v195
  v_cvt_pk_bf16_f32 v74, v200, v201
  v_cvt_pk_bf16_f32 v75, v202, v203
  s_add_u32 s72, s60, 0
  buffer_store_dwordx4 v[72:75], v6, s[4:7], s72 offen
  v_cvt_pk_bf16_f32 v76, v208, v209
  v_cvt_pk_bf16_f32 v77, v210, v211
  v_cvt_pk_bf16_f32 v78, v216, v217
  v_cvt_pk_bf16_f32 v79, v218, v219
  s_add_u32 s72, s60, 32768
  buffer_store_dwordx4 v[76:79], v6, s[4:7], s72 offen
  v_cvt_pk_bf16_f32 v72, v224, v225
  v_cvt_pk_bf16_f32 v73, v226, v227
  v_cvt_pk_bf16_f32 v74, v232, v233
  v_cvt_pk_bf16_f32 v75, v234, v235
  s_add_u32 s72, s60, 65536
  buffer_store_dwordx4 v[72:75], v6, s[4:7], s72 offen
  v_cvt_pk_bf16_f32 v76, v240, v241
  v_cvt_pk_bf16_f32 v77, v242, v243
  v_cvt_pk_bf16_f32 v78, v248, v249
  v_cvt_pk_bf16_f32 v79, v250, v251
  s_add_u32 s72, s60, 98304
  buffer_store_dwordx4 v[76:79], v6, s[4:7], s72 offen
  v_cvt_pk_bf16_f32 v72, v196, v197
  v_cvt_pk_bf16_f32 v73, v198, v199
  v_cvt_pk_bf16_f32 v74, v204, v205
  v_cvt_pk_bf16_f32 v75, v206, v207
  s_add_u32 s72, s60, 524288
  buffer_store_dwordx4 v[72:75], v6, s[4:7], s72 offen
  v_cvt_pk_bf16_f32 v76, v212, v213
  v_cvt_pk_bf16_f32 v77, v214, v215
  v_cvt_pk_bf16_f32 v78, v220, v221
  v_cvt_pk_bf16_f32 v79, v222, v223
  s_add_u32 s72, s60, 557056
  buffer_store_dwordx4 v[76:79], v6, s[4:7], s72 offen
  v_cvt_pk_bf16_f32 v72, v228, v229
  v_cvt_pk_bf16_f32 v73, v230, v231
  v_cvt_pk_bf16_f32 v74, v236, v237
  v_cvt_pk_bf16_f32 v75, v238, v239
  s_add_u32 s72, s60, 589824
  buffer_store_dwordx4 v[72:75], v6, s[4:7], s72 offen
  v_cvt_pk_bf16_f32 v76, v244, v245
  v_cvt_pk_bf16_f32 v77, v246, v247
  v_cvt_pk_bf16_f32 v78, v252, v253
  v_cvt_pk_bf16_f32 v79, v254, v255
  s_add_u32 s72, s60, 622592
  buffer_store_dwordx4 v[76:79], v6, s[4:7], s72 offen
  s_mov_b32 s62, s56
  s_add_u32 s56, s56, 5
  s_waitcnt vmcnt(0)
  s_barrier
  s_add_u32 s57, s57, 1
  s_cmp_eq_u32 s54, 0
  s_cbranch_scc0 L_xb_ws_f
  s_lshl_b32 s72, s52, 2
  s_add_u32 s72, s72, s58
  s_mov_b64 exec, 1
  v_mov_b32 v12, 0
  v_mov_b32 v13, s57
  buffer_store_dword v13, v12, s[4:7], s72 offen
  s_mov_b32 exec_lo, -1
  v_lshlrev_b32 v12, 2, v0
L_xb_ps_f:
  buffer_load_dword v13, v12, s[4:7], s58 offen sc1
  s_waitcnt vmcnt(0)
  v_cmp_gt_u32 vcc, s57, v13
  s_nop 0
  s_cbranch_vccz L_xb_oks_f
  s_sleep 1
  s_sub_u32 s70, s70, 1
  s_cbranch_scc0 L_xb_ps_f
  s_mov_b32 s70, 0
L_xb_oks_f:
  s_mov_b64 exec, -1
L_xb_ws_f:
  s_barrier
  s_add_u32 s72, s60, 0
  buffer_load_dwordx4 v[160:163], v7, s[4:7], s72 offen sc1
  s_add_u32 s72, s60, 4096
  buffer_load_dwordx4 v[164:167], v7, s[4:7], s72 offen sc1
  s_add_u32 s72, s60, 8192
  buffer_load_dwordx4 v[168:171], v7, s[4:7], s72 offen sc1
  s_add_u32 s72, s60, 12288
  buffer_load_dwordx4 v[172:175], v7, s[4:7], s72 offen sc1
  s_add_u32 s72, s60, 16384
  buffer_load_dwordx4 v[176:179], v7, s[4:7], s72 offen sc1
  s_add_u32 s72, s60, 20480
  buffer_load_dwordx4 v[180:183], v7, s[4:7], s72 offen sc1
  s_add_u32 s72, s60, 24576
  buffer_load_dwordx4 v[184:187], v7, s[4:7], s72 offen sc1
  s_add_u32 s72, s60, 28672
  buffer_load_dwordx4 v[188:191], v7, s[4:7], s72 offen sc1
  s_waitcnt vmcnt(7)
  v_mfma_f32_16x16x32_bf16 v[192:195], v[16:19], v[160:163], 0
  s_waitcnt vmcnt(6)
  v_mfma_f32_16x16x32_bf16 v[192:195], v[16:19], v[164:167], v[192:195]
  s_waitcnt vmcnt(5)
  v_mfma_f32_16x16x32_bf16 v[192:195], v[16:19], v[168:171], v[192:195]
  s_waitcnt vmcnt(4)
  v_mfma_f32_16x16x32_bf16 v[192:195], v[16:19], v[172:175], v[192:195]
  s_waitcnt vmcnt(3)
  v_mfma_f32_16x16x32_bf16 v[192:195], v[16:19], v[176:179], v[192:195]
  s_waitcnt vmcnt(2)
  v_mfma_f32_16x16x32_bf16 v[192:195], v[16:19], v[180:183], v[192:195]
  s_waitcnt vmcnt(1)
  v_mfma_f32_16x16x32_bf16 v[192:195], v[16:19], v[184:187], v[192:195]
  s_waitcnt vmcnt(0)
  v_mfma_f32_16x16x32_bf16 v[192:195], v[16:19], v[188:191], v[192:195]
  s_nop 7
  v_cvt_pk_bf16_f32 v192, v192, v192
  v_lshlrev_b32 v192, 16, v192
  v_cvt_pk_bf16_f32 v193, v193, v193
  v_lshlrev_b32 v193, 16, v193
  v_cvt_pk_bf16_f32 v194, v194, v194
  v_lshlrev_b32 v194, 16, v194
  v_cvt_pk_bf16_f32 v195, v195, v195
  v_lshlrev_b32 v195, 16, v195
  v_mul_f32 v192, v192, v24
  v_mul_f32 v193, v193, v25
  v_mul_f32 v194, v194, v26
  v_mul_f32 v195, v195, v27
  v_cvt_pk_bf16_f32 v192, v192, v192
  v_lshlrev_b32 v192, 16, v192
  v_cvt_pk_bf16_f32 v193, v193, v193
  v_lshlrev_b32 v193, 16, v193
  v_cvt_pk_bf16_f32 v194, v194, v194
  v_lshlrev_b32 v194, 16, v194
  v_cvt_pk_bf16_f32 v195, v195, v195
  v_lshlrev_b32 v195, 16, v195
  v_lshlrev_b32 v12, 16, v28
  v_and_b32 v13, 0xffff0000, v28
  v_lshlrev_b32 v14, 16, v29
  v_and_b32 v28, 0xffff0000, v29
  v_add_f32 v192, v192, v12
  v_add_f32 v193, v193, v13
  v_add_f32 v194, v194, v14
  v_add_f32 v195, v195, v28
  v_cvt_pk_bf16_f32 v12, v192, v193
  v_cvt_pk_bf16_f32 v13, v194, v195
  s_mov_b32 s8, s46
  s_and_b32 s9, s47, 0xffff
  s_mov_b32 s10, 0x200000
  s_mov_b32 s11, 0x20000
  s_lshl_b32 s61, s62, 15
  s_mov_b32 exec_hi, 0
  buffer_store_dwordx2 v[12:13], v8, s[8:11], s61 offen
  s_mov_b64 exec, -1
  s_cmp_lt_u32 s56, 64
  s_cbranch_scc1 L_tl_more_f
  s_branch L_end
L_tl_more_f:
  s_lshl_b32 s73, s56, 15
  s_lshl_b32 s74, s54, 13
  s_add_u32 s73, s73, s74
  s_add_u32 m0, s74, 0
  s_add_u32 s72, s73, 0
  buffer_load_dwordx4 v1, s[4:7], s72 offen sc1 lds
  s_add_u32 m0, s74, 1024
  s_add_u32 s72, s73, 1024
  buffer_load_dwordx4 v1, s[4:7], s72 offen sc1 lds
  s_add_u32 m0, s74, 2048
  s_add_u32 s72, s73, 2048
  buffer_load_dwordx4 v1, s[4:7], s72 offen sc1 lds
  s_add_u32 m0, s74, 3072
  s_add_u32 s72, s73, 3072
  buffer_load_dwordx4 v1, s[4:7], s72 offen sc1 lds
  s_add_u32 m0, s74, 4096
  s_add_u32 s72, s73, 4096
  buffer_load_dwordx4 v1, s[4:7], s72 offen sc1 lds
  s_add_u32 m0, s74, 5120
  s_add_u32 s72, s73, 5120
  buffer_load_dwordx4 v1, s[4:7], s72 offen sc1 lds
  s_add_u32 m0, s74, 6144
  s_add_u32 s72, s73, 6144
  buffer_load_dwordx4 v1, s[4:7], s72 offen sc1 lds
  s_add_u32 m0, s74, 7168
  s_add_u32 s72, s73, 7168
  buffer_load_dwordx4 v1, s[4:7], s72 offen sc1 lds
  s_branch L_tl_loop_f
L_tail_s:
  v_lshlrev_b32 v1, 4, v0
  s_cmp_eq_u32 s54, 0
  s_cbranch_scc0 L_tl_clr0_s_ok
  s_mov_b64 exec, 0xff
  v_lshlrev_b32 v12, 4, v0
  v_add_u32 v12, 112, v12
  v_cmp_eq_u32 vcc, 0, v0
  s_nop 1
  v_cndmask_b32 v12, v12, 0, vcc
L_tl_clr0_s:
  buffer_load_dwordx2 v[14:15], v12, s[16:19], 0 offen sc1
  s_waitcnt vmcnt(0)
  v_readlane_b32 s96, v15, 0
  v_readlane_b32 s97, v15, 1
  v_readlane_b32 s98, v15, 2
  v_readlane_b32 s99, v15, 3
  v_readlane_b32 s100, v15, 4
  v_readlane_b32 s101, v15, 5
  v_readlane_b32 s22, v15, 6
  v_readlane_b32 s23, v15, 7
  s_nop 3
  s_add_u32 s3, s96, s97
  s_add_u32 s3, s3, s98
  s_add_u32 s3, s3, s99
  s_add_u32 s3, s3, s100
  s_add_u32 s3, s3, s101
  s_add_u32 s3, s3, s22
  s_add_u32 s3, s3, s23
  s_cmp_ge_u32 s3, 0x100
  s_cbranch_scc1 L_tl_clr0_s_d
  s_sub_u32 s70, s70, 64
  s_cselect_b32 s70, 0, s70
  s_cbranch_scc1 L_tl_clr0_s_d
  s_sleep 4
  s_branch L_tl_clr0_s
L_tl_clr0_s_d:
  v_readlane_b32 s96, v14, 0
  v_readlane_b32 s97, v14, 1
  v_readlane_b32 s98, v14, 2
  v_readlane_b32 s99, v14, 3
  v_readlane_b32 s100, v14, 4
  v_readlane_b32 s101, v14, 5
  v_readlane_b32 s22, v14, 6
  v_readlane_b32 s23, v14, 7
  s_nop 3
  s_mov_b32 s3, 0
  s_cmp_eq_u32 s96, 32
  s_cselect_b32 s3, s3, 1
  s_cmp_eq_u32 s97, 32
  s_cselect_b32 s3, s3, 1
  s_cmp_eq_u32 s98, 32
  s_cselect_b32 s3, s3, 1
  s_cmp_eq_u32 s99, 32
  s_cselect_b32 s3, s3, 1
  s_cmp_eq_u32 s100, 32
  s_cselect_b32 s3, s3, 1
  s_cmp_eq_u32 s101, 32
  s_cselect_b32 s3, s3, 1
  s_cmp_eq_u32 s22, 32
  s_cselect_b32 s3, s3, 1
  s_cmp_eq_u32 s23, 32
  s_cselect_b32 s3, s3, 1
  s_cmp_eq_u32 s55, 0
  s_cselect_b32 s3, s3, 0
  s_mov_b64 exec, -1
  v_mov_b32 v12, 0x27ff0
  v_mov_b32 v13, s3
  ds_write_b32 v12, v13
  s_waitcnt lgkmcnt(0)
  s_mov_b64 exec, -1
L_tl_clr0_s_ok:
  s_barrier
  v_mov_b32 v12, 0x27ff0
  ds_read_b32 v13, v12
  s_waitcnt lgkmcnt(0)
  v_readfirstlane_b32 s3, v13
  s_nop 3
  s_cmp_eq_u32 s3, 0
  s_cbranch_scc0 L_fallback
  s_lshl_b32 s62, s52, 7
  s_add_u32 s62, s62, 0x42d1000
  s_cmp_eq_u32 s54, 0
  s_cbranch_scc0 L_tl_go_s_bar
  s_mov_b64 exec, 1
L_tl_go_s:
  buffer_load_dword v12, off, s[4:7], s62 sc1
  s_waitcnt vmcnt(0)
  v_readfirstlane_b32 s72, v12
  s_nop 3
  s_cmp_ge_u32 s72, 1
  s_cbranch_scc1 L_tl_go_s_ok
  s_sub_u32 s70, s70, 16
  s_cselect_b32 s70, 0, s70
  s_cbranch_scc1 L_tl_go_s_ok
  s_sleep 16
  s_branch L_tl_go_s
L_tl_go_s_ok:
  s_mov_b64 exec, -1
L_tl_go_s_bar:
  s_barrier
  s_lshl_b32 s73, s54, 13
  s_add_u32 s73, s73, 0x10000
  v_lshrrev_b32 v104, 1, v0
  v_and_b32 v104, 7, v104
  v_lshrrev_b32 v15, 4, v0
  v_and_b32 v15, 3, v15
  v_xor_b32 v104, v104, v15
  v_lshlrev_b32 v104, 5, v104
  v_lshrrev_b32 v15, 4, v0
  v_and_b32 v15, 3, v15
  v_lshlrev_b32 v15, 8, v15
  v_and_b32 v127, 1, v0
  v_lshlrev_b32 v127, 4, v127
  v_add_u32 v15, v15, v127
  v_add_u32 v104, v104, v15
  v_add_u32 v104, s73, v104
  v_xor_b32 v115, 0x80, v104
  v_lshrrev_b32 v105, 2, v0
  v_and_b32 v105, 3, v105
  v_lshrrev_b32 v127, 4, v0
  v_and_b32 v127, 1, v127
  v_lshlrev_b32 v127, 2, v127
  v_add_u32 v105, v105, v127
  s_lshl_b32 s72, s54, 1
  v_xor_b32 v105, s72, v105
  v_lshlrev_b32 v105, 5, v105
  v_lshrrev_b32 v15, 4, v0
  v_and_b32 v15, 3, v15
  v_lshlrev_b32 v15, 11, v15
  v_lshrrev_b32 v127, 2, v0
  v_and_b32 v127, 3, v127
  v_lshlrev_b32 v127, 8, v127
  v_add_u32 v15, v15, v127
  v_and_b32 v127, 3, v0
  v_lshlrev_b32 v127, 3, v127
  v_add_u32 v15, v15, v127
  v_add_u32 v15, 0x10000, v15
  v_add_u32 v105, v105, v15
  v_xor_b32 v106, 32, v105
  v_lshrrev_b32 v107, 1, v0
  v_and_b32 v107, 3, v107
  v_lshrrev_b32 v15, 4, v0
  v_and_b32 v15, 3, v15
  v_xor_b32 v107, v107, v15
  v_lshlrev_b32 v107, 5, v107
  v_lshrrev_b32 v15, 3, v0
  v_and_b32 v15, 7, v15
  v_lshlrev_b32 v15, 7, v15
  v_and_b32 v127, 1, v0
  v_lshlrev_b32 v127, 4, v127
  v_add_u32 v15, v15, v127
  v_add_u32 v107, v107, v15
  v_add_u32 v107, s73, v107
  v_lshrrev_b32 v108, 4, v0
  v_and_b32 v108, 1, v108
  v_lshlrev_b32 v108, 1, v108
  v_lshrrev_b32 v127, 3, v0
  v_and_b32 v127, 1, v127
  v_add_u32 v108, v108, v127
  v_lshlrev_b32 v108, 5, v108
  v_lshrrev_b32 v15, 4, v0
  v_and_b32 v15, 3, v15
  v_lshlrev_b32 v15, 9, v15
  v_lshrrev_b32 v127, 2, v0
  v_and_b32 v127, 3, v127
  v_lshlrev_b32 v127, 7, v127
  v_add_u32 v15, v15, v127
  v_and_b32 v127, 3, v0
  v_lshlrev_b32 v127, 3, v127
  v_add_u32 v15, v15, v127
  v_add_u32 v108, v108, v15
  v_add_u32 v108, s73, v108
  v_lshrrev_b32 v109, 1, v0
  v_and_b32 v109, 31, v109
  v_lshlrev_b32 v109, 5, v109
  v_lshrrev_b32 v15, 4, v0
  v_and_b32 v15, 1, v15
  v_lshlrev_b32 v15, 7, v15
  v_xor_b32 v109, v109, v15
  v_and_b32 v15, 1, v0
  v_lshlrev_b32 v15, 4, v15
  v_add_u32 v109, v109, v15
  v_add_u32 v109, s73, v109
  v_lshrrev_b32 v110, 4, v0
  v_and_b32 v110, 3, v110
  v_lshlrev_b32 v110, 8, v110
  v_lshrrev_b32 v127, 4, v0
  v_and_b32 v127, 1, v127
  v_lshlrev_b32 v127, 7, v127
  v_add_u32 v110, v110, v127
  v_lshrrev_b32 v127, 2, v0
  v_and_b32 v127, 3, v127
  v_lshlrev_b32 v127, 5, v127
  v_add_u32 v110, v110, v127
  v_and_b32 v127, 3, v0
  v_lshlrev_b32 v127, 3, v127
  v_add_u32 v110, v110, v127
  v_add_u32 v110, s73, v110
  v_xor_b32 v111, 0x80, v110
  v_lshrrev_b32 v112, 3, v0
  v_and_b32 v112, 7, v112
  v_lshlrev_b32 v112, 10, v112
  v_and_b32 v127, 7, v0
  v_lshlrev_b32 v127, 4, v127
  v_add_u32 v112, v112, v127
  s_lshl_b32 s72, s54, 8
  v_add_u32 v112, s72, v112
  s_lshl_b32 s72, s52, 16
  v_add_u32 v113, s72, v112
  s_lshl_b32 s72, s52, 17
  v_add_u32 v112, s72, v112
  v_lshrrev_b32 v114, 1, v0
  v_mul_u32_u24 v114, 3584, v114
  v_and_b32 v15, 1, v0
  v_lshlrev_b32 v15, 4, v15
  v_add_u32 v114, v114, v15
  s_lshl_b32 s72, s54, 5
  v_add_u32 v114, s72, v114
  s_lshl_b32 s72, s52, 7
  v_add_u32 v114, s72, v114
  s_cmp_lt_u32 s52, 28
  s_cbranch_scc0 L_tl_nofw_s
  s_mov_b32 s8, s40
  s_and_b32 s9, s41, 0xffff
  s_mov_b32 s10, 0x1c0000
  s_mov_b32 s11, 0x20000
  s_mov_b32 s74, 0x0
  buffer_load_dwordx4 a[192:195], v114, s[8:11], s74 offen
  s_mov_b32 s74, 0x1c000
  buffer_load_dwordx4 a[196:199], v114, s[8:11], s74 offen
  s_mov_b32 s74, 0x38000
  buffer_load_dwordx4 a[200:203], v114, s[8:11], s74 offen
  s_mov_b32 s74, 0x54000
  buffer_load_dwordx4 a[204:207], v114, s[8:11], s74 offen
  s_mov_b32 s74, 0x70000
  buffer_load_dwordx4 a[208:211], v114, s[8:11], s74 offen
  s_mov_b32 s74, 0x8c000
  buffer_load_dwordx4 a[212:215], v114, s[8:11], s74 offen
  s_mov_b32 s74, 0xa8000
  buffer_load_dwordx4 a[216:219], v114, s[8:11], s74 offen
  s_mov_b32 s74, 0xc4000
  buffer_load_dwordx4 a[220:223], v114, s[8:11], s74 offen
  s_mov_b32 s12, s40
  s_and_b32 s13, s41, 0xffff
  s_mov_b32 s14, 0x1c0000
  s_mov_b32 s15, 0x20000
  s_mov_b32 s74, 0xe0000
  buffer_load_dwordx4 a[224:227], v114, s[12:15], s74 offen
  s_mov_b32 s74, 0xfc000
  buffer_load_dwordx4 a[228:231], v114, s[12:15], s74 offen
  s_mov_b32 s74, 0x118000
  buffer_load_dwordx4 a[232:235], v114, s[12:15], s74 offen
  s_mov_b32 s74, 0x134000
  buffer_load_dwordx4 a[236:239], v114, s[12:15], s74 offen
  s_mov_b32 s74, 0x150000
  buffer_load_dwordx4 a[240:243], v114, s[12:15], s74 offen
  s_mov_b32 s74, 0x16c000
  buffer_load_dwordx4 a[244:247], v114, s[12:15], s74 offen
  s_mov_b32 s74, 0x188000
  buffer_load_dwordx4 a[248:251], v114, s[12:15], s74 offen
  s_mov_b32 s74, 0x1a4000
  buffer_load_dwordx4 a[252:255], v114, s[12:15], s74 offen
  s_mov_b32 s8, s44
  s_and_b32 s9, s45, 0xffff
  s_mov_b32 s10, 0x1c0000
  s_mov_b32 s11, 0x20000
  s_mov_b32 s74, 0x0
  buffer_load_dwordx4 a[128:131], v113, s[8:11], s74 offen
  s_mov_b32 s74, 0x2000
  buffer_load_dwordx4 a[132:135], v113, s[8:11], s74 offen
  s_mov_b32 s74, 0x4000
  buffer_load_dwordx4 a[136:139], v113, s[8:11], s74 offen
  s_mov_b32 s74, 0x6000
  buffer_load_dwordx4 a[140:143], v113, s[8:11], s74 offen
  s_mov_b32 s74, 0x8000
  buffer_load_dwordx4 a[144:147], v113, s[8:11], s74 offen
  s_mov_b32 s74, 0xa000
  buffer_load_dwordx4 a[148:151], v113, s[8:11], s74 offen
  s_mov_b32 s74, 0xc000
  buffer_load_dwordx4 a[152:155], v113, s[8:11], s74 offen
  s_mov_b32 s74, 0xe000
  buffer_load_dwordx4 a[156:159], v113, s[8:11], s74 offen
  s_mov_b32 s12, s44
  s_and_b32 s13, s45, 0xffff
  s_mov_b32 s14, 0x1c0000
  s_mov_b32 s15, 0x20000
  s_mov_b32 s74, 0x80
  buffer_load_dwordx4 a[160:163], v113, s[12:15], s74 offen
  s_mov_b32 s74, 0x2080
  buffer_load_dwordx4 a[164:167], v113, s[12:15], s74 offen
  s_mov_b32 s74, 0x4080
  buffer_load_dwordx4 a[168:171], v113, s[12:15], s74 offen
  s_mov_b32 s74, 0x6080
  buffer_load_dwordx4 a[172:175], v113, s[12:15], s74 offen
  s_mov_b32 s74, 0x8080
  buffer_load_dwordx4 a[176:179], v113, s[12:15], s74 offen
  s_mov_b32 s74, 0xa080
  buffer_load_dwordx4 a[180:183], v113, s[12:15], s74 offen
  s_mov_b32 s74, 0xc080
  buffer_load_dwordx4 a[184:187], v113, s[12:15], s74 offen
  s_mov_b32 s74, 0xe080
  buffer_load_dwordx4 a[188:191], v113, s[12:15], s74 offen
  s_waitcnt vmcnt(24)
  ds_write_b128 v109, a[192:195] offset:0
  ds_write_b128 v109, a[196:199] offset:1024
  ds_write_b128 v109, a[200:203] offset:2048
  ds_write_b128 v109, a[204:207] offset:3072
  ds_write_b128 v109, a[208:211] offset:4096
  ds_write_b128 v109, a[212:215] offset:5120
  ds_write_b128 v109, a[216:219] offset:6144
  ds_write_b128 v109, a[220:223] offset:7168
  s_waitcnt lgkmcnt(0)
  ds_read_b64_tr_b16 a[192:193], v110 offset:0
  ds_read_b64_tr_b16 a[194:195], v111 offset:0
  ds_read_b64_tr_b16 a[196:197], v110 offset:1024
  ds_read_b64_tr_b16 a[198:199], v111 offset:1024
  ds_read_b64_tr_b16 a[200:201], v110 offset:2048
  ds_read_b64_tr_b16 a[202:203], v111 offset:2048
  ds_read_b64_tr_b16 a[204:205], v110 offset:3072
  ds_read_b64_tr_b16 a[206:207], v111 offset:3072
  s_waitcnt lgkmcnt(0)
  ds_read_b64_tr_b16 a[208:209], v110 offset:4096
  ds_read_b64_tr_b16 a[210:211], v111 offset:4096
  ds_read_b64_tr_b16 a[212:213], v110 offset:5120
  ds_read_b64_tr_b16 a[214:215], v111 offset:5120
  ds_read_b64_tr_b16 a[216:217], v110 offset:6144
  ds_read_b64_tr_b16 a[218:219], v111 offset:6144
  ds_read_b64_tr_b16 a[220:221], v110 offset:7168
  ds_read_b64_tr_b16 a[222:223], v111 offset:7168
  s_waitcnt lgkmcnt(0)
  s_waitcnt vmcnt(16)
  ds_write_b128 v109, a[224:227] offset:0
  ds_write_b128 v109, a[228:231] offset:1024
  ds_write_b128 v109, a[232:235] offset:2048
  ds_write_b128 v109, a[236:239] offset:3072
  ds_write_b128 v109, a[240:243] offset:4096
  ds_write_b128 v109, a[244:247] offset:5120
  ds_write_b128 v109, a[248:251] offset:6144
  ds_write_b128 v109, a[252:255] offset:7168
  s_waitcnt lgkmcnt(0)
  ds_read_b64_tr_b16 a[224:225], v110 offset:0
  ds_read_b64_tr_b16 a[226:227], v111 offset:0
  ds_read_b64_tr_b16 a[228:229], v110 offset:1024
  ds_read_b64_tr_b16 a[230:231], v111 offset:1024
  ds_read_b64_tr_b16 a[232:233], v110 offset:2048
  ds_read_b64_tr_b16 a[234:235], v111 offset:2048
  ds_read_b64_tr_b16 a[236:237], v110 offset:3072
  ds_read_b64_tr_b16 a[238:239], v111 offset:3072
  s_waitcnt lgkmcnt(0)
  ds_read_b64_tr_b16 a[240:241], v110 offset:4096
  ds_read_b64_tr_b16 a[242:243], v111 offset:4096
  ds_read_b64_tr_b16 a[244:245], v110 offset:5120
  ds_read_b64_tr_b16 a[246:247], v111 offset:5120
  ds_read_b64_tr_b16 a[248:249], v110 offset:6144
  ds_read_b64_tr_b16 a[250:251], v111 offset:6144
  ds_read_b64_tr_b16 a[252:253], v110 offset:7168
  ds_read_b64_tr_b16 a[254:255], v111 offset:7168
  s_waitcnt lgkmcnt(0)
  s_waitcnt vmcnt(8)
  ds_write_b128 v107, a[128:131] offset:0
  ds_write_b128 v107, a[132:135] offset:1024
  ds_write_b128 v107, a[136:139] offset:2048
  ds_write_b128 v107, a[140:143] offset:3072
  ds_write_b128 v107, a[144:147] offset:4096
  ds_write_b128 v107, a[148:151] offset:5120
  ds_write_b128 v107, a[152:155] offset:6144
  ds_write_b128 v107, a[156:159] offset:7168
  s_waitcnt lgkmcnt(0)
  ds_read_b64_tr_b16 a[128:129], v108 offset:0
  ds_read_b64_tr_b16 a[130:131], v108 offset:2048
  ds_read_b64_tr_b16 a[132:133], v108 offset:4096
  ds_read_b64_tr_b16 a[134:135], v108 offset:6144
  v_xor_b32 v15, 32, v108
  ds_read_b64_tr_b16 a[136:137], v15 offset:0
  ds_read_b64_tr_b16 a[138:139], v15 offset:2048
  ds_read_b64_tr_b16 a[140:141], v15 offset:4096
  ds_read_b64_tr_b16 a[142:143], v15 offset:6144
  s_waitcnt lgkmcnt(0)
  v_xor_b32 v15, 64, v108
  ds_read_b64_tr_b16 a[144:145], v15 offset:0
  ds_read_b64_tr_b16 a[146:147], v15 offset:2048
  ds_read_b64_tr_b16 a[148:149], v15 offset:4096
  ds_read_b64_tr_b16 a[150:151], v15 offset:6144
  v_xor_b32 v15, 96, v108
  ds_read_b64_tr_b16 a[152:153], v15 offset:0
  ds_read_b64_tr_b16 a[154:155], v15 offset:2048
  ds_read_b64_tr_b16 a[156:157], v15 offset:4096
  ds_read_b64_tr_b16 a[158:159], v15 offset:6144
  s_waitcnt lgkmcnt(0)
  s_waitcnt vmcnt(0)
  ds_write_b128 v107, a[160:163] offset:0
  ds_write_b128 v107, a[164:167] offset:1024
  ds_write_b128 v107, a[168:171] offset:2048
  ds_write_b128 v107, a[172:175] offset:3072
  ds_write_b128 v107, a[176:179] offset:4096
  ds_write_b128 v107, a[180:183] offset:5120
  ds_write_b128 v107, a[184:187] offset:6144
  ds_write_b128 v107, a[188:191] offset:7168
  s_waitcnt lgkmcnt(0)
  ds_read_b64_tr_b16 a[160:161], v108 offset:0
  ds_read_b64_tr_b16 a[162:163], v108 offset:2048
  ds_read_b64_tr_b16 a[164:165], v108 offset:4096
  ds_read_b64_tr_b16 a[166:167], v108 offset:6144
  v_xor_b32 v15, 32, v108
  ds_read_b64_tr_b16 a[168:169], v15 offset:0
  ds_read_b64_tr_b16 a[170:171], v15 offset:2048
  ds_read_b64_tr_b16 a[172:173], v15 offset:4096
  ds_read_b64_tr_b16 a[174:175], v15 offset:6144
  s_waitcnt lgkmcnt(0)
  v_xor_b32 v15, 64, v108
  ds_read_b64_tr_b16 a[176:177], v15 offset:0
  ds_read_b64_tr_b16 a[178:179], v15 offset:2048
  ds_read_b64_tr_b16 a[180:181], v15 offset:4096
  ds_read_b64_tr_b16 a[182:183], v15 offset:6144
  v_xor_b32 v15, 96, v108
  ds_read_b64_tr_b16 a[184:185], v15 offset:0
  ds_read_b64_tr_b16 a[186:187], v15 offset:2048
  ds_read_b64_tr_b16 a[188:189], v15 offset:4096
  ds_read_b64_tr_b16 a[190:191], v15 offset:6144
  s_waitcnt lgkmcnt(0)
  s_mov_b32 s8, s42
  s_and_b32 s9, s43, 0xffff
  s_mov_b32 s10, 0xe00
  s_mov_b32 s11, 0x20000
  v_lshrrev_b32 v15, 4, v0
  v_and_b32 v15, 3, v15
  v_lshlrev_b32 v15, 3, v15
  s_lshl_b32 s72, s52, 7
  v_add_u32 v15, s72, v15
  s_lshl_b32 s72, s54, 5
  v_add_u32 v15, s72, v15
  buffer_load_dwordx2 v[12:13], v15, s[8:11], 0 offen
  s_waitcnt vmcnt(0)
  v_lshlrev_b32 v20, 16, v12
  v_and_b32 v21, 0xffff0000, v12
  v_lshlrev_b32 v22, 16, v13
  v_and_b32 v23, 0xffff0000, v13
L_tl_nofw_s:
  s_mov_b32 s8, s34
  s_and_b32 s9, s35, 0xffff
  s_mov_b32 s10, 0x400000
  s_mov_b32 s11, 0x20000
  s_mov_b32 s74, 0x0
  buffer_load_dwordx4 a[0:3], v112, s[8:11], s74 offen
  s_mov_b32 s74, 0x2000
  buffer_load_dwordx4 a[4:7], v112, s[8:11], s74 offen
  s_mov_b32 s74, 0x4000
  buffer_load_dwordx4 a[8:11], v112, s[8:11], s74 offen
  s_mov_b32 s74, 0x6000
  buffer_load_dwordx4 a[12:15], v112, s[8:11], s74 offen
  s_mov_b32 s74, 0x8000
  buffer_load_dwordx4 a[16:19], v112, s[8:11], s74 offen
  s_mov_b32 s74, 0xa000
  buffer_load_dwordx4 a[20:23], v112, s[8:11], s74 offen
  s_mov_b32 s74, 0xc000
  buffer_load_dwordx4 a[24:27], v112, s[8:11], s74 offen
  s_mov_b32 s74, 0xe000
  buffer_load_dwordx4 a[28:31], v112, s[8:11], s74 offen
  s_mov_b32 s12, s34
  s_and_b32 s13, s35, 0xffff
  s_mov_b32 s14, 0x400000
  s_mov_b32 s15, 0x20000
  s_mov_b32 s74, 0x80
  buffer_load_dwordx4 a[32:35], v112, s[12:15], s74 offen
  s_mov_b32 s74, 0x2080
  buffer_load_dwordx4 a[36:39], v112, s[12:15], s74 offen
  s_mov_b32 s74, 0x4080
  buffer_load_dwordx4 a[40:43], v112, s[12:15], s74 offen
  s_mov_b32 s74, 0x6080
  buffer_load_dwordx4 a[44:47], v112, s[12:15], s74 offen
  s_mov_b32 s74, 0x8080
  buffer_load_dwordx4 a[48:51], v112, s[12:15], s74 offen
  s_mov_b32 s74, 0xa080
  buffer_load_dwordx4 a[52:55], v112, s[12:15], s74 offen
  s_mov_b32 s74, 0xc080
  buffer_load_dwordx4 a[56:59], v112, s[12:15], s74 offen
  s_mov_b32 s74, 0xe080
  buffer_load_dwordx4 a[60:63], v112, s[12:15], s74 offen
  s_mov_b32 s8, s34
  s_and_b32 s9, s35, 0xffff
  s_mov_b32 s10, 0x400000
  s_mov_b32 s11, 0x20000
  s_mov_b32 s74, 0x10000
  buffer_load_dwordx4 a[64:67], v112, s[8:11], s74 offen
  s_mov_b32 s74, 0x12000
  buffer_load_dwordx4 a[68:71], v112, s[8:11], s74 offen
  s_mov_b32 s74, 0x14000
  buffer_load_dwordx4 a[72:75], v112, s[8:11], s74 offen
  s_mov_b32 s74, 0x16000
  buffer_load_dwordx4 a[76:79], v112, s[8:11], s74 offen
  s_mov_b32 s74, 0x18000
  buffer_load_dwordx4 a[80:83], v112, s[8:11], s74 offen
  s_mov_b32 s74, 0x1a000
  buffer_load_dwordx4 a[84:87], v112, s[8:11], s74 offen
  s_mov_b32 s74, 0x1c000
  buffer_load_dwordx4 a[88:91], v112, s[8:11], s74 offen
  s_mov_b32 s74, 0x1e000
  buffer_load_dwordx4 a[92:95], v112, s[8:11], s74 offen
  s_mov_b32 s12, s34
  s_and_b32 s13, s35, 0xffff
  s_mov_b32 s14, 0x400000
  s_mov_b32 s15, 0x20000
  s_mov_b32 s74, 0x10080
  buffer_load_dwordx4 a[96:99], v112, s[12:15], s74 offen
  s_mov_b32 s74, 0x12080
  buffer_load_dwordx4 a[100:103], v112, s[12:15], s74 offen
  s_mov_b32 s74, 0x14080
  buffer_load_dwordx4 a[104:107], v112, s[12:15], s74 offen
  s_mov_b32 s74, 0x16080
  buffer_load_dwordx4 a[108:111], v112, s[12:15], s74 offen
  s_mov_b32 s74, 0x18080
  buffer_load_dwordx4 a[112:115], v112, s[12:15], s74 offen
  s_mov_b32 s74, 0x1a080
  buffer_load_dwordx4 a[116:119], v112, s[12:15], s74 offen
  s_mov_b32 s74, 0x1c080
  buffer_load_dwordx4 a[120:123], v112, s[12:15], s74 offen
  s_mov_b32 s74, 0x1e080
  buffer_load_dwordx4 a[124:127], v112, s[12:15], s74 offen
  s_waitcnt vmcnt(24)
  ds_write_b128 v107, a[0:3] offset:0
  ds_write_b128 v107, a[4:7] offset:1024
  ds_write_b128 v107, a[8:11] offset:2048
  ds_write_b128 v107, a[12:15] offset:3072
  ds_write_b128 v107, a[16:19] offset:4096
  ds_write_b128 v107, a[20:23] offset:5120
  ds_write_b128 v107, a[24:27] offset:6144
  ds_write_b128 v107, a[28:31] offset:7168
  s_waitcnt lgkmcnt(0)
  ds_read_b64_tr_b16 a[0:1], v108 offset:0
  ds_read_b64_tr_b16 a[2:3], v108 offset:2048
  ds_read_b64_tr_b16 a[4:5], v108 offset:4096
  ds_read_b64_tr_b16 a[6:7], v108 offset:6144
  v_xor_b32 v15, 32, v108
  ds_read_b64_tr_b16 a[8:9], v15 offset:0
  ds_read_b64_tr_b16 a[10:11], v15 offset:2048
  ds_read_b64_tr_b16 a[12:13], v15 offset:4096
  ds_read_b64_tr_b16 a[14:15], v15 offset:6144
  s_waitcnt lgkmcnt(0)
  v_xor_b32 v15, 64, v108
  ds_read_b64_tr_b16 a[16:17], v15 offset:0
  ds_read_b64_tr_b16 a[18:19], v15 offset:2048
  ds_read_b64_tr_b16 a[20:21], v15 offset:4096
  ds_read_b64_tr_b16 a[22:23], v15 offset:6144
  v_xor_b32 v15, 96, v108
  ds_read_b64_tr_b16 a[24:25], v15 offset:0
  ds_read_b64_tr_b16 a[26:27], v15 offset:2048
  ds_read_b64_tr_b16 a[28:29], v15 offset:4096
  ds_read_b64_tr_b16 a[30:31], v15 offset:6144
  s_waitcnt lgkmcnt(0)
  s_waitcnt vmcnt(16)
  ds_write_b128 v107, a[32:35] offset:0
  ds_write_b128 v107, a[36:39] offset:1024
  ds_write_b128 v107, a[40:43] offset:2048
  ds_write_b128 v107, a[44:47] offset:3072
  ds_write_b128 v107, a[48:51] offset:4096
  ds_write_b128 v107, a[52:55] offset:5120
  ds_write_b128 v107, a[56:59] offset:6144
  ds_write_b128 v107, a[60:63] offset:7168
  s_waitcnt lgkmcnt(0)
  ds_read_b64_tr_b16 a[32:33], v108 offset:0
  ds_read_b64_tr_b16 a[34:35], v108 offset:2048
  ds_read_b64_tr_b16 a[36:37], v108 offset:4096
  ds_read_b64_tr_b16 a[38:39], v108 offset:6144
  v_xor_b32 v15, 32, v108
  ds_read_b64_tr_b16 a[40:41], v15 offset:0
  ds_read_b64_tr_b16 a[42:43], v15 offset:2048
  ds_read_b64_tr_b16 a[44:45], v15 offset:4096
  ds_read_b64_tr_b16 a[46:47], v15 offset:6144
  s_waitcnt lgkmcnt(0)
  v_xor_b32 v15, 64, v108
  ds_read_b64_tr_b16 a[48:49], v15 offset:0
  ds_read_b64_tr_b16 a[50:51], v15 offset:2048
  ds_read_b64_tr_b16 a[52:53], v15 offset:4096
  ds_read_b64_tr_b16 a[54:55], v15 offset:6144
  v_xor_b32 v15, 96, v108
  ds_read_b64_tr_b16 a[56:57], v15 offset:0
  ds_read_b64_tr_b16 a[58:59], v15 offset:2048
  ds_read_b64_tr_b16 a[60:61], v15 offset:4096
  ds_read_b64_tr_b16 a[62:63], v15 offset:6144
  s_waitcnt lgkmcnt(0)
  s_waitcnt vmcnt(8)
  ds_write_b128 v107, a[64:67] offset:0
  ds_write_b128 v107, a[68:71] offset:1024
  ds_write_b128 v107, a[72:75] offset:2048
  ds_write_b128 v107, a[76:79] offset:3072
  ds_write_b128 v107, a[80:83] offset:4096
  ds_write_b128 v107, a[84:87] offset:5120
  ds_write_b128 v107, a[88:91] offset:6144
  ds_write_b128 v107, a[92:95] offset:7168
  s_waitcnt lgkmcnt(0)
  ds_read_b64_tr_b16 a[64:65], v108 offset:0
  ds_read_b64_tr_b16 a[66:67], v108 offset:2048
  ds_read_b64_tr_b16 a[68:69], v108 offset:4096
  ds_read_b64_tr_b16 a[70:71], v108 offset:6144
  v_xor_b32 v15, 32, v108
  ds_read_b64_tr_b16 a[72:73], v15 offset:0
  ds_read_b64_tr_b16 a[74:75], v15 offset:2048
  ds_read_b64_tr_b16 a[76:77], v15 offset:4096
  ds_read_b64_tr_b16 a[78:79], v15 offset:6144
  s_waitcnt lgkmcnt(0)
  v_xor_b32 v15, 64, v108
  ds_read_b64_tr_b16 a[80:81], v15 offset:0
  ds_read_b64_tr_b16 a[82:83], v15 offset:2048
  ds_read_b64_tr_b16 a[84:85], v15 offset:4096
  ds_read_b64_tr_b16 a[86:87], v15 offset:6144
  v_xor_b32 v15, 96, v108
  ds_read_b64_tr_b16 a[88:89], v15 offset:0
  ds_read_b64_tr_b16 a[90:91], v15 offset:2048
  ds_read_b64_tr_b16 a[92:93], v15 offset:4096
  ds_read_b64_tr_b16 a[94:95], v15 offset:6144
  s_waitcnt lgkmcnt(0)
  s_waitcnt vmcnt(0)
  ds_write_b128 v107, a[96:99] offset:0
  ds_write_b128 v107, a[100:103] offset:1024
  ds_write_b128 v107, a[104:107] offset:2048
  ds_write_b128 v107, a[108:111] offset:3072
  ds_write_b128 v107, a[112:115] offset:4096
  ds_write_b128 v107, a[116:119] offset:5120
  ds_write_b128 v107, a[120:123] offset:6144
  ds_write_b128 v107, a[124:127] offset:7168
  s_waitcnt lgkmcnt(0)
  ds_read_b64_tr_b16 a[96:97], v108 offset:0
  ds_read_b64_tr_b16 a[98:99], v108 offset:2048
  ds_read_b64_tr_b16 a[100:101], v108 offset:4096
  ds_read_b64_tr_b16 a[102:103], v108 offset:6144
  v_xor_b32 v15, 32, v108
  ds_read_b64_tr_b16 a[104:105], v15 offset:0
  ds_read_b64_tr_b16 a[106:107], v15 offset:2048
  ds_read_b64_tr_b16 a[108:109], v15 offset:4096
  ds_read_b64_tr_b16 a[110:111], v15 offset:6144
  s_waitcnt lgkmcnt(0)
  v_xor_b32 v15, 64, v108
  ds_read_b64_tr_b16 a[112:113], v15 offset:0
  ds_read_b64_tr_b16 a[114:115], v15 offset:2048
  ds_read_b64_tr_b16 a[116:117], v15 offset:4096
  ds_read_b64_tr_b16 a[118:119], v15 offset:6144
  v_xor_b32 v15, 96, v108
  ds_read_b64_tr_b16 a[120:121], v15 offset:0
  ds_read_b64_tr_b16 a[122:123], v15 offset:2048
  ds_read_b64_tr_b16 a[124:125], v15 offset:4096
  ds_read_b64_tr_b16 a[126:127], v15 offset:6144
  s_waitcnt lgkmcnt(0)
  v_mov_b32 v2, v1
  s_lshr_b32 s72, s54, 1
  s_lshl_b32 s72, s72, 10
  s_and_b32 s73, s54, 1
  s_lshl_b32 s73, s73, 3
  s_add_u32 s72, s72, s73
  s_add_u32 s72, s72, 0x8000
  v_add_u32 v3, s72, v1
  v_add_u32 v4, 0x8000, v1
  s_and_b32 s72, s54, 1
  s_lshl_b32 s72, s72, 12
  s_lshr_b32 s73, s54, 1
  s_lshl_b32 s73, s73, 11
  s_add_u32 s72, s72, s73
  s_add_u32 s72, s72, 0x9000
  v_add_u32 v5, s72, v1
  s_lshl_b32 s72, s54, 17
  s_lshl_b32 s73, s52, 10
  s_add_u32 s72, s72, s73
  v_add_u32 v6, s72, v1
  v_lshrrev_b32 v7, 4, v0
  v_and_b32 v7, 3, v7
  v_lshlrev_b32 v7, 10, v7
  v_and_b32 v127, 15, v0
  v_lshlrev_b32 v127, 4, v127
  v_add_u32 v7, v7, v127
  s_lshl_b32 s72, s54, 8
  s_lshl_b32 s73, s52, 15
  s_add_u32 s72, s72, s73
  v_add_u32 v7, s72, v7
  v_and_b32 v8, 15, v0
  v_lshlrev_b32 v8, 10, v8
  v_lshrrev_b32 v127, 4, v0
  v_and_b32 v127, 1, v127
  v_lshlrev_b32 v127, 5, v127
  v_add_u32 v8, v8, v127
  s_lshr_b32 s72, s52, 4
  s_lshl_b32 s72, s72, 14
  s_and_b32 s73, s52, 15
  s_lshl_b32 s73, s73, 6
  s_add_u32 s72, s72, s73
  s_lshl_b32 s73, s54, 3
  s_add_u32 s72, s72, s73
  v_add_u32 v8, s72, v8
  v_and_b32 v15, 1, v0
  v_lshlrev_b32 v15, 4, v15
  v_mov_b32 v12, 0x3f80
  v_lshlrev_b32 v12, v15, v12
  v_lshrrev_b32 v15, 1, v0
  v_and_b32 v15, 7, v15
  v_cmp_eq_u32 vcc, 0, v15
  s_nop 1
  v_cndmask_b32 v16, 0, v12, vcc
  v_cmp_eq_u32 vcc, 1, v15
  s_nop 1
  v_cndmask_b32 v17, 0, v12, vcc
  v_cmp_eq_u32 vcc, 2, v15
  s_nop 1
  v_cndmask_b32 v18, 0, v12, vcc
  v_cmp_eq_u32 vcc, 3, v15
  s_nop 1
  v_cndmask_b32 v19, 0, v12, vcc
  v_and_b32 v12, 15, v0
  s_and_b32 s72, s54, 1
  s_lshl_b32 s72, s72, 4
  v_add_u32 v12, s72, v12
  v_lshrrev_b32 v13, 4, v0
  v_and_b32 v13, 3, v13
  v_lshlrev_b32 v13, 2, v13
  v_add_u32 v14, 0, v13
  v_cmp_le_u32 s[80:81], v14, v12
  v_add_u32 v14, 1, v13
  v_cmp_le_u32 s[82:83], v14, v12
  v_add_u32 v14, 2, v13
  v_cmp_le_u32 s[84:85], v14, v12
  v_add_u32 v14, 3, v13
  v_cmp_le_u32 s[86:87], v14, v12
  v_add_u32 v14, 16, v13
  v_cmp_le_u32 s[88:89], v14, v12
  v_add_u32 v14, 17, v13
  v_cmp_le_u32 s[90:91], v14, v12
  v_add_u32 v14, 18, v13
  v_cmp_le_u32 s[92:93], v14, v12
  v_add_u32 v14, 19, v13
  v_cmp_le_u32 s[94:95], v14, v12
  s_sub_u32 s56, s53, 3
  s_lshl_b32 s59, s56, 21
  s_add_u32 s59, s59, 0x4300000
  s_add_u32 s60, s59, 0x100000
  s_lshl_b32 s58, s53, 7
  s_add_u32 s58, s58, 0x42d7400
  s_mov_b32 s57, 0
  s_mov_b32 s64, 0x3e0293ee
  s_mov_b32 s67, 0xbfb8aa3b
  s_waitcnt vmcnt(0) lgkmcnt(0)
  s_barrier
  v_lshlrev_b32 v127, 3, v0
  s_mov_b32 s73, 0x42d0000
L_tl_x0_s:
  buffer_load_dwordx2 v[12:13], v127, s[4:7], s73 offen sc1
  s_waitcnt vmcnt(0)
  v_min_u32 v12, v12, v13
  v_cmp_eq_u32 vcc, 0, v12
  s_nop 0
  s_cbranch_vccz L_tl_x0_s_ok
  s_sub_u32 s70, s70, 16
  s_cselect_b32 s70, 0, s70
  s_cbranch_scc1 L_tl_x0_s_ok
  s_sleep 8
  s_branch L_tl_x0_s
L_tl_x0_s_ok:
  s_lshl_b32 s73, s56, 15
  s_lshl_b32 s74, s54, 13
  s_add_u32 s73, s73, s74
  s_add_u32 m0, s74, 0
  s_add_u32 s72, s73, 0
  buffer_load_dwordx4 v1, s[4:7], s72 offen sc1 lds
  s_add_u32 m0, s74, 1024
  s_add_u32 s72, s73, 1024
  buffer_load_dwordx4 v1, s[4:7], s72 offen sc1 lds
  s_add_u32 m0, s74, 2048
  s_add_u32 s72, s73, 2048
  buffer_load_dwordx4 v1, s[4:7], s72 offen sc1 lds
  s_add_u32 m0, s74, 3072
  s_add_u32 s72, s73, 3072
  buffer_load_dwordx4 v1, s[4:7], s72 offen sc1 lds
  s_add_u32 m0, s74, 4096
  s_add_u32 s72, s73, 4096
  buffer_load_dwordx4 v1, s[4:7], s72 offen sc1 lds
  s_add_u32 m0, s74, 5120
  s_add_u32 s72, s73, 5120
  buffer_load_dwordx4 v1, s[4:7], s72 offen sc1 lds
  s_add_u32 m0, s74, 6144
  s_add_u32 s72, s73, 6144
  buffer_load_dwordx4 v1, s[4:7], s72 offen sc1 lds
  s_add_u32 m0, s74, 7168
  s_add_u32 s72, s73, 7168
  buffer_load_dwordx4 v1, s[4:7], s72 offen sc1 lds
L_tl_loop_s:
  s_waitcnt vmcnt(0)
  s_barrier
  s_cmp_lt_u32 s52, 28
  s_cbranch_scc0 L_tl_noffn_s
  ds_read_b128 v[32:35], v2 offset:0
  ds_read_b128 v[36:39], v2 offset:16384
  ds_read_b128 v[40:43], v2 offset:1024
  ds_read_b128 v[44:47], v2 offset:17408
  s_waitcnt lgkmcnt(3)
  v_mfma_f32_16x16x32_bf16 v[48:51], a[192:195], v[32:35], 0
  ds_read_b128 v[32:35], v2 offset:2048
  s_waitcnt lgkmcnt(3)
  v_mfma_f32_16x16x32_bf16 v[52:55], a[192:195], v[36:39], 0
  ds_read_b128 v[36:39], v2 offset:18432
  s_waitcnt lgkmcnt(3)
  v_mfma_f32_16x16x32_bf16 v[48:51], a[196:199], v[40:43], v[48:51]
  ds_read_b128 v[40:43], v2 offset:3072
  s_waitcnt lgkmcnt(3)
  v_mfma_f32_16x16x32_bf16 v[52:55], a[196:199], v[44:47], v[52:55]
  ds_read_b128 v[44:47], v2 offset:19456
  s_waitcnt lgkmcnt(3)
  v_mfma_f32_16x16x32_bf16 v[48:51], a[200:203], v[32:35], v[48:51]
  ds_read_b128 v[32:35], v2 offset:4096
  s_waitcnt lgkmcnt(3)
  v_mfma_f32_16x16x32_bf16 v[52:55], a[200:203], v[36:39], v[52:55]
  ds_read_b128 v[36:39], v2 offset:20480
  s_waitcnt lgkmcnt(3)
  v_mfma_f32_16x16x32_bf16 v[48:51], a[204:207], v[40:43], v[48:51]
  ds_read_b128 v[40:43], v2 offset:5120
  s_waitcnt lgkmcnt(3)
  v_mfma_f32_16x16x32_bf16 v[52:55], a[204:207], v[44:47], v[52:55]
  ds_read_b128 v[44:47], v2 offset:21504
  s_waitcnt lgkmcnt(3)
  v_mfma_f32_16x16x32_bf16 v[48:51], a[208:211], v[32:35], v[48:51]
  ds_read_b128 v[32:35], v2 offset:6144
  s_waitcnt lgkmcnt(3)
  v_mfma_f32_16x16x32_bf16 v[52:55], a[208:211], v[36:39], v[52:55]
  ds_read_b128 v[36:39], v2 offset:22528
  s_waitcnt lgkmcnt(3)
  v_mfma_f32_16x16x32_bf16 v[48:51], a[212:215], v[40:43], v[48:51]
  ds_read_b128 v[40:43], v2 offset:7168
  s_waitcnt lgkmcnt(3)
  v_mfma_f32_16x16x32_bf16 v[52:55], a[212:215], v[44:47], v[52:55]
  ds_read_b128 v[44:47], v2 offset:23552
  s_waitcnt lgkmcnt(3)
  v_mfma_f32_16x16x32_bf16 v[48:51], a[216:219], v[32:35], v[48:51]
  ds_read_b128 v[32:35], v2 offset:8192
  s_waitcnt lgkmcnt(3)
  v_mfma_f32_16x16x32_bf16 v[52:55], a[216:219], v[36:39], v[52:55]
  ds_read_b128 v[36:39], v2 offset:24576
  s_waitcnt lgkmcnt(3)
  v_mfma_f32_16x16x32_bf16 v[48:51], a[220:223], v[40:43], v[48:51]
  ds_read_b128 v[40:43], v2 offset:9216
  s_waitcnt lgkmcnt(3)
  v_mfma_f32_16x16x32_bf16 v[52:55], a[220:223], v[44:47], v[52:55]
  ds_read_b128 v[44:47], v2 offset:25600
  s_waitcnt lgkmcnt(3)
  v_mfma_f32_16x16x32_bf16 v[48:51], a[224:227], v[32:35], v[48:51]
  ds_read_b128 v[32:35], v2 offset:10240
  s_waitcnt lgkmcnt(3)
  v_mfma_f32_16x16x32_bf16 v[52:55], a[224:227], v[36:39], v[52:55]
  ds_read_b128 v[36:39], v2 offset:26624
  s_waitcnt lgkmcnt(3)
  v_mfma_f32_16x16x32_bf16 v[48:51], a[228:231], v[40:43], v[48:51]
  ds_read_b128 v[40:43], v2 offset:11264
  s_waitcnt lgkmcnt(3)
  v_mfma_f32_16x16x32_bf16 v[52:55], a[228:231], v[44:47], v[52:55]
  ds_read_b128 v[44:47], v2 offset:27648
  s_waitcnt lgkmcnt(3)
  v_mfma_f32_16x16x32_bf16 v[48:51], a[232:235], v[32:35], v[48:51]
  ds_read_b128 v[32:35], v2 offset:12288
  s_waitcnt lgkmcnt(3)
  v_mfma_f32_16x16x32_bf16 v[52:55], a[232:235], v[36:39], v[52:55]
  ds_read_b128 v[36:39], v2 offset:28672
  s_waitcnt lgkmcnt(3)
  v_mfma_f32_16x16x32_bf16 v[48:51], a[236:239], v[40:43], v[48:51]
  ds_read_b128 v[40:43], v2 offset:13312
  s_waitcnt lgkmcnt(3)
  v_mfma_f32_16x16x32_bf16 v[52:55], a[236:239], v[44:47], v[52:55]
  ds_read_b128 v[44:47], v2 offset:29696
  s_waitcnt lgkmcnt(3)
  v_mfma_f32_16x16x32_bf16 v[48:51], a[240:243], v[32:35], v[48:51]
  ds_read_b128 v[32:35], v2 offset:14336
  s_waitcnt lgkmcnt(3)
  v_mfma_f32_16x16x32_bf16 v[52:55], a[240:243], v[36:39], v[52:55]
  ds_read_b128 v[36:39], v2 offset:30720
  s_waitcnt lgkmcnt(3)
  v_mfma_f32_16x16x32_bf16 v[48:51], a[244:247], v[40:43], v[48:51]
  ds_read_b128 v[40:43], v2 offset:15360
  s_waitcnt lgkmcnt(3)
  v_mfma_f32_16x16x32_bf16 v[52:55], a[244:247], v[44:47], v[52:55]
  ds_read_b128 v[44:47], v2 offset:31744
  s_waitcnt lgkmcnt(3)
  v_mfma_f32_16x16x32_bf16 v[48:51], a[248:251], v[32:35], v[48:51]
  s_waitcnt lgkmcnt(2)
  v_mfma_f32_16x16x32_bf16 v[52:55], a[248:251], v[36:39], v[52:55]
  s_waitcnt lgkmcnt(1)
  v_mfma_f32_16x16x32_bf16 v[48:51], a[252:255], v[40:43], v[48:51]
  s_waitcnt lgkmcnt(0)
  v_mfma_f32_16x16x32_bf16 v[52:55], a[252:255], v[44:47], v[52:55]
  s_nop 5
  v_cvt_pk_bf16_f32 v88, v48, v48
  v_lshlrev_b32 v48, 16, v88
  v_cvt_pk_bf16_f32 v89, v49, v49
  v_lshlrev_b32 v49, 16, v89
  v_cvt_pk_bf16_f32 v90, v50, v50
  v_lshlrev_b32 v50, 16, v90
  v_cvt_pk_bf16_f32 v91, v51, v51
  v_lshlrev_b32 v51, 16, v91
  v_cvt_pk_bf16_f32 v92, v52, v52
  v_lshlrev_b32 v52, 16, v92
  v_cvt_pk_bf16_f32 v93, v53, v53
  v_lshlrev_b32 v53, 16, v93
  v_cvt_pk_bf16_f32 v94, v54, v54
  v_lshlrev_b32 v54, 16, v94
  v_cvt_pk_bf16_f32 v95, v55, v55
  v_lshlrev_b32 v55, 16, v95
  v_add_f32 v48, v48, v20
  v_add_f32 v49, v49, v21
  v_add_f32 v50, v50, v22
  v_add_f32 v51, v51, v23
  v_add_f32 v52, v52, v20
  v_add_f32 v53, v53, v21
  v_add_f32 v54, v54, v22
  v_add_f32 v55, v55, v23
  v_cvt_pk_bf16_f32 v88, v48, v48
  v_lshlrev_b32 v48, 16, v88
  v_cvt_pk_bf16_f32 v89, v49, v49
  v_lshlrev_b32 v49, 16, v89
  v_cvt_pk_bf16_f32 v90, v50, v50
  v_lshlrev_b32 v50, 16, v90
  v_cvt_pk_bf16_f32 v91, v51, v51
  v_lshlrev_b32 v51, 16, v91
  v_cvt_pk_bf16_f32 v92, v52, v52
  v_lshlrev_b32 v52, 16, v92
  v_cvt_pk_bf16_f32 v93, v53, v53
  v_lshlrev_b32 v53, 16, v93
  v_cvt_pk_bf16_f32 v94, v54, v54
  v_lshlrev_b32 v54, 16, v94
  v_cvt_pk_bf16_f32 v95, v55, v55
  v_lshlrev_b32 v55, 16, v95
  v_mul_f32_e64 v88, |v48|, s67
  v_mul_f32_e64 v89, |v49|, s67
  v_mul_f32_e64 v90, |v50|, s67
  v_mul_f32_e64 v91, |v51|, s67
  v_mul_f32_e64 v92, |v52|, s67
  v_mul_f32_e64 v93, |v53|, s67
  v_mul_f32_e64 v94, |v54|, s67
  v_mul_f32_e64 v95, |v55|, s67
  v_exp_f32 v88, v88
  v_exp_f32 v89, v89
  v_exp_f32 v90, v90
  v_exp_f32 v91, v91
  v_exp_f32 v92, v92
  v_exp_f32 v93, v93
  v_exp_f32 v94, v94
  v_exp_f32 v95, v95
  v_mul_f32 v96, v88, v88
  v_fma_f32 v104, v88, 2.0, 1.0
  v_fma_f32 v88, v88, 2.0, v96
  v_cmp_lt_f32 vcc, 0, v48
  s_nop 1
  v_cndmask_b32 v80, v88, v104, vcc
  v_fma_f32 v104, v96, 2.0, v104
  v_add_f32 v88, 2.0, v88
  v_cndmask_b32 v88, v88, v104, vcc
  v_mul_f32 v97, v89, v89
  v_fma_f32 v105, v89, 2.0, 1.0
  v_fma_f32 v89, v89, 2.0, v97
  v_cmp_lt_f32 vcc, 0, v49
  s_nop 1
  v_cndmask_b32 v81, v89, v105, vcc
  v_fma_f32 v105, v97, 2.0, v105
  v_add_f32 v89, 2.0, v89
  v_cndmask_b32 v89, v89, v105, vcc
  v_mul_f32 v98, v90, v90
  v_fma_f32 v106, v90, 2.0, 1.0
  v_fma_f32 v90, v90, 2.0, v98
  v_cmp_lt_f32 vcc, 0, v50
  s_nop 1
  v_cndmask_b32 v82, v90, v106, vcc
  v_fma_f32 v106, v98, 2.0, v106
  v_add_f32 v90, 2.0, v90
  v_cndmask_b32 v90, v90, v106, vcc
  v_mul_f32 v99, v91, v91
  v_fma_f32 v107, v91, 2.0, 1.0
  v_fma_f32 v91, v91, 2.0, v99
  v_cmp_lt_f32 vcc, 0, v51
  s_nop 1
  v_cndmask_b32 v83, v91, v107, vcc
  v_fma_f32 v107, v99, 2.0, v107
  v_add_f32 v91, 2.0, v91
  v_cndmask_b32 v91, v91, v107, vcc
  v_mul_f32 v100, v92, v92
  v_fma_f32 v108, v92, 2.0, 1.0
  v_fma_f32 v92, v92, 2.0, v100
  v_cmp_lt_f32 vcc, 0, v52
  s_nop 1
  v_cndmask_b32 v84, v92, v108, vcc
  v_fma_f32 v108, v100, 2.0, v108
  v_add_f32 v92, 2.0, v92
  v_cndmask_b32 v92, v92, v108, vcc
  v_mul_f32 v101, v93, v93
  v_fma_f32 v109, v93, 2.0, 1.0
  v_fma_f32 v93, v93, 2.0, v101
  v_cmp_lt_f32 vcc, 0, v53
  s_nop 1
  v_cndmask_b32 v85, v93, v109, vcc
  v_fma_f32 v109, v101, 2.0, v109
  v_add_f32 v93, 2.0, v93
  v_cndmask_b32 v93, v93, v109, vcc
  v_mul_f32 v102, v94, v94
  v_fma_f32 v110, v94, 2.0, 1.0
  v_fma_f32 v94, v94, 2.0, v102
  v_cmp_lt_f32 vcc, 0, v54
  s_nop 1
  v_cndmask_b32 v86, v94, v110, vcc
  v_fma_f32 v110, v102, 2.0, v110
  v_add_f32 v94, 2.0, v94
  v_cndmask_b32 v94, v94, v110, vcc
  v_mul_f32 v103, v95, v95
  v_fma_f32 v111, v95, 2.0, 1.0
  v_fma_f32 v95, v95, 2.0, v103
  v_cmp_lt_f32 vcc, 0, v55
  s_nop 1
  v_cndmask_b32 v87, v95, v111, vcc
  v_fma_f32 v111, v103, 2.0, v111
  v_add_f32 v95, 2.0, v95
  v_cndmask_b32 v95, v95, v111, vcc
  v_rcp_f32 v88, v88
  v_rcp_f32 v89, v89
  v_rcp_f32 v90, v90
  v_rcp_f32 v91, v91
  v_rcp_f32 v92, v92
  v_rcp_f32 v93, v93
  v_rcp_f32 v94, v94
  v_rcp_f32 v95, v95
  v_mul_f32 v80, v80, v88
  v_mul_f32 v81, v81, v89
  v_mul_f32 v82, v82, v90
  v_mul_f32 v83, v83, v91
  v_mul_f32 v84, v84, v92
  v_mul_f32 v85, v85, v93
  v_mul_f32 v86, v86, v94
  v_mul_f32 v87, v87, v95
  v_mul_f32 v80, v80, v48
  v_mul_f32 v81, v81, v49
  v_mul_f32 v82, v82, v50
  v_mul_f32 v83, v83, v51
  v_mul_f32 v84, v84, v52
  v_mul_f32 v85, v85, v53
  v_mul_f32 v86, v86, v54
  v_mul_f32 v87, v87, v55
  v_cvt_pk_bf16_f32 v88, v80, v81
  v_cvt_pk_bf16_f32 v89, v82, v83
  ds_write_b64 v3, v[88:89] offset:0
  v_cvt_pk_bf16_f32 v90, v84, v85
  v_cvt_pk_bf16_f32 v91, v86, v87
  ds_write_b64 v3, v[90:91] offset:2048
  s_waitcnt lgkmcnt(0)
  s_barrier
  ds_read_b128 v[56:59], v4 offset:0
  ds_read_b128 v[60:63], v4 offset:1024
  ds_read_b128 v[64:67], v4 offset:2048
  ds_read_b128 v[68:71], v4 offset:3072
  s_waitcnt lgkmcnt(3)
  v_mfma_f32_16x16x32_bf16 v[128:131], a[128:131], v[56:59], 0
  s_waitcnt lgkmcnt(2)
  v_mfma_f32_16x16x32_bf16 v[128:131], a[132:135], v[60:63], v[128:131]
  s_waitcnt lgkmcnt(1)
  v_mfma_f32_16x16x32_bf16 v[132:135], a[128:131], v[64:67], 0
  s_waitcnt lgkmcnt(0)
  v_mfma_f32_16x16x32_bf16 v[132:135], a[132:135], v[68:71], v[132:135]
  v_mfma_f32_16x16x32_bf16 v[136:139], a[136:139], v[56:59], 0
  v_mfma_f32_16x16x32_bf16 v[136:139], a[140:143], v[60:63], v[136:139]
  v_mfma_f32_16x16x32_bf16 v[140:143], a[136:139], v[64:67], 0
  v_mfma_f32_16x16x32_bf16 v[140:143], a[140:143], v[68:71], v[140:143]
  v_mfma_f32_16x16x32_bf16 v[144:147], a[144:147], v[56:59], 0
  v_mfma_f32_16x16x32_bf16 v[144:147], a[148:151], v[60:63], v[144:147]
  v_mfma_f32_16x16x32_bf16 v[148:151], a[144:147], v[64:67], 0
  v_mfma_f32_16x16x32_bf16 v[148:151], a[148:151], v[68:71], v[148:151]
  v_mfma_f32_16x16x32_bf16 v[152:155], a[152:155], v[56:59], 0
  v_mfma_f32_16x16x32_bf16 v[152:155], a[156:159], v[60:63], v[152:155]
  v_mfma_f32_16x16x32_bf16 v[156:159], a[152:155], v[64:67], 0
  v_mfma_f32_16x16x32_bf16 v[156:159], a[156:159], v[68:71], v[156:159]
  v_mfma_f32_16x16x32_bf16 v[160:163], a[160:163], v[56:59], 0
  v_mfma_f32_16x16x32_bf16 v[160:163], a[164:167], v[60:63], v[160:163]
  v_mfma_f32_16x16x32_bf16 v[164:167], a[160:163], v[64:67], 0
  v_mfma_f32_16x16x32_bf16 v[164:167], a[164:167], v[68:71], v[164:167]
  v_mfma_f32_16x16x32_bf16 v[168:171], a[168:171], v[56:59], 0
  v_mfma_f32_16x16x32_bf16 v[168:171], a[172:175], v[60:63], v[168:171]
  v_mfma_f32_16x16x32_bf16 v[172:175], a[168:171], v[64:67], 0
  v_mfma_f32_16x16x32_bf16 v[172:175], a[172:175], v[68:71], v[172:175]
  v_mfma_f32_16x16x32_bf16 v[176:179], a[176:179], v[56:59], 0
  v_mfma_f32_16x16x32_bf16 v[176:179], a[180:183], v[60:63], v[176:179]
  v_mfma_f32_16x16x32_bf16 v[180:183], a[176:179], v[64:67], 0
  v_mfma_f32_16x16x32_bf16 v[180:183], a[180:183], v[68:71], v[180:183]
  v_mfma_f32_16x16x32_bf16 v[184:187], a[184:187], v[56:59], 0
  v_mfma_f32_16x16x32_bf16 v[184:187], a[188:191], v[60:63], v[184:187]
  v_mfma_f32_16x16x32_bf16 v[188:191], a[184:187], v[64:67], 0
  v_mfma_f32_16x16x32_bf16 v[188:191], a[188:191], v[68:71], v[188:191]
  v_cvt_pk_bf16_f32 v72, v128, v129
  v_cvt_pk_bf16_f32 v73, v130, v131
  v_cvt_pk_bf16_f32 v74, v136, v137
  v_cvt_pk_bf16_f32 v75, v138, v139
  s_add_u32 s72, s59, 0
  buffer_store_dwordx4 v[72:75], v6, s[4:7], s72 offen sc1
  v_cvt_pk_bf16_f32 v76, v144, v145
  v_cvt_pk_bf16_f32 v77, v146, v147
  v_cvt_pk_bf16_f32 v78, v152, v153
  v_cvt_pk_bf16_f32 v79, v154, v155
  s_add_u32 s72, s59, 32768
  buffer_store_dwordx4 v[76:79], v6, s[4:7], s72 offen sc1
  v_cvt_pk_bf16_f32 v72, v160, v161
  v_cvt_pk_bf16_f32 v73, v162, v163
  v_cvt_pk_bf16_f32 v74, v168, v169
  v_cvt_pk_bf16_f32 v75, v170, v171
  s_add_u32 s72, s59, 65536
  buffer_store_dwordx4 v[72:75], v6, s[4:7], s72 offen sc1
  v_cvt_pk_bf16_f32 v76, v176, v177
  v_cvt_pk_bf16_f32 v77, v178, v179
  v_cvt_pk_bf16_f32 v78, v184, v185
  v_cvt_pk_bf16_f32 v79, v186, v187
  s_add_u32 s72, s59, 98304
  buffer_store_dwordx4 v[76:79], v6, s[4:7], s72 offen sc1
  v_cvt_pk_bf16_f32 v72, v132, v133
  v_cvt_pk_bf16_f32 v73, v134, v135
  v_cvt_pk_bf16_f32 v74, v140, v141
  v_cvt_pk_bf16_f32 v75, v142, v143
  s_add_u32 s72, s59, 524288
  buffer_store_dwordx4 v[72:75], v6, s[4:7], s72 offen sc1
  v_cvt_pk_bf16_f32 v76, v148, v149
  v_cvt_pk_bf16_f32 v77, v150, v151
  v_cvt_pk_bf16_f32 v78, v156, v157
  v_cvt_pk_bf16_f32 v79, v158, v159
  s_add_u32 s72, s59, 557056
  buffer_store_dwordx4 v[76:79], v6, s[4:7], s72 offen sc1
  v_cvt_pk_bf16_f32 v72, v164, v165
  v_cvt_pk_bf16_f32 v73, v166, v167
  v_cvt_pk_bf16_f32 v74, v172, v173
  v_cvt_pk_bf16_f32 v75, v174, v175
  s_add_u32 s72, s59, 589824
  buffer_store_dwordx4 v[72:75], v6, s[4:7], s72 offen sc1
  v_cvt_pk_bf16_f32 v76, v180, v181
  v_cvt_pk_bf16_f32 v77, v182, v183
  v_cvt_pk_bf16_f32 v78, v188, v189
  v_cvt_pk_bf16_f32 v79, v190, v191
  s_add_u32 s72, s59, 622592
  buffer_store_dwordx4 v[76:79], v6, s[4:7], s72 offen sc1
  s_branch L_tl_ffn_done_s
L_tl_noffn_s:
  s_barrier
L_tl_ffn_done_s:
  s_lshl_b32 s73, s56, 5
  s_add_u32 s73, s73, s52
  s_lshl_b32 s74, s52, 7
  s_add_u32 s66, s74, 0x42d5000
  s_and_b32 s65, s56, 1
  s_lshl_b32 s65, s65, 2
  s_add_u32 s65, s65, s74
  s_add_u32 s65, s65, 0x42d1000
  s_lshr_b32 s68, s56, 1
  s_add_u32 s68, s68, 1
  s_add_u32 s69, s56, 1
  s_lshl_b32 s62, s73, 13
  s_lshl_b32 s63, s73, 12
  s_waitcnt vmcnt(0)
  s_barrier
  s_add_u32 s57, s57, 1
  s_cmp_eq_u32 s54, 0
  s_cbranch_scc0 L_xb_wg_s
  s_lshl_b32 s72, s52, 2
  s_add_u32 s72, s72, s58
  s_mov_b64 exec, 1
  v_mov_b32 v12, 0
  v_mov_b32 v13, s57
  buffer_store_dword v13, v12, s[4:7], s72 offen sc1
  s_mov_b32 exec_lo, -1
  v_lshlrev_b32 v12, 2, v0
L_xb_pg_s:
  buffer_load_dword v13, v12, s[4:7], s58 offen sc1
  s_waitcnt vmcnt(0)
  v_cmp_gt_u32 vcc, s57, v13
  s_nop 0
  s_cbranch_vccz L_xb_okg_s
  s_sleep 1
  s_sub_u32 s70, s70, 1
  s_cbranch_scc0 L_xb_pg_s
  s_mov_b32 s70, 0
L_xb_okg_s:
  s_mov_b64 exec, -1
L_xb_wg_s:
  s_barrier
  s_add_u32 s72, s59, 0
  buffer_load_dwordx4 v[160:163], v7, s[4:7], s72 offen sc1
  s_add_u32 s72, s59, 4096
  buffer_load_dwordx4 v[164:167], v7, s[4:7], s72 offen sc1
  s_add_u32 s72, s59, 8192
  buffer_load_dwordx4 v[168:171], v7, s[4:7], s72 offen sc1
  s_add_u32 s72, s59, 12288
  buffer_load_dwordx4 v[172:175], v7, s[4:7], s72 offen sc1
  s_add_u32 s72, s59, 16384
  buffer_load_dwordx4 v[176:179], v7, s[4:7], s72 offen sc1
  s_add_u32 s72, s59, 20480
  buffer_load_dwordx4 v[180:183], v7, s[4:7], s72 offen sc1
  s_add_u32 s72, s59, 24576
  buffer_load_dwordx4 v[184:187], v7, s[4:7], s72 offen sc1
  s_waitcnt vmcnt(6)
  v_mfma_f32_16x16x32_bf16 v[192:195], v[16:19], v[160:163], 0
  s_waitcnt vmcnt(5)
  v_mfma_f32_16x16x32_bf16 v[192:195], v[16:19], v[164:167], v[192:195]
  s_waitcnt vmcnt(4)
  v_mfma_f32_16x16x32_bf16 v[192:195], v[16:19], v[168:171], v[192:195]
  s_waitcnt vmcnt(3)
  v_mfma_f32_16x16x32_bf16 v[192:195], v[16:19], v[172:175], v[192:195]
  s_waitcnt vmcnt(2)
  v_mfma_f32_16x16x32_bf16 v[192:195], v[16:19], v[176:179], v[192:195]
  s_waitcnt vmcnt(1)
  v_mfma_f32_16x16x32_bf16 v[192:195], v[16:19], v[180:183], v[192:195]
  s_waitcnt vmcnt(0)
  v_mfma_f32_16x16x32_bf16 v[192:195], v[16:19], v[184:187], v[192:195]
  s_nop 7
  v_cvt_pk_bf16_f32 v24, v192, v192
  v_lshlrev_b32 v24, 16, v24
  v_cvt_pk_bf16_f32 v25, v193, v193
  v_lshlrev_b32 v25, 16, v25
  v_cvt_pk_bf16_f32 v26, v194, v194
  v_lshlrev_b32 v26, 16, v26
  v_cvt_pk_bf16_f32 v27, v195, v195
  v_lshlrev_b32 v27, 16, v27
  v_mul_f32 v192, 0xbfb8aa3b, v24
  v_mul_f32 v193, 0xbfb8aa3b, v25
  v_mul_f32 v194, 0xbfb8aa3b, v26
  v_mul_f32 v195, 0xbfb8aa3b, v27
  v_exp_f32 v192, v192
  v_exp_f32 v193, v193
  v_exp_f32 v194, v194
  v_exp_f32 v195, v195
  v_add_f32 v192, 1.0, v192
  v_add_f32 v193, 1.0, v193
  v_add_f32 v194, 1.0, v194
  v_add_f32 v195, 1.0, v195
  v_rcp_f32 v192, v192
  v_rcp_f32 v193, v193
  v_rcp_f32 v194, v194
  v_rcp_f32 v195, v195
  v_mul_f32 v24, v24, v192
  v_mul_f32 v25, v25, v193
  v_mul_f32 v26, v26, v194
  v_mul_f32 v27, v27, v195
  v_cvt_pk_bf16_f32 v24, v24, v24
  v_lshlrev_b32 v24, 16, v24
  v_cvt_pk_bf16_f32 v25, v25, v25
  v_lshlrev_b32 v25, 16, v25
  v_cvt_pk_bf16_f32 v26, v26, v26
  v_lshlrev_b32 v26, 16, v26
  v_cvt_pk_bf16_f32 v27, v27, v27
  v_lshlrev_b32 v27, 16, v27
  s_cmp_eq_u32 s54, 0
  s_cbranch_scc0 L_tl_kv_s_bar
  s_mov_b64 exec, 1
L_tl_kv_s:
  buffer_load_dword v12, off, s[4:7], s65 sc1
  s_waitcnt vmcnt(0)
  v_readfirstlane_b32 s72, v12
  s_nop 3
  s_cmp_ge_u32 s72, s68
  s_cbranch_scc1 L_tl_kv_s_ok
  s_sub_u32 s70, s70, 16
  s_cselect_b32 s70, 0, s70
  s_cbranch_scc1 L_tl_kv_s_ok
  s_sleep 16
  s_branch L_tl_kv_s
L_tl_kv_s_ok:
  s_mov_b64 exec, -1
L_tl_kv_s_bar:
  s_barrier
  s_and_b32 s73, s54, 1
  s_lshl_b32 s73, s73, 12
  s_add_u32 s73, s73, s62
  s_add_u32 s73, s73, 0x1200000
  buffer_load_dwordx4 v[32:35], v1, s[4:7], s73 offen offset:0 sc1
  buffer_load_dwordx4 v[36:39], v1, s[4:7], s73 offen offset:1024 sc1
  buffer_load_dwordx4 v[40:43], v1, s[4:7], s73 offen offset:2048 sc1
  buffer_load_dwordx4 v[44:47], v1, s[4:7], s73 offen offset:3072 sc1
  s_add_u32 s73, s62, 0x200000
  buffer_load_dwordx4 v[48:51], v1, s[4:7], s73 offen offset:0 sc1
  buffer_load_dwordx4 v[52:55], v1, s[4:7], s73 offen offset:1024 sc1
  buffer_load_dwordx4 v[56:59], v1, s[4:7], s73 offen offset:2048 sc1
  buffer_load_dwordx4 v[60:63], v1, s[4:7], s73 offen offset:3072 sc1
  s_add_u32 s73, s73, 4096
  buffer_load_dwordx4 v[64:67], v1, s[4:7], s73 offen offset:0 sc1
  buffer_load_dwordx4 v[68:71], v1, s[4:7], s73 offen offset:1024 sc1
  buffer_load_dwordx4 v[72:75], v1, s[4:7], s73 offen offset:2048 sc1
  buffer_load_dwordx4 v[76:79], v1, s[4:7], s73 offen offset:3072 sc1
  s_lshr_b32 s73, s54, 1
  s_lshl_b32 s73, s73, 12
  s_add_u32 s73, s73, s62
  s_add_u32 s73, s73, 0x2200000
  buffer_load_dwordx4 v[96:99], v1, s[4:7], s73 offen offset:0 sc1
  buffer_load_dwordx4 v[100:103], v1, s[4:7], s73 offen offset:1024 sc1
  buffer_load_dwordx4 v[104:107], v1, s[4:7], s73 offen offset:2048 sc1
  buffer_load_dwordx4 v[108:111], v1, s[4:7], s73 offen offset:3072 sc1
  s_mov_b32 s8, s24
  s_and_b32 s9, s25, 0xffff
  s_mov_b32 s10, 0x200000
  s_mov_b32 s11, 0x20000
  s_lshl_b32 s61, s56, 15
  buffer_load_dwordx2 v[28:29], v8, s[8:11], s61 offen
  s_waitcnt vmcnt(12)
  v_mfma_f32_16x16x32_bf16 v[124:127], v[48:51], v[32:35], 0
  s_waitcnt vmcnt(11)
  v_mfma_f32_16x16x32_bf16 v[124:127], v[52:55], v[36:39], v[124:127]
  s_waitcnt vmcnt(10)
  v_mfma_f32_16x16x32_bf16 v[124:127], v[56:59], v[40:43], v[124:127]
  s_waitcnt vmcnt(9)
  v_mfma_f32_16x16x32_bf16 v[124:127], v[60:63], v[44:47], v[124:127]
  s_waitcnt vmcnt(8)
  v_mfma_f32_16x16x32_bf16 v[128:131], v[64:67], v[32:35], 0
  s_waitcnt vmcnt(7)
  v_mfma_f32_16x16x32_bf16 v[128:131], v[68:71], v[36:39], v[128:131]
  s_waitcnt vmcnt(6)
  v_mfma_f32_16x16x32_bf16 v[128:131], v[72:75], v[40:43], v[128:131]
  s_waitcnt vmcnt(5)
  v_mfma_f32_16x16x32_bf16 v[128:131], v[76:79], v[44:47], v[128:131]
  v_mov_b32 v14, 0xf149f2ca
  v_cndmask_b32 v124, v14, v124, s[80:81]
  v_cndmask_b32 v125, v14, v125, s[82:83]
  v_cndmask_b32 v126, v14, v126, s[84:85]
  v_cndmask_b32 v127, v14, v127, s[86:87]
  s_nop 2
  v_cndmask_b32 v128, v14, v128, s[88:89]
  v_cndmask_b32 v129, v14, v129, s[90:91]
  v_cndmask_b32 v130, v14, v130, s[92:93]
  v_cndmask_b32 v131, v14, v131, s[94:95]
  v_max3_f32 v30, v124, v125, v126
  v_max3_f32 v30, v30, v127, v128
  v_max3_f32 v30, v30, v129, v130
  v_max_f32 v30, v30, v131
  s_waitcnt vmcnt(0)
  s_cmp_eq_u32 s54, 0
  s_cbranch_scc0 L_tl_km_s_bar
  s_mov_b64 exec, 1
L_tl_km_s:
  buffer_load_dword v12, off, s[4:7], s66 sc1
  s_waitcnt vmcnt(0)
  v_readfirstlane_b32 s72, v12
  s_nop 3
  s_cmp_ge_u32 s72, s69
  s_cbranch_scc1 L_tl_km_s_ok
  s_sub_u32 s70, s70, 16
  s_cselect_b32 s70, 0, s70
  s_cbranch_scc1 L_tl_km_s_ok
  s_sleep 4
  s_branch L_tl_km_s
L_tl_km_s_ok:
  s_mov_b64 exec, -1
L_tl_km_s_bar:
  s_barrier
  s_add_u32 s73, s63, 0x3200000
  buffer_load_dwordx4 v[80:83], v1, s[4:7], s73 offen offset:0 sc1
  buffer_load_dwordx4 v[84:87], v1, s[4:7], s73 offen offset:1024 sc1
  buffer_load_dwordx4 v[88:91], v1, s[4:7], s73 offen offset:2048 sc1
  buffer_load_dwordx4 v[92:95], v1, s[4:7], s73 offen offset:3072 sc1
  s_lshr_b32 s73, s54, 1
  s_lshl_b32 s73, s73, 11
  s_add_u32 s73, s73, s63
  s_add_u32 s73, s73, 0x3a00000
  buffer_load_dwordx4 v[112:115], v1, s[4:7], s73 offen offset:0 sc1
  buffer_load_dwordx4 v[116:119], v1, s[4:7], s73 offen offset:1024 sc1
  s_waitcnt vmcnt(0)
  v_mfma_f32_16x16x32_bf16 v[120:123], v[80:83], v[32:35], 0
  v_mfma_f32_16x16x32_bf16 v[120:123], v[84:87], v[36:39], v[120:123]
  v_mfma_f32_16x16x32_bf16 v[120:123], v[88:91], v[40:43], v[120:123]
  v_mfma_f32_16x16x32_bf16 v[120:123], v[92:95], v[44:47], v[120:123]
  s_nop 7
  v_max3_f32 v12, v30, v120, v121
  v_mov_b32 v13, v12
  s_nop 1
  v_permlane16_swap_b32 v12, v13
  v_max_f32 v12, v12, v13
  v_mov_b32 v13, v12
  s_nop 1
  v_permlane32_swap_b32 v12, v13
  v_max_f32 v12, v12, v13
  v_mul_f32 v12, s64, v12
  v_fma_f32 v124, v124, s64, -v12
  v_fma_f32 v125, v125, s64, -v12
  v_fma_f32 v126, v126, s64, -v12
  v_fma_f32 v127, v127, s64, -v12
  v_fma_f32 v128, v128, s64, -v12
  v_fma_f32 v129, v129, s64, -v12
  v_fma_f32 v130, v130, s64, -v12
  v_fma_f32 v131, v131, s64, -v12
  v_fma_f32 v120, v120, s64, -v12
  v_fma_f32 v121, v121, s64, -v12
  v_exp_f32 v124, v124
  v_exp_f32 v125, v125
  v_exp_f32 v126, v126
  v_exp_f32 v127, v127
  v_exp_f32 v128, v128
  v_exp_f32 v129, v129
  v_exp_f32 v130, v130
  v_exp_f32 v131, v131
  v_exp_f32 v120, v120
  v_exp_f32 v121, v121
  v_cvt_pk_bf16_f32 v132, v124, v125
  v_cvt_pk_bf16_f32 v133, v126, v127
  v_cvt_pk_bf16_f32 v134, v128, v129
  v_cvt_pk_bf16_f32 v135, v130, v131
  v_cvt_pk_bf16_f32 v136, v120, v121
  v_cvt_pk_bf16_f32 v137, v120, v121
  v_mfma_f32_16x16x32_bf16 v[140:143], v[96:99], v[132:135], 0
  v_mfma_f32_16x16x32_bf16 v[144:147], v[100:103], v[132:135], 0
  v_mfma_f32_16x16x32_bf16 v[148:151], v[104:107], v[132:135], 0
  v_mfma_f32_16x16x32_bf16 v[152:155], v[108:111], v[132:135], 0
  v_add_f32 v12, v124, v125
  v_add_f32 v12, v12, v126
  v_add_f32 v12, v12, v127
  v_add_f32 v12, v12, v128
  v_add_f32 v12, v12, v129
  v_add_f32 v12, v12, v130
  v_add_f32 v12, v12, v131
  v_add_f32 v12, v12, v120
  v_add_f32 v12, v12, v121
  v_mfma_f32_16x16x16_bf16 v[140:143], v[112:113], v[136:137], v[140:143]
  v_mfma_f32_16x16x16_bf16 v[144:147], v[114:115], v[136:137], v[144:147]
  v_mfma_f32_16x16x16_bf16 v[148:151], v[116:117], v[136:137], v[148:151]
  v_mfma_f32_16x16x16_bf16 v[152:155], v[118:119], v[136:137], v[152:155]
  v_mov_b32 v13, v12
  s_nop 1
  v_permlane16_swap_b32 v12, v13
  v_add_f32 v12, v12, v13
  v_mov_b32 v13, v12
  s_nop 1
  v_permlane32_swap_b32 v12, v13
  v_add_f32 v12, v12, v13
  v_rcp_f32 v12, v12
  s_nop 0
  v_mul_f32 v140, v140, v12
  v_mul_f32 v141, v141, v12
  v_mul_f32 v142, v142, v12
  v_mul_f32 v143, v143, v12
  v_mul_f32 v144, v144, v12
  v_mul_f32 v145, v145, v12
  v_mul_f32 v146, v146, v12
  v_mul_f32 v147, v147, v12
  v_mul_f32 v148, v148, v12
  v_mul_f32 v149, v149, v12
  v_mul_f32 v150, v150, v12
  v_mul_f32 v151, v151, v12
  v_mul_f32 v152, v152, v12
  v_mul_f32 v153, v153, v12
  v_mul_f32 v154, v154, v12
  v_mul_f32 v155, v155, v12
  v_cvt_pk_bf16_f32 v140, v140, v141
  v_cvt_pk_bf16_f32 v141, v142, v143
  v_cvt_pk_bf16_f32 v142, v144, v145
  v_cvt_pk_bf16_f32 v143, v146, v147
  v_cvt_pk_bf16_f32 v144, v148, v149
  v_cvt_pk_bf16_f32 v145, v150, v151
  v_cvt_pk_bf16_f32 v146, v152, v153
  v_cvt_pk_bf16_f32 v147, v154, v155
  ds_write_b128 v5, v[140:143] offset:0
  ds_write_b128 v5, v[144:147] offset:1024
  s_waitcnt lgkmcnt(0)
  s_barrier
  ds_read_b128 v[160:163], v4 offset:4096
  ds_read_b128 v[164:167], v4 offset:5120
  ds_read_b128 v[168:171], v4 offset:6144
  ds_read_b128 v[172:175], v4 offset:7168
  ds_read_b128 v[176:179], v4 offset:8192
  ds_read_b128 v[180:183], v4 offset:9216
  ds_read_b128 v[184:187], v4 offset:10240
  ds_read_b128 v[188:191], v4 offset:11264
  s_waitcnt lgkmcnt(7)
  v_mfma_f32_16x16x32_bf16 v[192:195], a[0:3], v[160:163], 0
  s_waitcnt lgkmcnt(6)
  v_mfma_f32_16x16x32_bf16 v[192:195], a[4:7], v[164:167], v[192:195]
  s_waitcnt lgkmcnt(5)
  v_mfma_f32_16x16x32_bf16 v[192:195], a[64:67], v[168:171], v[192:195]
  s_waitcnt lgkmcnt(4)
  v_mfma_f32_16x16x32_bf16 v[192:195], a[68:71], v[172:175], v[192:195]
  s_waitcnt lgkmcnt(3)
  v_mfma_f32_16x16x32_bf16 v[196:199], a[0:3], v[176:179], 0
  s_waitcnt lgkmcnt(2)
  v_mfma_f32_16x16x32_bf16 v[196:199], a[4:7], v[180:183], v[196:199]
  s_waitcnt lgkmcnt(1)
  v_mfma_f32_16x16x32_bf16 v[196:199], a[64:67], v[184:187], v[196:199]
  s_waitcnt lgkmcnt(0)
  v_mfma_f32_16x16x32_bf16 v[196:199], a[68:71], v[188:191], v[196:199]
  v_mfma_f32_16x16x32_bf16 v[200:203], a[8:11], v[160:163], 0
  v_mfma_f32_16x16x32_bf16 v[200:203], a[12:15], v[164:167], v[200:203]
  v_mfma_f32_16x16x32_bf16 v[200:203], a[72:75], v[168:171], v[200:203]
  v_mfma_f32_16x16x32_bf16 v[200:203], a[76:79], v[172:175], v[200:203]
  v_mfma_f32_16x16x32_bf16 v[204:207], a[8:11], v[176:179], 0
  v_mfma_f32_16x16x32_bf16 v[204:207], a[12:15], v[180:183], v[204:207]
  v_mfma_f32_16x16x32_bf16 v[204:207], a[72:75], v[184:187], v[204:207]
  v_mfma_f32_16x16x32_bf16 v[204:207], a[76:79], v[188:191], v[204:207]
  v_mfma_f32_16x16x32_bf16 v[208:211], a[16:19], v[160:163], 0
  v_mfma_f32_16x16x32_bf16 v[208:211], a[20:23], v[164:167], v[208:211]
  v_mfma_f32_16x16x32_bf16 v[208:211], a[80:83], v[168:171], v[208:211]
  v_mfma_f32_16x16x32_bf16 v[208:211], a[84:87], v[172:175], v[208:211]
  v_mfma_f32_16x16x32_bf16 v[212:215], a[16:19], v[176:179], 0
  v_mfma_f32_16x16x32_bf16 v[212:215], a[20:23], v[180:183], v[212:215]
  v_mfma_f32_16x16x32_bf16 v[212:215], a[80:83], v[184:187], v[212:215]
  v_mfma_f32_16x16x32_bf16 v[212:215], a[84:87], v[188:191], v[212:215]
  v_mfma_f32_16x16x32_bf16 v[216:219], a[24:27], v[160:163], 0
  v_mfma_f32_16x16x32_bf16 v[216:219], a[28:31], v[164:167], v[216:219]
  v_mfma_f32_16x16x32_bf16 v[216:219], a[88:91], v[168:171], v[216:219]
  v_mfma_f32_16x16x32_bf16 v[216:219], a[92:95], v[172:175], v[216:219]
  v_mfma_f32_16x16x32_bf16 v[220:223], a[24:27], v[176:179], 0
  v_mfma_f32_16x16x32_bf16 v[220:223], a[28:31], v[180:183], v[220:223]
  v_mfma_f32_16x16x32_bf16 v[220:223], a[88:91], v[184:187], v[220:223]
  v_mfma_f32_16x16x32_bf16 v[220:223], a[92:95], v[188:191], v[220:223]
  v_mfma_f32_16x16x32_bf16 v[224:227], a[32:35], v[160:163], 0
  v_mfma_f32_16x16x32_bf16 v[224:227], a[36:39], v[164:167], v[224:227]
  v_mfma_f32_16x16x32_bf16 v[224:227], a[96:99], v[168:171], v[224:227]
  v_mfma_f32_16x16x32_bf16 v[224:227], a[100:103], v[172:175], v[224:227]
  v_mfma_f32_16x16x32_bf16 v[228:231], a[32:35], v[176:179], 0
  v_mfma_f32_16x16x32_bf16 v[228:231], a[36:39], v[180:183], v[228:231]
  v_mfma_f32_16x16x32_bf16 v[228:231], a[96:99], v[184:187], v[228:231]
  v_mfma_f32_16x16x32_bf16 v[228:231], a[100:103], v[188:191], v[228:231]
  v_mfma_f32_16x16x32_bf16 v[232:235], a[40:43], v[160:163], 0
  v_mfma_f32_16x16x32_bf16 v[232:235], a[44:47], v[164:167], v[232:235]
  v_mfma_f32_16x16x32_bf16 v[232:235], a[104:107], v[168:171], v[232:235]
  v_mfma_f32_16x16x32_bf16 v[232:235], a[108:111], v[172:175], v[232:235]
  v_mfma_f32_16x16x32_bf16 v[236:239], a[40:43], v[176:179], 0
  v_mfma_f32_16x16x32_bf16 v[236:239], a[44:47], v[180:183], v[236:239]
  v_mfma_f32_16x16x32_bf16 v[236:239], a[104:107], v[184:187], v[236:239]
  v_mfma_f32_16x16x32_bf16 v[236:239], a[108:111], v[188:191], v[236:239]
  v_mfma_f32_16x16x32_bf16 v[240:243], a[48:51], v[160:163], 0
  v_mfma_f32_16x16x32_bf16 v[240:243], a[52:55], v[164:167], v[240:243]
  v_mfma_f32_16x16x32_bf16 v[240:243], a[112:115], v[168:171], v[240:243]
  v_mfma_f32_16x16x32_bf16 v[240:243], a[116:119], v[172:175], v[240:243]
  v_mfma_f32_16x16x32_bf16 v[244:247], a[48:51], v[176:179], 0
  v_mfma_f32_16x16x32_bf16 v[244:247], a[52:55], v[180:183], v[244:247]
  v_mfma_f32_16x16x32_bf16 v[244:247], a[112:115], v[184:187], v[244:247]
  v_mfma_f32_16x16x32_bf16 v[244:247], a[116:119], v[188:191], v[244:247]
  v_mfma_f32_16x16x32_bf16 v[248:251], a[56:59], v[160:163], 0
  v_mfma_f32_16x16x32_bf16 v[248:251], a[60:63], v[164:167], v[248:251]
  v_mfma_f32_16x16x32_bf16 v[248:251], a[120:123], v[168:171], v[248:251]
  v_mfma_f32_16x16x32_bf16 v[248:251], a[124:127], v[172:175], v[248:251]
  v_mfma_f32_16x16x32_bf16 v[252:255], a[56:59], v[176:179], 0
  v_mfma_f32_16x16x32_bf16 v[252:255], a[60:63], v[180:183], v[252:255]
  v_mfma_f32_16x16x32_bf16 v[252:255], a[120:123], v[184:187], v[252:255]
  v_mfma_f32_16x16x32_bf16 v[252:255], a[124:127], v[188:191], v[252:255]
  v_cvt_pk_bf16_f32 v72, v192, v193
  v_cvt_pk_bf16_f32 v73, v194, v195
  v_cvt_pk_bf16_f32 v74, v200, v201
  v_cvt_pk_bf16_f32 v75, v202, v203
  s_add_u32 s72, s60, 0
  buffer_store_dwordx4 v[72:75], v6, s[4:7], s72 offen sc1
  v_cvt_pk_bf16_f32 v76, v208, v209
  v_cvt_pk_bf16_f32 v77, v210, v211
  v_cvt_pk_bf16_f32 v78, v216, v217
  v_cvt_pk_bf16_f32 v79, v218, v219
  s_add_u32 s72, s60, 32768
  buffer_store_dwordx4 v[76:79], v6, s[4:7], s72 offen sc1
  v_cvt_pk_bf16_f32 v72, v224, v225
  v_cvt_pk_bf16_f32 v73, v226, v227
  v_cvt_pk_bf16_f32 v74, v232, v233
  v_cvt_pk_bf16_f32 v75, v234, v235
  s_add_u32 s72, s60, 65536
  buffer_store_dwordx4 v[72:75], v6, s[4:7], s72 offen sc1
  v_cvt_pk_bf16_f32 v76, v240, v241
  v_cvt_pk_bf16_f32 v77, v242, v243
  v_cvt_pk_bf16_f32 v78, v248, v249
  v_cvt_pk_bf16_f32 v79, v250, v251
  s_add_u32 s72, s60, 98304
  buffer_store_dwordx4 v[76:79], v6, s[4:7], s72 offen sc1
  v_cvt_pk_bf16_f32 v72, v196, v197
  v_cvt_pk_bf16_f32 v73, v198, v199
  v_cvt_pk_bf16_f32 v74, v204, v205
  v_cvt_pk_bf16_f32 v75, v206, v207
  s_add_u32 s72, s60, 524288
  buffer_store_dwordx4 v[72:75], v6, s[4:7], s72 offen sc1
  v_cvt_pk_bf16_f32 v76, v212, v213
  v_cvt_pk_bf16_f32 v77, v214, v215
  v_cvt_pk_bf16_f32 v78, v220, v221
  v_cvt_pk_bf16_f32 v79, v222, v223
  s_add_u32 s72, s60, 557056
  buffer_store_dwordx4 v[76:79], v6, s[4:7], s72 offen sc1
  v_cvt_pk_bf16_f32 v72, v228, v229
  v_cvt_pk_bf16_f32 v73, v230, v231
  v_cvt_pk_bf16_f32 v74, v236, v237
  v_cvt_pk_bf16_f32 v75, v238, v239
  s_add_u32 s72, s60, 589824
  buffer_store_dwordx4 v[72:75], v6, s[4:7], s72 offen sc1
  v_cvt_pk_bf16_f32 v76, v244, v245
  v_cvt_pk_bf16_f32 v77, v246, v247
  v_cvt_pk_bf16_f32 v78, v252, v253
  v_cvt_pk_bf16_f32 v79, v254, v255
  s_add_u32 s72, s60, 622592
  buffer_store_dwordx4 v[76:79], v6, s[4:7], s72 offen sc1
  s_mov_b32 s62, s56
  s_add_u32 s56, s56, 5
  s_waitcnt vmcnt(0)
  s_barrier
  s_add_u32 s57, s57, 1
  s_cmp_eq_u32 s54, 0
  s_cbranch_scc0 L_xb_ws_s
  s_lshl_b32 s72, s52, 2
  s_add_u32 s72, s72, s58
  s_mov_b64 exec, 1
  v_mov_b32 v12, 0
  v_mov_b32 v13, s57
  buffer_store_dword v13, v12, s[4:7], s72 offen sc1
  s_mov_b32 exec_lo, -1
  v_lshlrev_b32 v12, 2, v0
L_xb_ps_s:
  buffer_load_dword v13, v12, s[4:7], s58 offen sc1
  s_waitcnt vmcnt(0)
  v_cmp_gt_u32 vcc, s57, v13
  s_nop 0
  s_cbranch_vccz L_xb_oks_s
  s_sleep 1
  s_sub_u32 s70, s70, 1
  s_cbranch_scc0 L_xb_ps_s
  s_mov_b32 s70, 0
L_xb_oks_s:
  s_mov_b64 exec, -1
L_xb_ws_s:
  s_barrier
  s_add_u32 s72, s60, 0
  buffer_load_dwordx4 v[160:163], v7, s[4:7], s72 offen sc1
  s_add_u32 s72, s60, 4096
  buffer_load_dwordx4 v[164:167], v7, s[4:7], s72 offen sc1
  s_add_u32 s72, s60, 8192
  buffer_load_dwordx4 v[168:171], v7, s[4:7], s72 offen sc1
  s_add_u32 s72, s60, 12288
  buffer_load_dwordx4 v[172:175], v7, s[4:7], s72 offen sc1
  s_add_u32 s72, s60, 16384
  buffer_load_dwordx4 v[176:179], v7, s[4:7], s72 offen sc1
  s_add_u32 s72, s60, 20480
  buffer_load_dwordx4 v[180:183], v7, s[4:7], s72 offen sc1
  s_add_u32 s72, s60, 24576
  buffer_load_dwordx4 v[184:187], v7, s[4:7], s72 offen sc1
  s_add_u32 s72, s60, 28672
  buffer_load_dwordx4 v[188:191], v7, s[4:7], s72 offen sc1
  s_waitcnt vmcnt(7)
  v_mfma_f32_16x16x32_bf16 v[192:195], v[16:19], v[160:163], 0
  s_waitcnt vmcnt(6)
  v_mfma_f32_16x16x32_bf16 v[192:195], v[16:19], v[164:167], v[192:195]
  s_waitcnt vmcnt(5)
  v_mfma_f32_16x16x32_bf16 v[192:195], v[16:19], v[168:171], v[192:195]
  s_waitcnt vmcnt(4)
  v_mfma_f32_16x16x32_bf16 v[192:195], v[16:19], v[172:175], v[192:195]
  s_waitcnt vmcnt(3)
  v_mfma_f32_16x16x32_bf16 v[192:195], v[16:19], v[176:179], v[192:195]
  s_waitcnt vmcnt(2)
  v_mfma_f32_16x16x32_bf16 v[192:195], v[16:19], v[180:183], v[192:195]
  s_waitcnt vmcnt(1)
  v_mfma_f32_16x16x32_bf16 v[192:195], v[16:19], v[184:187], v[192:195]
  s_waitcnt vmcnt(0)
  v_mfma_f32_16x16x32_bf16 v[192:195], v[16:19], v[188:191], v[192:195]
  s_nop 7
  v_cvt_pk_bf16_f32 v192, v192, v192
  v_lshlrev_b32 v192, 16, v192
  v_cvt_pk_bf16_f32 v193, v193, v193
  v_lshlrev_b32 v193, 16, v193
  v_cvt_pk_bf16_f32 v194, v194, v194
  v_lshlrev_b32 v194, 16, v194
  v_cvt_pk_bf16_f32 v195, v195, v195
  v_lshlrev_b32 v195, 16, v195
  v_mul_f32 v192, v192, v24
  v_mul_f32 v193, v193, v25
  v_mul_f32 v194, v194, v26
  v_mul_f32 v195, v195, v27
  v_cvt_pk_bf16_f32 v192, v192, v192
  v_lshlrev_b32 v192, 16, v192
  v_cvt_pk_bf16_f32 v193, v193, v193
  v_lshlrev_b32 v193, 16, v193
  v_cvt_pk_bf16_f32 v194, v194, v194
  v_lshlrev_b32 v194, 16, v194
  v_cvt_pk_bf16_f32 v195, v195, v195
  v_lshlrev_b32 v195, 16, v195
  v_lshlrev_b32 v12, 16, v28
  v_and_b32 v13, 0xffff0000, v28
  v_lshlrev_b32 v14, 16, v29
  v_and_b32 v28, 0xffff0000, v29
  v_add_f32 v192, v192, v12
  v_add_f32 v193, v193, v13
  v_add_f32 v194, v194, v14
  v_add_f32 v195, v195, v28
  v_cvt_pk_bf16_f32 v12, v192, v193
  v_cvt_pk_bf16_f32 v13, v194, v195
  s_mov_b32 s8, s46
  s_and_b32 s9, s47, 0xffff
  s_mov_b32 s10, 0x200000
  s_mov_b32 s11, 0x20000
  s_lshl_b32 s61, s62, 15
  s_mov_b32 exec_hi, 0
  buffer_store_dwordx2 v[12:13], v8, s[8:11], s61 offen
  s_mov_b64 exec, -1
  s_cmp_lt_u32 s56, 64
  s_cbranch_scc1 L_tl_more_s
  s_branch L_end
L_tl_more_s:
  s_lshl_b32 s73, s56, 15
  s_lshl_b32 s74, s54, 13
  s_add_u32 s73, s73, s74
  s_add_u32 m0, s74, 0
  s_add_u32 s72, s73, 0
  buffer_load_dwordx4 v1, s[4:7], s72 offen sc1 lds
  s_add_u32 m0, s74, 1024
  s_add_u32 s72, s73, 1024
  buffer_load_dwordx4 v1, s[4:7], s72 offen sc1 lds
  s_add_u32 m0, s74, 2048
  s_add_u32 s72, s73, 2048
  buffer_load_dwordx4 v1, s[4:7], s72 offen sc1 lds
  s_add_u32 m0, s74, 3072
  s_add_u32 s72, s73, 3072
  buffer_load_dwordx4 v1, s[4:7], s72 offen sc1 lds
  s_add_u32 m0, s74, 4096
  s_add_u32 s72, s73, 4096
  buffer_load_dwordx4 v1, s[4:7], s72 offen sc1 lds
  s_add_u32 m0, s74, 5120
  s_add_u32 s72, s73, 5120
  buffer_load_dwordx4 v1, s[4:7], s72 offen sc1 lds
  s_add_u32 m0, s74, 6144
  s_add_u32 s72, s73, 6144
  buffer_load_dwordx4 v1, s[4:7], s72 offen sc1 lds
  s_add_u32 m0, s74, 7168
  s_add_u32 s72, s73, 7168
  buffer_load_dwordx4 v1, s[4:7], s72 offen sc1 lds
  s_branch L_tl_loop_s
L_proj:
  v_lshlrev_b32 v1, 4, v0
  s_lshl_b32 s73, s54, 13
  s_add_u32 s73, s73, 0x10000
  v_lshrrev_b32 v104, 1, v0
  v_and_b32 v104, 7, v104
  v_lshrrev_b32 v15, 4, v0
  v_and_b32 v15, 3, v15
  v_xor_b32 v104, v104, v15
  v_lshlrev_b32 v104, 5, v104
  v_lshrrev_b32 v15, 4, v0
  v_and_b32 v15, 3, v15
  v_lshlrev_b32 v15, 8, v15
  v_and_b32 v127, 1, v0
  v_lshlrev_b32 v127, 4, v127
  v_add_u32 v15, v15, v127
  v_add_u32 v104, v104, v15
  v_add_u32 v104, s73, v104
  v_xor_b32 v115, 0x80, v104
  v_lshrrev_b32 v105, 2, v0
  v_and_b32 v105, 3, v105
  v_lshrrev_b32 v127, 4, v0
  v_and_b32 v127, 1, v127
  v_lshlrev_b32 v127, 2, v127
  v_add_u32 v105, v105, v127
  s_lshl_b32 s72, s54, 1
  v_xor_b32 v105, s72, v105
  v_lshlrev_b32 v105, 5, v105
  v_lshrrev_b32 v15, 4, v0
  v_and_b32 v15, 3, v15
  v_lshlrev_b32 v15, 11, v15
  v_lshrrev_b32 v127, 2, v0
  v_and_b32 v127, 3, v127
  v_lshlrev_b32 v127, 8, v127
  v_add_u32 v15, v15, v127
  v_and_b32 v127, 3, v0
  v_lshlrev_b32 v127, 3, v127
  v_add_u32 v15, v15, v127
  v_add_u32 v15, 0x10000, v15
  v_add_u32 v105, v105, v15
  v_xor_b32 v106, 32, v105
  v_lshrrev_b32 v107, 1, v0
  v_and_b32 v107, 3, v107
  v_lshrrev_b32 v15, 4, v0
  v_and_b32 v15, 3, v15
  v_xor_b32 v107, v107, v15
  v_lshlrev_b32 v107, 5, v107
  v_lshrrev_b32 v15, 3, v0
  v_and_b32 v15, 7, v15
  v_lshlrev_b32 v15, 7, v15
  v_and_b32 v127, 1, v0
  v_lshlrev_b32 v127, 4, v127
  v_add_u32 v15, v15, v127
  v_add_u32 v107, v107, v15
  v_add_u32 v107, s73, v107
  v_lshrrev_b32 v108, 4, v0
  v_and_b32 v108, 1, v108
  v_lshlrev_b32 v108, 1, v108
  v_lshrrev_b32 v127, 3, v0
  v_and_b32 v127, 1, v127
  v_add_u32 v108, v108, v127
  v_lshlrev_b32 v108, 5, v108
  v_lshrrev_b32 v15, 4, v0
  v_and_b32 v15, 3, v15
  v_lshlrev_b32 v15, 9, v15
  v_lshrrev_b32 v127, 2, v0
  v_and_b32 v127, 3, v127
  v_lshlrev_b32 v127, 7, v127
  v_add_u32 v15, v15, v127
  v_and_b32 v127, 3, v0
  v_lshlrev_b32 v127, 3, v127
  v_add_u32 v15, v15, v127
  v_add_u32 v108, v108, v15
  v_add_u32 v108, s73, v108
  v_lshrrev_b32 v109, 1, v0
  v_and_b32 v109, 31, v109
  v_lshlrev_b32 v109, 5, v109
  v_lshrrev_b32 v15, 4, v0
  v_and_b32 v15, 1, v15
  v_lshlrev_b32 v15, 7, v15
  v_xor_b32 v109, v109, v15
  v_and_b32 v15, 1, v0
  v_lshlrev_b32 v15, 4, v15
  v_add_u32 v109, v109, v15
  v_add_u32 v109, s73, v109
  v_lshrrev_b32 v110, 4, v0
  v_and_b32 v110, 3, v110
  v_lshlrev_b32 v110, 8, v110
  v_lshrrev_b32 v127, 4, v0
  v_and_b32 v127, 1, v127
  v_lshlrev_b32 v127, 7, v127
  v_add_u32 v110, v110, v127
  v_lshrrev_b32 v127, 2, v0
  v_and_b32 v127, 3, v127
  v_lshlrev_b32 v127, 5, v127
  v_add_u32 v110, v110, v127
  v_and_b32 v127, 3, v0
  v_lshlrev_b32 v127, 3, v127
  v_add_u32 v110, v110, v127
  v_add_u32 v110, s73, v110
  v_xor_b32 v111, 0x80, v110
  v_lshrrev_b32 v112, 4, v0
  v_and_b32 v112, 3, v112
  v_lshlrev_b32 v112, 13, v112
  v_and_b32 v127, 15, v0
  v_lshlrev_b32 v127, 4, v127
  v_add_u32 v112, v112, v127
  s_lshl_b32 s72, s54, 18
  v_add_u32 v112, s72, v112
  s_lshl_b32 s72, s52, 8
  v_add_u32 v112, s72, v112
  s_mov_b32 s8, s30
  s_and_b32 s9, s31, 0xffff
  s_mov_b32 s10, 0x400000
  s_mov_b32 s11, 0x20000
  s_mov_b32 s74, 0x0
  buffer_load_dwordx4 a[0:3], v112, s[8:11], s74 offen
  s_mov_b32 s74, 0x8000
  buffer_load_dwordx4 a[4:7], v112, s[8:11], s74 offen
  s_mov_b32 s74, 0x10000
  buffer_load_dwordx4 a[8:11], v112, s[8:11], s74 offen
  s_mov_b32 s74, 0x18000
  buffer_load_dwordx4 a[12:15], v112, s[8:11], s74 offen
  s_mov_b32 s74, 0x20000
  buffer_load_dwordx4 a[16:19], v112, s[8:11], s74 offen
  s_mov_b32 s74, 0x28000
  buffer_load_dwordx4 a[20:23], v112, s[8:11], s74 offen
  s_mov_b32 s74, 0x30000
  buffer_load_dwordx4 a[24:27], v112, s[8:11], s74 offen
  s_mov_b32 s74, 0x38000
  buffer_load_dwordx4 a[28:31], v112, s[8:11], s74 offen
  s_mov_b32 s12, s30
  s_and_b32 s13, s31, 0xffff
  s_mov_b32 s14, 0x400000
  s_mov_b32 s15, 0x20000
  s_mov_b32 s74, 0x100000
  buffer_load_dwordx4 a[32:35], v112, s[12:15], s74 offen
  s_mov_b32 s74, 0x108000
  buffer_load_dwordx4 a[36:39], v112, s[12:15], s74 offen
  s_mov_b32 s74, 0x110000
  buffer_load_dwordx4 a[40:43], v112, s[12:15], s74 offen
  s_mov_b32 s74, 0x118000
  buffer_load_dwordx4 a[44:47], v112, s[12:15], s74 offen
  s_mov_b32 s74, 0x120000
  buffer_load_dwordx4 a[48:51], v112, s[12:15], s74 offen
  s_mov_b32 s74, 0x128000
  buffer_load_dwordx4 a[52:55], v112, s[12:15], s74 offen
  s_mov_b32 s74, 0x130000
  buffer_load_dwordx4 a[56:59], v112, s[12:15], s74 offen
  s_mov_b32 s74, 0x138000
  buffer_load_dwordx4 a[60:63], v112, s[12:15], s74 offen
  s_waitcnt vmcnt(8)
  ds_write_b128 v104, a[0:3] offset:0
  ds_write_b128 v104, a[4:7] offset:1024
  ds_write_b128 v115, a[8:11] offset:2048
  ds_write_b128 v115, a[12:15] offset:3072
  ds_write_b128 v104, a[16:19] offset:4096
  ds_write_b128 v104, a[20:23] offset:5120
  ds_write_b128 v115, a[24:27] offset:6144
  ds_write_b128 v115, a[28:31] offset:7168
  s_waitcnt lgkmcnt(0)
  s_barrier
  ds_read_b64_tr_b16 a[0:1], v105 offset:0
  ds_read_b64_tr_b16 a[2:3], v105 offset:1024
  ds_read_b64_tr_b16 a[4:5], v106 offset:0
  ds_read_b64_tr_b16 a[6:7], v106 offset:1024
  ds_read_b64_tr_b16 a[8:9], v105 offset:8192
  ds_read_b64_tr_b16 a[10:11], v105 offset:9216
  ds_read_b64_tr_b16 a[12:13], v106 offset:8192
  ds_read_b64_tr_b16 a[14:15], v106 offset:9216
  s_waitcnt lgkmcnt(0)
  ds_read_b64_tr_b16 a[16:17], v105 offset:16384
  ds_read_b64_tr_b16 a[18:19], v105 offset:17408
  ds_read_b64_tr_b16 a[20:21], v106 offset:16384
  ds_read_b64_tr_b16 a[22:23], v106 offset:17408
  ds_read_b64_tr_b16 a[24:25], v105 offset:24576
  ds_read_b64_tr_b16 a[26:27], v105 offset:25600
  ds_read_b64_tr_b16 a[28:29], v106 offset:24576
  ds_read_b64_tr_b16 a[30:31], v106 offset:25600
  s_waitcnt lgkmcnt(0)
  s_barrier
  s_mov_b32 s8, s30
  s_and_b32 s9, s31, 0xffff
  s_mov_b32 s10, 0x400000
  s_mov_b32 s11, 0x20000
  s_mov_b32 s74, 0x200000
  buffer_load_dwordx4 a[64:67], v112, s[8:11], s74 offen
  s_mov_b32 s74, 0x208000
  buffer_load_dwordx4 a[68:71], v112, s[8:11], s74 offen
  s_mov_b32 s74, 0x210000
  buffer_load_dwordx4 a[72:75], v112, s[8:11], s74 offen
  s_mov_b32 s74, 0x218000
  buffer_load_dwordx4 a[76:79], v112, s[8:11], s74 offen
  s_mov_b32 s74, 0x220000
  buffer_load_dwordx4 a[80:83], v112, s[8:11], s74 offen
  s_mov_b32 s74, 0x228000
  buffer_load_dwordx4 a[84:87], v112, s[8:11], s74 offen
  s_mov_b32 s74, 0x230000
  buffer_load_dwordx4 a[88:91], v112, s[8:11], s74 offen
  s_mov_b32 s74, 0x238000
  buffer_load_dwordx4 a[92:95], v112, s[8:11], s74 offen
  s_waitcnt vmcnt(8)
  ds_write_b128 v104, a[32:35] offset:0
  ds_write_b128 v104, a[36:39] offset:1024
  ds_write_b128 v115, a[40:43] offset:2048
  ds_write_b128 v115, a[44:47] offset:3072
  ds_write_b128 v104, a[48:51] offset:4096
  ds_write_b128 v104, a[52:55] offset:5120
  ds_write_b128 v115, a[56:59] offset:6144
  ds_write_b128 v115, a[60:63] offset:7168
  s_waitcnt lgkmcnt(0)
  s_barrier
  ds_read_b64_tr_b16 a[32:33], v105 offset:0
  ds_read_b64_tr_b16 a[34:35], v105 offset:1024
  ds_read_b64_tr_b16 a[36:37], v106 offset:0
  ds_read_b64_tr_b16 a[38:39], v106 offset:1024
  ds_read_b64_tr_b16 a[40:41], v105 offset:8192
  ds_read_b64_tr_b16 a[42:43], v105 offset:9216
  ds_read_b64_tr_b16 a[44:45], v106 offset:8192
  ds_read_b64_tr_b16 a[46:47], v106 offset:9216
  s_waitcnt lgkmcnt(0)
  ds_read_b64_tr_b16 a[48:49], v105 offset:16384
  ds_read_b64_tr_b16 a[50:51], v105 offset:17408
  ds_read_b64_tr_b16 a[52:53], v106 offset:16384
  ds_read_b64_tr_b16 a[54:55], v106 offset:17408
  ds_read_b64_tr_b16 a[56:57], v105 offset:24576
  ds_read_b64_tr_b16 a[58:59], v105 offset:25600
  ds_read_b64_tr_b16 a[60:61], v106 offset:24576
  ds_read_b64_tr_b16 a[62:63], v106 offset:25600
  s_waitcnt lgkmcnt(0)
  s_barrier
  s_mov_b32 s12, s30
  s_and_b32 s13, s31, 0xffff
  s_mov_b32 s14, 0x400000
  s_mov_b32 s15, 0x20000
  s_mov_b32 s74, 0x300000
  buffer_load_dwordx4 a[96:99], v112, s[12:15], s74 offen
  s_mov_b32 s74, 0x308000
  buffer_load_dwordx4 a[100:103], v112, s[12:15], s74 offen
  s_mov_b32 s74, 0x310000
  buffer_load_dwordx4 a[104:107], v112, s[12:15], s74 offen
  s_mov_b32 s74, 0x318000
  buffer_load_dwordx4 a[108:111], v112, s[12:15], s74 offen
  s_mov_b32 s74, 0x320000
  buffer_load_dwordx4 a[112:115], v112, s[12:15], s74 offen
  s_mov_b32 s74, 0x328000
  buffer_load_dwordx4 a[116:119], v112, s[12:15], s74 offen
  s_mov_b32 s74, 0x330000
  buffer_load_dwordx4 a[120:123], v112, s[12:15], s74 offen
  s_mov_b32 s74, 0x338000
  buffer_load_dwordx4 a[124:127], v112, s[12:15], s74 offen
  s_waitcnt vmcnt(8)
  ds_write_b128 v104, a[64:67] offset:0
  ds_write_b128 v104, a[68:71] offset:1024
  ds_write_b128 v115, a[72:75] offset:2048
  ds_write_b128 v115, a[76:79] offset:3072
  ds_write_b128 v104, a[80:83] offset:4096
  ds_write_b128 v104, a[84:87] offset:5120
  ds_write_b128 v115, a[88:91] offset:6144
  ds_write_b128 v115, a[92:95] offset:7168
  s_waitcnt lgkmcnt(0)
  s_barrier
  ds_read_b64_tr_b16 a[64:65], v105 offset:0
  ds_read_b64_tr_b16 a[66:67], v105 offset:1024
  ds_read_b64_tr_b16 a[68:69], v106 offset:0
  ds_read_b64_tr_b16 a[70:71], v106 offset:1024
  ds_read_b64_tr_b16 a[72:73], v105 offset:8192
  ds_read_b64_tr_b16 a[74:75], v105 offset:9216
  ds_read_b64_tr_b16 a[76:77], v106 offset:8192
  ds_read_b64_tr_b16 a[78:79], v106 offset:9216
  s_waitcnt lgkmcnt(0)
  ds_read_b64_tr_b16 a[80:81], v105 offset:16384
  ds_read_b64_tr_b16 a[82:83], v105 offset:17408
  ds_read_b64_tr_b16 a[84:85], v106 offset:16384
  ds_read_b64_tr_b16 a[86:87], v106 offset:17408
  ds_read_b64_tr_b16 a[88:89], v105 offset:24576
  ds_read_b64_tr_b16 a[90:91], v105 offset:25600
  ds_read_b64_tr_b16 a[92:93], v106 offset:24576
  ds_read_b64_tr_b16 a[94:95], v106 offset:25600
  s_waitcnt lgkmcnt(0)
  s_barrier
  s_mov_b32 s8, s32
  s_and_b32 s9, s33, 0xffff
  s_mov_b32 s10, 0x400000
  s_mov_b32 s11, 0x20000
  s_mov_b32 s74, 0x0
  buffer_load_dwordx4 a[128:131], v112, s[8:11], s74 offen
  s_mov_b32 s74, 0x8000
  buffer_load_dwordx4 a[132:135], v112, s[8:11], s74 offen
  s_mov_b32 s74, 0x10000
  buffer_load_dwordx4 a[136:139], v112, s[8:11], s74 offen
  s_mov_b32 s74, 0x18000
  buffer_load_dwordx4 a[140:143], v112, s[8:11], s74 offen
  s_mov_b32 s74, 0x20000
  buffer_load_dwordx4 a[144:147], v112, s[8:11], s74 offen
  s_mov_b32 s74, 0x28000
  buffer_load_dwordx4 a[148:151], v112, s[8:11], s74 offen
  s_mov_b32 s74, 0x30000
  buffer_load_dwordx4 a[152:155], v112, s[8:11], s74 offen
  s_mov_b32 s74, 0x38000
  buffer_load_dwordx4 a[156:159], v112, s[8:11], s74 offen
  s_waitcnt vmcnt(8)
  ds_write_b128 v104, a[96:99] offset:0
  ds_write_b128 v104, a[100:103] offset:1024
  ds_write_b128 v115, a[104:107] offset:2048
  ds_write_b128 v115, a[108:111] offset:3072
  ds_write_b128 v104, a[112:115] offset:4096
  ds_write_b128 v104, a[116:119] offset:5120
  ds_write_b128 v115, a[120:123] offset:6144
  ds_write_b128 v115, a[124:127] offset:7168
  s_waitcnt lgkmcnt(0)
  s_barrier
  ds_read_b64_tr_b16 a[96:97], v105 offset:0
  ds_read_b64_tr_b16 a[98:99], v105 offset:1024
  ds_read_b64_tr_b16 a[100:101], v106 offset:0
  ds_read_b64_tr_b16 a[102:103], v106 offset:1024
  ds_read_b64_tr_b16 a[104:105], v105 offset:8192
  ds_read_b64_tr_b16 a[106:107], v105 offset:9216
  ds_read_b64_tr_b16 a[108:109], v106 offset:8192
  ds_read_b64_tr_b16 a[110:111], v106 offset:9216
  s_waitcnt lgkmcnt(0)
  ds_read_b64_tr_b16 a[112:113], v105 offset:16384
  ds_read_b64_tr_b16 a[114:115], v105 offset:17408
  ds_read_b64_tr_b16 a[116:117], v106 offset:16384
  ds_read_b64_tr_b16 a[118:119], v106 offset:17408
  ds_read_b64_tr_b16 a[120:121], v105 offset:24576
  ds_read_b64_tr_b16 a[122:123], v105 offset:25600
  ds_read_b64_tr_b16 a[124:125], v106 offset:24576
  ds_read_b64_tr_b16 a[126:127], v106 offset:25600
  s_waitcnt lgkmcnt(0)
  s_barrier
  s_mov_b32 s12, s32
  s_and_b32 s13, s33, 0xffff
  s_mov_b32 s14, 0x400000
  s_mov_b32 s15, 0x20000
  s_mov_b32 s74, 0x100000
  buffer_load_dwordx4 a[160:163], v112, s[12:15], s74 offen
  s_mov_b32 s74, 0x108000
  buffer_load_dwordx4 a[164:167], v112, s[12:15], s74 offen
  s_mov_b32 s74, 0x110000
  buffer_load_dwordx4 a[168:171], v112, s[12:15], s74 offen
  s_mov_b32 s74, 0x118000
  buffer_load_dwordx4 a[172:175], v112, s[12:15], s74 offen
  s_mov_b32 s74, 0x120000
  buffer_load_dwordx4 a[176:179], v112, s[12:15], s74 offen
  s_mov_b32 s74, 0x128000
  buffer_load_dwordx4 a[180:183], v112, s[12:15], s74 offen
  s_mov_b32 s74, 0x130000
  buffer_load_dwordx4 a[184:187], v112, s[12:15], s74 offen
  s_mov_b32 s74, 0x138000
  buffer_load_dwordx4 a[188:191], v112, s[12:15], s74 offen
  s_waitcnt vmcnt(8)
  ds_write_b128 v104, a[128:131] offset:0
  ds_write_b128 v104, a[132:135] offset:1024
  ds_write_b128 v115, a[136:139] offset:2048
  ds_write_b128 v115, a[140:143] offset:3072
  ds_write_b128 v104, a[144:147] offset:4096
  ds_write_b128 v104, a[148:151] offset:5120
  ds_write_b128 v115, a[152:155] offset:6144
  ds_write_b128 v115, a[156:159] offset:7168
  s_waitcnt lgkmcnt(0)
  s_barrier
  ds_read_b64_tr_b16 a[128:129], v105 offset:0
  ds_read_b64_tr_b16 a[130:131], v105 offset:1024
  ds_read_b64_tr_b16 a[132:133], v106 offset:0
  ds_read_b64_tr_b16 a[134:135], v106 offset:1024
  ds_read_b64_tr_b16 a[136:137], v105 offset:8192
  ds_read_b64_tr_b16 a[138:139], v105 offset:9216
  ds_read_b64_tr_b16 a[140:141], v106 offset:8192
  ds_read_b64_tr_b16 a[142:143], v106 offset:9216
  s_waitcnt lgkmcnt(0)
  ds_read_b64_tr_b16 a[144:145], v105 offset:16384
  ds_read_b64_tr_b16 a[146:147], v105 offset:17408
  ds_read_b64_tr_b16 a[148:149], v106 offset:16384
  ds_read_b64_tr_b16 a[150:151], v106 offset:17408
  ds_read_b64_tr_b16 a[152:153], v105 offset:24576
  ds_read_b64_tr_b16 a[154:155], v105 offset:25600
  ds_read_b64_tr_b16 a[156:157], v106 offset:24576
  ds_read_b64_tr_b16 a[158:159], v106 offset:25600
  s_waitcnt lgkmcnt(0)
  s_barrier
  s_mov_b32 s8, s32
  s_and_b32 s9, s33, 0xffff
  s_mov_b32 s10, 0x400000
  s_mov_b32 s11, 0x20000
  s_mov_b32 s74, 0x200000
  buffer_load_dwordx4 a[192:195], v112, s[8:11], s74 offen
  s_mov_b32 s74, 0x208000
  buffer_load_dwordx4 a[196:199], v112, s[8:11], s74 offen
  s_mov_b32 s74, 0x210000
  buffer_load_dwordx4 a[200:203], v112, s[8:11], s74 offen
  s_mov_b32 s74, 0x218000
  buffer_load_dwordx4 a[204:207], v112, s[8:11], s74 offen
  s_mov_b32 s74, 0x220000
  buffer_load_dwordx4 a[208:211], v112, s[8:11], s74 offen
  s_mov_b32 s74, 0x228000
  buffer_load_dwordx4 a[212:215], v112, s[8:11], s74 offen
  s_mov_b32 s74, 0x230000
  buffer_load_dwordx4 a[216:219], v112, s[8:11], s74 offen
  s_mov_b32 s74, 0x238000
  buffer_load_dwordx4 a[220:223], v112, s[8:11], s74 offen
  s_waitcnt vmcnt(8)
  ds_write_b128 v104, a[160:163] offset:0
  ds_write_b128 v104, a[164:167] offset:1024
  ds_write_b128 v115, a[168:171] offset:2048
  ds_write_b128 v115, a[172:175] offset:3072
  ds_write_b128 v104, a[176:179] offset:4096
  ds_write_b128 v104, a[180:183] offset:5120
  ds_write_b128 v115, a[184:187] offset:6144
  ds_write_b128 v115, a[188:191] offset:7168
  s_waitcnt lgkmcnt(0)
  s_barrier
  ds_read_b64_tr_b16 a[160:161], v105 offset:0
  ds_read_b64_tr_b16 a[162:163], v105 offset:1024
  ds_read_b64_tr_b16 a[164:165], v106 offset:0
  ds_read_b64_tr_b16 a[166:167], v106 offset:1024
  ds_read_b64_tr_b16 a[168:169], v105 offset:8192
  ds_read_b64_tr_b16 a[170:171], v105 offset:9216
  ds_read_b64_tr_b16 a[172:173], v106 offset:8192
  ds_read_b64_tr_b16 a[174:175], v106 offset:9216
  s_waitcnt lgkmcnt(0)
  ds_read_b64_tr_b16 a[176:177], v105 offset:16384
  ds_read_b64_tr_b16 a[178:179], v105 offset:17408
  ds_read_b64_tr_b16 a[180:181], v106 offset:16384
  ds_read_b64_tr_b16 a[182:183], v106 offset:17408
  ds_read_b64_tr_b16 a[184:185], v105 offset:24576
  ds_read_b64_tr_b16 a[186:187], v105 offset:25600
  ds_read_b64_tr_b16 a[188:189], v106 offset:24576
  ds_read_b64_tr_b16 a[190:191], v106 offset:25600
  s_waitcnt lgkmcnt(0)
  s_barrier
  s_mov_b32 s12, s32
  s_and_b32 s13, s33, 0xffff
  s_mov_b32 s14, 0x400000
  s_mov_b32 s15, 0x20000
  s_mov_b32 s74, 0x300000
  buffer_load_dwordx4 a[224:227], v112, s[12:15], s74 offen
  s_mov_b32 s74, 0x308000
  buffer_load_dwordx4 a[228:231], v112, s[12:15], s74 offen
  s_mov_b32 s74, 0x310000
  buffer_load_dwordx4 a[232:235], v112, s[12:15], s74 offen
  s_mov_b32 s74, 0x318000
  buffer_load_dwordx4 a[236:239], v112, s[12:15], s74 offen
  s_mov_b32 s74, 0x320000
  buffer_load_dwordx4 a[240:243], v112, s[12:15], s74 offen
  s_mov_b32 s74, 0x328000
  buffer_load_dwordx4 a[244:247], v112, s[12:15], s74 offen
  s_mov_b32 s74, 0x330000
  buffer_load_dwordx4 a[248:251], v112, s[12:15], s74 offen
  s_mov_b32 s74, 0x338000
  buffer_load_dwordx4 a[252:255], v112, s[12:15], s74 offen
  s_waitcnt vmcnt(8)
  ds_write_b128 v104, a[192:195] offset:0
  ds_write_b128 v104, a[196:199] offset:1024
  ds_write_b128 v115, a[200:203] offset:2048
  ds_write_b128 v115, a[204:207] offset:3072
  ds_write_b128 v104, a[208:211] offset:4096
  ds_write_b128 v104, a[212:215] offset:5120
  ds_write_b128 v115, a[216:219] offset:6144
  ds_write_b128 v115, a[220:223] offset:7168
  s_waitcnt lgkmcnt(0)
  s_barrier
  ds_read_b64_tr_b16 a[192:193], v105 offset:0
  ds_read_b64_tr_b16 a[194:195], v105 offset:1024
  ds_read_b64_tr_b16 a[196:197], v106 offset:0
  ds_read_b64_tr_b16 a[198:199], v106 offset:1024
  ds_read_b64_tr_b16 a[200:201], v105 offset:8192
  ds_read_b64_tr_b16 a[202:203], v105 offset:9216
  ds_read_b64_tr_b16 a[204:205], v106 offset:8192
  ds_read_b64_tr_b16 a[206:207], v106 offset:9216
  s_waitcnt lgkmcnt(0)
  ds_read_b64_tr_b16 a[208:209], v105 offset:16384
  ds_read_b64_tr_b16 a[210:211], v105 offset:17408
  ds_read_b64_tr_b16 a[212:213], v106 offset:16384
  ds_read_b64_tr_b16 a[214:215], v106 offset:17408
  ds_read_b64_tr_b16 a[216:217], v105 offset:24576
  ds_read_b64_tr_b16 a[218:219], v105 offset:25600
  ds_read_b64_tr_b16 a[220:221], v106 offset:24576
  ds_read_b64_tr_b16 a[222:223], v106 offset:25600
  s_waitcnt lgkmcnt(0)
  s_barrier
  s_mov_b32 s8, s28
  s_and_b32 s9, s29, 0xffff
  s_mov_b32 s10, 0x400000
  s_mov_b32 s11, 0x20000
  s_mov_b32 s74, 0x0
  buffer_load_dwordx4 v[128:131], v112, s[8:11], s74 offen
  s_mov_b32 s74, 0x8000
  buffer_load_dwordx4 v[132:135], v112, s[8:11], s74 offen
  s_mov_b32 s74, 0x10000
  buffer_load_dwordx4 v[136:139], v112, s[8:11], s74 offen
  s_mov_b32 s74, 0x18000
  buffer_load_dwordx4 v[140:143], v112, s[8:11], s74 offen
  s_mov_b32 s74, 0x20000
  buffer_load_dwordx4 v[144:147], v112, s[8:11], s74 offen
  s_mov_b32 s74, 0x28000
  buffer_load_dwordx4 v[148:151], v112, s[8:11], s74 offen
  s_mov_b32 s74, 0x30000
  buffer_load_dwordx4 v[152:155], v112, s[8:11], s74 offen
  s_mov_b32 s74, 0x38000
  buffer_load_dwordx4 v[156:159], v112, s[8:11], s74 offen
  s_waitcnt vmcnt(8)
  ds_write_b128 v104, a[224:227] offset:0
  ds_write_b128 v104, a[228:231] offset:1024
  ds_write_b128 v115, a[232:235] offset:2048
  ds_write_b128 v115, a[236:239] offset:3072
  ds_write_b128 v104, a[240:243] offset:4096
  ds_write_b128 v104, a[244:247] offset:5120
  ds_write_b128 v115, a[248:251] offset:6144
  ds_write_b128 v115, a[252:255] offset:7168
  s_waitcnt lgkmcnt(0)
  s_barrier
  ds_read_b64_tr_b16 a[224:225], v105 offset:0
  ds_read_b64_tr_b16 a[226:227], v105 offset:1024
  ds_read_b64_tr_b16 a[228:229], v106 offset:0
  ds_read_b64_tr_b16 a[230:231], v106 offset:1024
  ds_read_b64_tr_b16 a[232:233], v105 offset:8192
  ds_read_b64_tr_b16 a[234:235], v105 offset:9216
  ds_read_b64_tr_b16 a[236:237], v106 offset:8192
  ds_read_b64_tr_b16 a[238:239], v106 offset:9216
  s_waitcnt lgkmcnt(0)
  ds_read_b64_tr_b16 a[240:241], v105 offset:16384
  ds_read_b64_tr_b16 a[242:243], v105 offset:17408
  ds_read_b64_tr_b16 a[244:245], v106 offset:16384
  ds_read_b64_tr_b16 a[246:247], v106 offset:17408
  ds_read_b64_tr_b16 a[248:249], v105 offset:24576
  ds_read_b64_tr_b16 a[250:251], v105 offset:25600
  ds_read_b64_tr_b16 a[252:253], v106 offset:24576
  ds_read_b64_tr_b16 a[254:255], v106 offset:25600
  s_waitcnt lgkmcnt(0)
  s_barrier
  s_mov_b32 s12, s28
  s_and_b32 s13, s29, 0xffff
  s_mov_b32 s14, 0x400000
  s_mov_b32 s15, 0x20000
  s_mov_b32 s74, 0x100000
  buffer_load_dwordx4 v[160:163], v112, s[12:15], s74 offen
  s_mov_b32 s74, 0x108000
  buffer_load_dwordx4 v[164:167], v112, s[12:15], s74 offen
  s_mov_b32 s74, 0x110000
  buffer_load_dwordx4 v[168:171], v112, s[12:15], s74 offen
  s_mov_b32 s74, 0x118000
  buffer_load_dwordx4 v[172:175], v112, s[12:15], s74 offen
  s_mov_b32 s74, 0x120000
  buffer_load_dwordx4 v[176:179], v112, s[12:15], s74 offen
  s_mov_b32 s74, 0x128000
  buffer_load_dwordx4 v[180:183], v112, s[12:15], s74 offen
  s_mov_b32 s74, 0x130000
  buffer_load_dwordx4 v[184:187], v112, s[12:15], s74 offen
  s_mov_b32 s74, 0x138000
  buffer_load_dwordx4 v[188:191], v112, s[12:15], s74 offen
  s_waitcnt vmcnt(8)
  ds_write_b128 v104, v[128:131] offset:0
  ds_write_b128 v104, v[132:135] offset:1024
  ds_write_b128 v115, v[136:139] offset:2048
  ds_write_b128 v115, v[140:143] offset:3072
  ds_write_b128 v104, v[144:147] offset:4096
  ds_write_b128 v104, v[148:151] offset:5120
  ds_write_b128 v115, v[152:155] offset:6144
  ds_write_b128 v115, v[156:159] offset:7168
  s_waitcnt lgkmcnt(0)
  s_barrier
  ds_read_b64_tr_b16 v[128:129], v105 offset:0
  ds_read_b64_tr_b16 v[130:131], v105 offset:1024
  ds_read_b64_tr_b16 v[132:133], v106 offset:0
  ds_read_b64_tr_b16 v[134:135], v106 offset:1024
  ds_read_b64_tr_b16 v[136:137], v105 offset:8192
  ds_read_b64_tr_b16 v[138:139], v105 offset:9216
  ds_read_b64_tr_b16 v[140:141], v106 offset:8192
  ds_read_b64_tr_b16 v[142:143], v106 offset:9216
  s_waitcnt lgkmcnt(0)
  ds_read_b64_tr_b16 v[144:145], v105 offset:16384
  ds_read_b64_tr_b16 v[146:147], v105 offset:17408
  ds_read_b64_tr_b16 v[148:149], v106 offset:16384
  ds_read_b64_tr_b16 v[150:151], v106 offset:17408
  ds_read_b64_tr_b16 v[152:153], v105 offset:24576
  ds_read_b64_tr_b16 v[154:155], v105 offset:25600
  ds_read_b64_tr_b16 v[156:157], v106 offset:24576
  ds_read_b64_tr_b16 v[158:159], v106 offset:25600
  s_waitcnt lgkmcnt(0)
  s_barrier
  s_mov_b32 s8, s28
  s_and_b32 s9, s29, 0xffff
  s_mov_b32 s10, 0x400000
  s_mov_b32 s11, 0x20000
  s_mov_b32 s74, 0x200000
  buffer_load_dwordx4 v[192:195], v112, s[8:11], s74 offen
  s_mov_b32 s74, 0x208000
  buffer_load_dwordx4 v[196:199], v112, s[8:11], s74 offen
  s_mov_b32 s74, 0x210000
  buffer_load_dwordx4 v[200:203], v112, s[8:11], s74 offen
  s_mov_b32 s74, 0x218000
  buffer_load_dwordx4 v[204:207], v112, s[8:11], s74 offen
  s_mov_b32 s74, 0x220000
  buffer_load_dwordx4 v[208:211], v112, s[8:11], s74 offen
  s_mov_b32 s74, 0x228000
  buffer_load_dwordx4 v[212:215], v112, s[8:11], s74 offen
  s_mov_b32 s74, 0x230000
  buffer_load_dwordx4 v[216:219], v112, s[8:11], s74 offen
  s_mov_b32 s74, 0x238000
  buffer_load_dwordx4 v[220:223], v112, s[8:11], s74 offen
  s_waitcnt vmcnt(8)
  ds_write_b128 v104, v[160:163] offset:0
  ds_write_b128 v104, v[164:167] offset:1024
  ds_write_b128 v115, v[168:171] offset:2048
  ds_write_b128 v115, v[172:175] offset:3072
  ds_write_b128 v104, v[176:179] offset:4096
  ds_write_b128 v104, v[180:183] offset:5120
  ds_write_b128 v115, v[184:187] offset:6144
  ds_write_b128 v115, v[188:191] offset:7168
  s_waitcnt lgkmcnt(0)
  s_barrier
  ds_read_b64_tr_b16 v[160:161], v105 offset:0
  ds_read_b64_tr_b16 v[162:163], v105 offset:1024
  ds_read_b64_tr_b16 v[164:165], v106 offset:0
  ds_read_b64_tr_b16 v[166:167], v106 offset:1024
  ds_read_b64_tr_b16 v[168:169], v105 offset:8192
  ds_read_b64_tr_b16 v[170:171], v105 offset:9216
  ds_read_b64_tr_b16 v[172:173], v106 offset:8192
  ds_read_b64_tr_b16 v[174:175], v106 offset:9216
  s_waitcnt lgkmcnt(0)
  ds_read_b64_tr_b16 v[176:177], v105 offset:16384
  ds_read_b64_tr_b16 v[178:179], v105 offset:17408
  ds_read_b64_tr_b16 v[180:181], v106 offset:16384
  ds_read_b64_tr_b16 v[182:183], v106 offset:17408
  ds_read_b64_tr_b16 v[184:185], v105 offset:24576
  ds_read_b64_tr_b16 v[186:187], v105 offset:25600
  ds_read_b64_tr_b16 v[188:189], v106 offset:24576
  ds_read_b64_tr_b16 v[190:191], v106 offset:25600
  s_waitcnt lgkmcnt(0)
  s_barrier
  s_mov_b32 s12, s28
  s_and_b32 s13, s29, 0xffff
  s_mov_b32 s14, 0x400000
  s_mov_b32 s15, 0x20000
  s_mov_b32 s74, 0x300000
  buffer_load_dwordx4 v[224:227], v112, s[12:15], s74 offen
  s_mov_b32 s74, 0x308000
  buffer_load_dwordx4 v[228:231], v112, s[12:15], s74 offen
  s_mov_b32 s74, 0x310000
  buffer_load_dwordx4 v[232:235], v112, s[12:15], s74 offen
  s_mov_b32 s74, 0x318000
  buffer_load_dwordx4 v[236:239], v112, s[12:15], s74 offen
  s_mov_b32 s74, 0x320000
  buffer_load_dwordx4 v[240:243], v112, s[12:15], s74 offen
  s_mov_b32 s74, 0x328000
  buffer_load_dwordx4 v[244:247], v112, s[12:15], s74 offen
  s_mov_b32 s74, 0x330000
  buffer_load_dwordx4 v[248:251], v112, s[12:15], s74 offen
  s_mov_b32 s74, 0x338000
  buffer_load_dwordx4 v[252:255], v112, s[12:15], s74 offen
  s_waitcnt vmcnt(8)
  ds_write_b128 v104, v[192:195] offset:0
  ds_write_b128 v104, v[196:199] offset:1024
  ds_write_b128 v115, v[200:203] offset:2048
  ds_write_b128 v115, v[204:207] offset:3072
  ds_write_b128 v104, v[208:211] offset:4096
  ds_write_b128 v104, v[212:215] offset:5120
  ds_write_b128 v115, v[216:219] offset:6144
  ds_write_b128 v115, v[220:223] offset:7168
  s_waitcnt lgkmcnt(0)
  s_barrier
  ds_read_b64_tr_b16 v[192:193], v105 offset:0
  ds_read_b64_tr_b16 v[194:195], v105 offset:1024
  ds_read_b64_tr_b16 v[196:197], v106 offset:0
  ds_read_b64_tr_b16 v[198:199], v106 offset:1024
  ds_read_b64_tr_b16 v[200:201], v105 offset:8192
  ds_read_b64_tr_b16 v[202:203], v105 offset:9216
  ds_read_b64_tr_b16 v[204:205], v106 offset:8192
  ds_read_b64_tr_b16 v[206:207], v106 offset:9216
  s_waitcnt lgkmcnt(0)
  ds_read_b64_tr_b16 v[208:209], v105 offset:16384
  ds_read_b64_tr_b16 v[210:211], v105 offset:17408
  ds_read_b64_tr_b16 v[212:213], v106 offset:16384
  ds_read_b64_tr_b16 v[214:215], v106 offset:17408
  ds_read_b64_tr_b16 v[216:217], v105 offset:24576
  ds_read_b64_tr_b16 v[218:219], v105 offset:25600
  ds_read_b64_tr_b16 v[220:221], v106 offset:24576
  ds_read_b64_tr_b16 v[222:223], v106 offset:25600
  s_waitcnt lgkmcnt(0)
  s_barrier
  s_waitcnt vmcnt(0)
  ds_write_b128 v104, v[224:227] offset:0
  ds_write_b128 v104, v[228:231] offset:1024
  ds_write_b128 v115, v[232:235] offset:2048
  ds_write_b128 v115, v[236:239] offset:3072
  ds_write_b128 v104, v[240:243] offset:4096
  ds_write_b128 v104, v[244:247] offset:5120
  ds_write_b128 v115, v[248:251] offset:6144
  ds_write_b128 v115, v[252:255] offset:7168
  s_waitcnt lgkmcnt(0)
  s_barrier
  ds_read_b64_tr_b16 v[224:225], v105 offset:0
  ds_read_b64_tr_b16 v[226:227], v105 offset:1024
  ds_read_b64_tr_b16 v[228:229], v106 offset:0
  ds_read_b64_tr_b16 v[230:231], v106 offset:1024
  ds_read_b64_tr_b16 v[232:233], v105 offset:8192
  ds_read_b64_tr_b16 v[234:235], v105 offset:9216
  ds_read_b64_tr_b16 v[236:237], v106 offset:8192
  ds_read_b64_tr_b16 v[238:239], v106 offset:9216
  s_waitcnt lgkmcnt(0)
  ds_read_b64_tr_b16 v[240:241], v105 offset:16384
  ds_read_b64_tr_b16 v[242:243], v105 offset:17408
  ds_read_b64_tr_b16 v[244:245], v106 offset:16384
  ds_read_b64_tr_b16 v[246:247], v106 offset:17408
  ds_read_b64_tr_b16 v[248:249], v105 offset:24576
  ds_read_b64_tr_b16 v[250:251], v105 offset:25600
  ds_read_b64_tr_b16 v[252:253], v106 offset:24576
  ds_read_b64_tr_b16 v[254:255], v106 offset:25600
  s_waitcnt lgkmcnt(0)
  s_barrier
  s_cmp_eq_u32 s54, 0
  s_cbranch_scc0 L_pj_clr_ok
  s_mov_b64 exec, 0xff
  v_lshlrev_b32 v12, 4, v0
  v_add_u32 v12, 112, v12
  v_cmp_eq_u32 vcc, 0, v0
  s_nop 1
  v_cndmask_b32 v12, v12, 0, vcc
L_pj_clr:
  buffer_load_dwordx2 v[14:15], v12, s[16:19], 0 offen sc1
  s_waitcnt vmcnt(0)
  v_readlane_b32 s96, v15, 0
  v_readlane_b32 s97, v15, 1
  v_readlane_b32 s98, v15, 2
  v_readlane_b32 s99, v15, 3
  v_readlane_b32 s100, v15, 4
  v_readlane_b32 s101, v15, 5
  v_readlane_b32 s22, v15, 6
  v_readlane_b32 s23, v15, 7
  s_nop 3
  s_add_u32 s3, s96, s97
  s_add_u32 s3, s3, s98
  s_add_u32 s3, s3, s99
  s_add_u32 s3, s3, s100
  s_add_u32 s3, s3, s101
  s_add_u32 s3, s3, s22
  s_add_u32 s3, s3, s23
  s_cmp_ge_u32 s3, 0x100
  s_cbranch_scc1 L_pj_clr_d
  s_sub_u32 s70, s70, 64
  s_cselect_b32 s70, 0, s70
  s_cbranch_scc1 L_pj_clr_d
  s_sleep 4
  s_branch L_pj_clr
L_pj_clr_d:
  v_readlane_b32 s96, v14, 0
  v_readlane_b32 s97, v14, 1
  v_readlane_b32 s98, v14, 2
  v_readlane_b32 s99, v14, 3
  v_readlane_b32 s100, v14, 4
  v_readlane_b32 s101, v14, 5
  v_readlane_b32 s22, v14, 6
  v_readlane_b32 s23, v14, 7
  s_nop 3
  s_mov_b32 s3, 0
  s_cmp_eq_u32 s96, 32
  s_cselect_b32 s3, s3, 1
  s_cmp_eq_u32 s97, 32
  s_cselect_b32 s3, s3, 1
  s_cmp_eq_u32 s98, 32
  s_cselect_b32 s3, s3, 1
  s_cmp_eq_u32 s99, 32
  s_cselect_b32 s3, s3, 1
  s_cmp_eq_u32 s100, 32
  s_cselect_b32 s3, s3, 1
  s_cmp_eq_u32 s101, 32
  s_cselect_b32 s3, s3, 1
  s_cmp_eq_u32 s22, 32
  s_cselect_b32 s3, s3, 1
  s_cmp_eq_u32 s23, 32
  s_cselect_b32 s3, s3, 1
  s_cmp_eq_u32 s55, 0
  s_cselect_b32 s3, s3, 0
  s_mov_b64 exec, -1
  v_mov_b32 v12, 0x27ff0
  v_mov_b32 v13, s3
  ds_write_b32 v12, v13
  s_waitcnt lgkmcnt(0)
  s_mov_b64 exec, -1
L_pj_clr_ok:
  s_barrier
  v_mov_b32 v12, 0x27ff0
  ds_read_b32 v13, v12
  s_waitcnt lgkmcnt(0)
  v_readfirstlane_b32 s3, v13
  s_nop 3
  s_cmp_eq_u32 s3, 0
  s_cbranch_scc0 L_fallback
  s_sub_u32 s56, s53, 1
  s_lshl_b32 s63, s52, 7
  s_lshl_b32 s72, s56, 2
  s_add_u32 s63, s63, s72
  s_add_u32 s63, s63, 0x42d1000
  s_mov_b32 s58, 0
  v_lshlrev_b32 v127, 3, v0
  s_mov_b32 s73, 0x42d0000
L_pj_x0:
  buffer_load_dwordx2 v[12:13], v127, s[4:7], s73 offen sc1
  s_waitcnt vmcnt(0)
  v_min_u32 v12, v12, v13
  v_cmp_eq_u32 vcc, 0, v12
  s_nop 0
  s_cbranch_vccz L_pj_x0_ok
  s_sub_u32 s70, s70, 16
  s_cselect_b32 s70, 0, s70
  s_cbranch_scc1 L_pj_x0_ok
  s_sleep 8
  s_branch L_pj_x0
L_pj_x0_ok:
  s_lshl_b32 s73, s56, 15
  s_lshl_b32 s74, s54, 13
  s_add_u32 s73, s73, s74
  s_add_u32 s74, s74, s58
  s_add_u32 m0, s74, 0
  s_nop 0
  s_add_u32 s72, s73, 0
  buffer_load_dwordx4 v1, s[4:7], s72 offen sc1 lds
  s_add_u32 m0, s74, 1024
  s_nop 0
  s_add_u32 s72, s73, 1024
  buffer_load_dwordx4 v1, s[4:7], s72 offen sc1 lds
  s_add_u32 m0, s74, 2048
  s_nop 0
  s_add_u32 s72, s73, 2048
  buffer_load_dwordx4 v1, s[4:7], s72 offen sc1 lds
  s_add_u32 m0, s74, 3072
  s_nop 0
  s_add_u32 s72, s73, 3072
  buffer_load_dwordx4 v1, s[4:7], s72 offen sc1 lds
  s_add_u32 m0, s74, 4096
  s_add_u32 s73, s73, 4096
  s_add_u32 s72, s73, 0
  buffer_load_dwordx4 v1, s[4:7], s72 offen sc1 lds
  s_add_u32 m0, s74, 5120
  s_nop 0
  s_add_u32 s72, s73, 1024
  buffer_load_dwordx4 v1, s[4:7], s72 offen sc1 lds
  s_add_u32 m0, s74, 6144
  s_nop 0
  s_add_u32 s72, s73, 2048
  buffer_load_dwordx4 v1, s[4:7], s72 offen sc1 lds
  s_add_u32 m0, s74, 7168
  s_nop 0
  s_add_u32 s72, s73, 3072
  buffer_load_dwordx4 v1, s[4:7], s72 offen sc1 lds
  s_mov_b32 s59, -1
  s_waitcnt vmcnt(0)
L_pj_loop:
  s_waitcnt vmcnt(6)
  s_barrier
  v_add_u32 v2, s58, v1
  s_add_u32 s57, s56, 2
  s_xor_b32 s61, s58, 0x8000
  s_lshl_b32 s64, s57, 15
  s_lshl_b32 s65, s54, 13
  s_add_u32 s64, s64, s65
  s_add_u32 s65, s65, s61
  ds_read_b128 v[16:19], v2 offset:0
  ds_read_b128 v[20:23], v2 offset:16384
  ds_read_b128 v[24:27], v2 offset:1024
  ds_read_b128 v[28:31], v2 offset:17408
  s_waitcnt lgkmcnt(3)
  v_mfma_f32_16x16x32_bf16 v[32:35], a[0:3], v[16:19], 0
  s_waitcnt lgkmcnt(2)
  v_mfma_f32_16x16x32_bf16 v[36:39], a[0:3], v[20:23], 0
  v_mfma_f32_16x16x32_bf16 v[40:43], a[4:7], v[16:19], 0
  v_mfma_f32_16x16x32_bf16 v[44:47], a[4:7], v[20:23], 0
  s_add_u32 m0, s65, 0
  s_add_u32 s66, s64, 0
  buffer_load_dwordx4 v1, s[4:7], s66 offen sc1 lds
  v_mfma_f32_16x16x32_bf16 v[64:67], v[16:19], a[128:131], 0
  v_mfma_f32_16x16x32_bf16 v[72:75], v[20:23], a[128:131], 0
  v_mfma_f32_16x16x32_bf16 v[68:71], v[16:19], a[132:135], 0
  v_mfma_f32_16x16x32_bf16 v[76:79], v[20:23], a[132:135], 0
  v_mfma_f32_16x16x32_bf16 v[48:51], v[128:131], v[16:19], 0
  v_mfma_f32_16x16x32_bf16 v[52:55], v[128:131], v[20:23], 0
  v_mfma_f32_16x16x32_bf16 v[56:59], v[132:135], v[16:19], 0
  v_mfma_f32_16x16x32_bf16 v[60:63], v[132:135], v[20:23], 0
  ds_read_b128 v[16:19], v2 offset:2048
  ds_read_b128 v[20:23], v2 offset:18432
  s_waitcnt lgkmcnt(3)
  v_mfma_f32_16x16x32_bf16 v[32:35], a[8:11], v[24:27], v[32:35]
  s_waitcnt lgkmcnt(2)
  v_mfma_f32_16x16x32_bf16 v[36:39], a[8:11], v[28:31], v[36:39]
  v_mfma_f32_16x16x32_bf16 v[40:43], a[12:15], v[24:27], v[40:43]
  v_mfma_f32_16x16x32_bf16 v[44:47], a[12:15], v[28:31], v[44:47]
  s_add_u32 m0, s65, 1024
  s_add_u32 s66, s64, 1024
  buffer_load_dwordx4 v1, s[4:7], s66 offen sc1 lds
  v_mfma_f32_16x16x32_bf16 v[64:67], v[24:27], a[136:139], v[64:67]
  v_mfma_f32_16x16x32_bf16 v[72:75], v[28:31], a[136:139], v[72:75]
  v_mfma_f32_16x16x32_bf16 v[68:71], v[24:27], a[140:143], v[68:71]
  v_mfma_f32_16x16x32_bf16 v[76:79], v[28:31], a[140:143], v[76:79]
  v_mfma_f32_16x16x32_bf16 v[48:51], v[136:139], v[24:27], v[48:51]
  v_mfma_f32_16x16x32_bf16 v[52:55], v[136:139], v[28:31], v[52:55]
  v_mfma_f32_16x16x32_bf16 v[56:59], v[140:143], v[24:27], v[56:59]
  v_mfma_f32_16x16x32_bf16 v[60:63], v[140:143], v[28:31], v[60:63]
  ds_read_b128 v[24:27], v2 offset:3072
  ds_read_b128 v[28:31], v2 offset:19456
  s_waitcnt lgkmcnt(3)
  v_mfma_f32_16x16x32_bf16 v[32:35], a[16:19], v[16:19], v[32:35]
  s_waitcnt lgkmcnt(2)
  v_mfma_f32_16x16x32_bf16 v[36:39], a[16:19], v[20:23], v[36:39]
  v_mfma_f32_16x16x32_bf16 v[40:43], a[20:23], v[16:19], v[40:43]
  v_mfma_f32_16x16x32_bf16 v[44:47], a[20:23], v[20:23], v[44:47]
  s_add_u32 m0, s65, 2048
  s_add_u32 s66, s64, 2048
  buffer_load_dwordx4 v1, s[4:7], s66 offen sc1 lds
  v_mfma_f32_16x16x32_bf16 v[64:67], v[16:19], a[144:147], v[64:67]
  v_mfma_f32_16x16x32_bf16 v[72:75], v[20:23], a[144:147], v[72:75]
  v_mfma_f32_16x16x32_bf16 v[68:71], v[16:19], a[148:151], v[68:71]
  v_mfma_f32_16x16x32_bf16 v[76:79], v[20:23], a[148:151], v[76:79]
  v_mfma_f32_16x16x32_bf16 v[48:51], v[144:147], v[16:19], v[48:51]
  v_mfma_f32_16x16x32_bf16 v[52:55], v[144:147], v[20:23], v[52:55]
  v_mfma_f32_16x16x32_bf16 v[56:59], v[148:151], v[16:19], v[56:59]
  v_mfma_f32_16x16x32_bf16 v[60:63], v[148:151], v[20:23], v[60:63]
  ds_read_b128 v[16:19], v2 offset:4096
  ds_read_b128 v[20:23], v2 offset:20480
  s_waitcnt lgkmcnt(3)
  v_mfma_f32_16x16x32_bf16 v[32:35], a[24:27], v[24:27], v[32:35]
  s_waitcnt lgkmcnt(2)
  v_mfma_f32_16x16x32_bf16 v[36:39], a[24:27], v[28:31], v[36:39]
  v_mfma_f32_16x16x32_bf16 v[40:43], a[28:31], v[24:27], v[40:43]
  v_mfma_f32_16x16x32_bf16 v[44:47], a[28:31], v[28:31], v[44:47]
  s_add_u32 m0, s65, 3072
  s_add_u32 s66, s64, 3072
  buffer_load_dwordx4 v1, s[4:7], s66 offen sc1 lds
  v_mfma_f32_16x16x32_bf16 v[64:67], v[24:27], a[152:155], v[64:67]
  v_mfma_f32_16x16x32_bf16 v[72:75], v[28:31], a[152:155], v[72:75]
  v_mfma_f32_16x16x32_bf16 v[68:71], v[24:27], a[156:159], v[68:71]
  v_mfma_f32_16x16x32_bf16 v[76:79], v[28:31], a[156:159], v[76:79]
  v_mfma_f32_16x16x32_bf16 v[48:51], v[152:155], v[24:27], v[48:51]
  v_mfma_f32_16x16x32_bf16 v[52:55], v[152:155], v[28:31], v[52:55]
  v_mfma_f32_16x16x32_bf16 v[56:59], v[156:159], v[24:27], v[56:59]
  v_mfma_f32_16x16x32_bf16 v[60:63], v[156:159], v[28:31], v[60:63]
  ds_read_b128 v[24:27], v2 offset:5120
  ds_read_b128 v[28:31], v2 offset:21504
  s_waitcnt lgkmcnt(3)
  v_mfma_f32_16x16x32_bf16 v[32:35], a[32:35], v[16:19], v[32:35]
  s_waitcnt lgkmcnt(2)
  v_mfma_f32_16x16x32_bf16 v[36:39], a[32:35], v[20:23], v[36:39]
  v_mfma_f32_16x16x32_bf16 v[40:43], a[36:39], v[16:19], v[40:43]
  v_mfma_f32_16x16x32_bf16 v[44:47], a[36:39], v[20:23], v[44:47]
  s_add_u32 m0, s65, 4096
  s_add_u32 s66, s64, 4096
  buffer_load_dwordx4 v1, s[4:7], s66 offen sc1 lds
  v_mfma_f32_16x16x32_bf16 v[64:67], v[16:19], a[160:163], v[64:67]
  v_mfma_f32_16x16x32_bf16 v[72:75], v[20:23], a[160:163], v[72:75]
  v_mfma_f32_16x16x32_bf16 v[68:71], v[16:19], a[164:167], v[68:71]
  v_mfma_f32_16x16x32_bf16 v[76:79], v[20:23], a[164:167], v[76:79]
  v_mfma_f32_16x16x32_bf16 v[48:51], v[160:163], v[16:19], v[48:51]
  v_mfma_f32_16x16x32_bf16 v[52:55], v[160:163], v[20:23], v[52:55]
  v_mfma_f32_16x16x32_bf16 v[56:59], v[164:167], v[16:19], v[56:59]
  v_mfma_f32_16x16x32_bf16 v[60:63], v[164:167], v[20:23], v[60:63]
  ds_read_b128 v[16:19], v2 offset:6144
  ds_read_b128 v[20:23], v2 offset:22528
  s_waitcnt lgkmcnt(3)
  v_mfma_f32_16x16x32_bf16 v[32:35], a[40:43], v[24:27], v[32:35]
  s_waitcnt lgkmcnt(2)
  v_mfma_f32_16x16x32_bf16 v[36:39], a[40:43], v[28:31], v[36:39]
  v_mfma_f32_16x16x32_bf16 v[40:43], a[44:47], v[24:27], v[40:43]
  v_mfma_f32_16x16x32_bf16 v[44:47], a[44:47], v[28:31], v[44:47]
  s_add_u32 m0, s65, 5120
  s_add_u32 s66, s64, 5120
  buffer_load_dwordx4 v1, s[4:7], s66 offen sc1 lds
  v_mfma_f32_16x16x32_bf16 v[64:67], v[24:27], a[168:171], v[64:67]
  v_mfma_f32_16x16x32_bf16 v[72:75], v[28:31], a[168:171], v[72:75]
  v_mfma_f32_16x16x32_bf16 v[68:71], v[24:27], a[172:175], v[68:71]
  v_mfma_f32_16x16x32_bf16 v[76:79], v[28:31], a[172:175], v[76:79]
  v_mfma_f32_16x16x32_bf16 v[48:51], v[168:171], v[24:27], v[48:51]
  v_mfma_f32_16x16x32_bf16 v[52:55], v[168:171], v[28:31], v[52:55]
  v_mfma_f32_16x16x32_bf16 v[56:59], v[172:175], v[24:27], v[56:59]
  v_mfma_f32_16x16x32_bf16 v[60:63], v[172:175], v[28:31], v[60:63]
  ds_read_b128 v[24:27], v2 offset:7168
  ds_read_b128 v[28:31], v2 offset:23552
  s_waitcnt lgkmcnt(3)
  v_mfma_f32_16x16x32_bf16 v[32:35], a[48:51], v[16:19], v[32:35]
  s_waitcnt lgkmcnt(2)
  v_mfma_f32_16x16x32_bf16 v[36:39], a[48:51], v[20:23], v[36:39]
  v_mfma_f32_16x16x32_bf16 v[40:43], a[52:55], v[16:19], v[40:43]
  v_mfma_f32_16x16x32_bf16 v[44:47], a[52:55], v[20:23], v[44:47]
  s_add_u32 m0, s65, 6144
  s_add_u32 s66, s64, 6144
  buffer_load_dwordx4 v1, s[4:7], s66 offen sc1 lds
  v_mfma_f32_16x16x32_bf16 v[64:67], v[16:19], a[176:179], v[64:67]
  v_mfma_f32_16x16x32_bf16 v[72:75], v[20:23], a[176:179], v[72:75]
  v_mfma_f32_16x16x32_bf16 v[68:71], v[16:19], a[180:183], v[68:71]
  v_mfma_f32_16x16x32_bf16 v[76:79], v[20:23], a[180:183], v[76:79]
  v_mfma_f32_16x16x32_bf16 v[48:51], v[176:179], v[16:19], v[48:51]
  v_mfma_f32_16x16x32_bf16 v[52:55], v[176:179], v[20:23], v[52:55]
  v_mfma_f32_16x16x32_bf16 v[56:59], v[180:183], v[16:19], v[56:59]
  v_mfma_f32_16x16x32_bf16 v[60:63], v[180:183], v[20:23], v[60:63]
  ds_read_b128 v[16:19], v2 offset:8192
  ds_read_b128 v[20:23], v2 offset:24576
  s_waitcnt lgkmcnt(3)
  v_mfma_f32_16x16x32_bf16 v[32:35], a[56:59], v[24:27], v[32:35]
  s_waitcnt lgkmcnt(2)
  v_mfma_f32_16x16x32_bf16 v[36:39], a[56:59], v[28:31], v[36:39]
  v_mfma_f32_16x16x32_bf16 v[40:43], a[60:63], v[24:27], v[40:43]
  v_mfma_f32_16x16x32_bf16 v[44:47], a[60:63], v[28:31], v[44:47]
  s_add_u32 m0, s65, 7168
  s_add_u32 s66, s64, 7168
  buffer_load_dwordx4 v1, s[4:7], s66 offen sc1 lds
  v_mfma_f32_16x16x32_bf16 v[64:67], v[24:27], a[184:187], v[64:67]
  v_mfma_f32_16x16x32_bf16 v[72:75], v[28:31], a[184:187], v[72:75]
  v_mfma_f32_16x16x32_bf16 v[68:71], v[24:27], a[188:191], v[68:71]
  v_mfma_f32_16x16x32_bf16 v[76:79], v[28:31], a[188:191], v[76:79]
  v_mfma_f32_16x16x32_bf16 v[48:51], v[184:187], v[24:27], v[48:51]
  v_mfma_f32_16x16x32_bf16 v[52:55], v[184:187], v[28:31], v[52:55]
  v_mfma_f32_16x16x32_bf16 v[56:59], v[188:191], v[24:27], v[56:59]
  v_mfma_f32_16x16x32_bf16 v[60:63], v[188:191], v[28:31], v[60:63]
  ds_read_b128 v[24:27], v2 offset:9216
  ds_read_b128 v[28:31], v2 offset:25600
  s_waitcnt lgkmcnt(3)
  v_mfma_f32_16x16x32_bf16 v[32:35], a[64:67], v[16:19], v[32:35]
  s_waitcnt lgkmcnt(2)
  v_mfma_f32_16x16x32_bf16 v[36:39], a[64:67], v[20:23], v[36:39]
  v_mfma_f32_16x16x32_bf16 v[40:43], a[68:71], v[16:19], v[40:43]
  v_mfma_f32_16x16x32_bf16 v[44:47], a[68:71], v[20:23], v[44:47]
  v_mfma_f32_16x16x32_bf16 v[64:67], v[16:19], a[192:195], v[64:67]
  v_mfma_f32_16x16x32_bf16 v[72:75], v[20:23], a[192:195], v[72:75]
  v_mfma_f32_16x16x32_bf16 v[68:71], v[16:19], a[196:199], v[68:71]
  v_mfma_f32_16x16x32_bf16 v[76:79], v[20:23], a[196:199], v[76:79]
  v_mfma_f32_16x16x32_bf16 v[48:51], v[192:195], v[16:19], v[48:51]
  v_mfma_f32_16x16x32_bf16 v[52:55], v[192:195], v[20:23], v[52:55]
  v_mfma_f32_16x16x32_bf16 v[56:59], v[196:199], v[16:19], v[56:59]
  v_mfma_f32_16x16x32_bf16 v[60:63], v[196:199], v[20:23], v[60:63]
  ds_read_b128 v[16:19], v2 offset:10240
  ds_read_b128 v[20:23], v2 offset:26624
  s_waitcnt lgkmcnt(3)
  v_mfma_f32_16x16x32_bf16 v[32:35], a[72:75], v[24:27], v[32:35]
  s_waitcnt lgkmcnt(2)
  v_mfma_f32_16x16x32_bf16 v[36:39], a[72:75], v[28:31], v[36:39]
  v_mfma_f32_16x16x32_bf16 v[40:43], a[76:79], v[24:27], v[40:43]
  v_mfma_f32_16x16x32_bf16 v[44:47], a[76:79], v[28:31], v[44:47]
  v_mfma_f32_16x16x32_bf16 v[64:67], v[24:27], a[200:203], v[64:67]
  v_mfma_f32_16x16x32_bf16 v[72:75], v[28:31], a[200:203], v[72:75]
  v_mfma_f32_16x16x32_bf16 v[68:71], v[24:27], a[204:207], v[68:71]
  v_mfma_f32_16x16x32_bf16 v[76:79], v[28:31], a[204:207], v[76:79]
  v_mfma_f32_16x16x32_bf16 v[48:51], v[200:203], v[24:27], v[48:51]
  v_mfma_f32_16x16x32_bf16 v[52:55], v[200:203], v[28:31], v[52:55]
  v_mfma_f32_16x16x32_bf16 v[56:59], v[204:207], v[24:27], v[56:59]
  v_mfma_f32_16x16x32_bf16 v[60:63], v[204:207], v[28:31], v[60:63]
  s_cmp_eq_u32 s59, -1
  s_cbranch_scc1 L_pj_nof
  s_waitcnt vmcnt(8)
  s_barrier
  s_cmp_eq_u32 s54, 0
  s_cbranch_scc0 L_pj_nof
  s_mov_b64 exec, 1
  v_mov_b32 v15, 0
  v_mov_b32 v127, s59
  buffer_store_dword v127, v15, s[4:7], s63 offen sc1
  s_mov_b64 exec, -1
L_pj_nof:
  ds_read_b128 v[24:27], v2 offset:11264
  ds_read_b128 v[28:31], v2 offset:27648
  s_waitcnt lgkmcnt(3)
  v_mfma_f32_16x16x32_bf16 v[32:35], a[80:83], v[16:19], v[32:35]
  s_waitcnt lgkmcnt(2)
  v_mfma_f32_16x16x32_bf16 v[36:39], a[80:83], v[20:23], v[36:39]
  v_mfma_f32_16x16x32_bf16 v[40:43], a[84:87], v[16:19], v[40:43]
  v_mfma_f32_16x16x32_bf16 v[44:47], a[84:87], v[20:23], v[44:47]
  v_mfma_f32_16x16x32_bf16 v[64:67], v[16:19], a[208:211], v[64:67]
  v_mfma_f32_16x16x32_bf16 v[72:75], v[20:23], a[208:211], v[72:75]
  v_mfma_f32_16x16x32_bf16 v[68:71], v[16:19], a[212:215], v[68:71]
  v_mfma_f32_16x16x32_bf16 v[76:79], v[20:23], a[212:215], v[76:79]
  v_mfma_f32_16x16x32_bf16 v[48:51], v[208:211], v[16:19], v[48:51]
  v_mfma_f32_16x16x32_bf16 v[52:55], v[208:211], v[20:23], v[52:55]
  v_mfma_f32_16x16x32_bf16 v[56:59], v[212:215], v[16:19], v[56:59]
  v_mfma_f32_16x16x32_bf16 v[60:63], v[212:215], v[20:23], v[60:63]
  ds_read_b128 v[16:19], v2 offset:12288
  ds_read_b128 v[20:23], v2 offset:28672
  s_waitcnt lgkmcnt(3)
  v_mfma_f32_16x16x32_bf16 v[32:35], a[88:91], v[24:27], v[32:35]
  s_waitcnt lgkmcnt(2)
  v_mfma_f32_16x16x32_bf16 v[36:39], a[88:91], v[28:31], v[36:39]
  v_mfma_f32_16x16x32_bf16 v[40:43], a[92:95], v[24:27], v[40:43]
  v_mfma_f32_16x16x32_bf16 v[44:47], a[92:95], v[28:31], v[44:47]
  v_mfma_f32_16x16x32_bf16 v[64:67], v[24:27], a[216:219], v[64:67]
  v_mfma_f32_16x16x32_bf16 v[72:75], v[28:31], a[216:219], v[72:75]
  v_mfma_f32_16x16x32_bf16 v[68:71], v[24:27], a[220:223], v[68:71]
  v_mfma_f32_16x16x32_bf16 v[76:79], v[28:31], a[220:223], v[76:79]
  v_mfma_f32_16x16x32_bf16 v[48:51], v[216:219], v[24:27], v[48:51]
  v_mfma_f32_16x16x32_bf16 v[52:55], v[216:219], v[28:31], v[52:55]
  v_mfma_f32_16x16x32_bf16 v[56:59], v[220:223], v[24:27], v[56:59]
  v_mfma_f32_16x16x32_bf16 v[60:63], v[220:223], v[28:31], v[60:63]
  ds_read_b128 v[24:27], v2 offset:13312
  ds_read_b128 v[28:31], v2 offset:29696
  s_waitcnt lgkmcnt(3)
  v_mfma_f32_16x16x32_bf16 v[32:35], a[96:99], v[16:19], v[32:35]
  s_waitcnt lgkmcnt(2)
  v_mfma_f32_16x16x32_bf16 v[36:39], a[96:99], v[20:23], v[36:39]
  v_mfma_f32_16x16x32_bf16 v[40:43], a[100:103], v[16:19], v[40:43]
  v_mfma_f32_16x16x32_bf16 v[44:47], a[100:103], v[20:23], v[44:47]
  v_mfma_f32_16x16x32_bf16 v[64:67], v[16:19], a[224:227], v[64:67]
  v_mfma_f32_16x16x32_bf16 v[72:75], v[20:23], a[224:227], v[72:75]
  v_mfma_f32_16x16x32_bf16 v[68:71], v[16:19], a[228:231], v[68:71]
  v_mfma_f32_16x16x32_bf16 v[76:79], v[20:23], a[228:231], v[76:79]
  v_mfma_f32_16x16x32_bf16 v[48:51], v[224:227], v[16:19], v[48:51]
  v_mfma_f32_16x16x32_bf16 v[52:55], v[224:227], v[20:23], v[52:55]
  v_mfma_f32_16x16x32_bf16 v[56:59], v[228:231], v[16:19], v[56:59]
  v_mfma_f32_16x16x32_bf16 v[60:63], v[228:231], v[20:23], v[60:63]
  ds_read_b128 v[16:19], v2 offset:14336
  ds_read_b128 v[20:23], v2 offset:30720
  s_waitcnt lgkmcnt(3)
  v_mfma_f32_16x16x32_bf16 v[32:35], a[104:107], v[24:27], v[32:35]
  s_waitcnt lgkmcnt(2)
  v_mfma_f32_16x16x32_bf16 v[36:39], a[104:107], v[28:31], v[36:39]
  v_mfma_f32_16x16x32_bf16 v[40:43], a[108:111], v[24:27], v[40:43]
  v_mfma_f32_16x16x32_bf16 v[44:47], a[108:111], v[28:31], v[44:47]
  v_mfma_f32_16x16x32_bf16 v[64:67], v[24:27], a[232:235], v[64:67]
  v_mfma_f32_16x16x32_bf16 v[72:75], v[28:31], a[232:235], v[72:75]
  v_mfma_f32_16x16x32_bf16 v[68:71], v[24:27], a[236:239], v[68:71]
  v_mfma_f32_16x16x32_bf16 v[76:79], v[28:31], a[236:239], v[76:79]
  v_mfma_f32_16x16x32_bf16 v[48:51], v[232:235], v[24:27], v[48:51]
  v_mfma_f32_16x16x32_bf16 v[52:55], v[232:235], v[28:31], v[52:55]
  v_mfma_f32_16x16x32_bf16 v[56:59], v[236:239], v[24:27], v[56:59]
  v_mfma_f32_16x16x32_bf16 v[60:63], v[236:239], v[28:31], v[60:63]
  ds_read_b128 v[24:27], v2 offset:15360
  ds_read_b128 v[28:31], v2 offset:31744
  s_waitcnt lgkmcnt(3)
  v_mfma_f32_16x16x32_bf16 v[32:35], a[112:115], v[16:19], v[32:35]
  s_waitcnt lgkmcnt(2)
  v_mfma_f32_16x16x32_bf16 v[36:39], a[112:115], v[20:23], v[36:39]
  v_mfma_f32_16x16x32_bf16 v[40:43], a[116:119], v[16:19], v[40:43]
  v_mfma_f32_16x16x32_bf16 v[44:47], a[116:119], v[20:23], v[44:47]
  v_mfma_f32_16x16x32_bf16 v[64:67], v[16:19], a[240:243], v[64:67]
  v_mfma_f32_16x16x32_bf16 v[72:75], v[20:23], a[240:243], v[72:75]
  v_mfma_f32_16x16x32_bf16 v[68:71], v[16:19], a[244:247], v[68:71]
  v_mfma_f32_16x16x32_bf16 v[76:79], v[20:23], a[244:247], v[76:79]
  v_mfma_f32_16x16x32_bf16 v[48:51], v[240:243], v[16:19], v[48:51]
  v_mfma_f32_16x16x32_bf16 v[52:55], v[240:243], v[20:23], v[52:55]
  v_mfma_f32_16x16x32_bf16 v[56:59], v[244:247], v[16:19], v[56:59]
  v_mfma_f32_16x16x32_bf16 v[60:63], v[244:247], v[20:23], v[60:63]
  s_waitcnt lgkmcnt(1)
  v_mfma_f32_16x16x32_bf16 v[32:35], a[120:123], v[24:27], v[32:35]
  s_waitcnt lgkmcnt(0)
  v_mfma_f32_16x16x32_bf16 v[36:39], a[120:123], v[28:31], v[36:39]
  v_mfma_f32_16x16x32_bf16 v[40:43], a[124:127], v[24:27], v[40:43]
  v_mfma_f32_16x16x32_bf16 v[44:47], a[124:127], v[28:31], v[44:47]
  v_mfma_f32_16x16x32_bf16 v[64:67], v[24:27], a[248:251], v[64:67]
  v_mfma_f32_16x16x32_bf16 v[72:75], v[28:31], a[248:251], v[72:75]
  v_mfma_f32_16x16x32_bf16 v[68:71], v[24:27], a[252:255], v[68:71]
  v_mfma_f32_16x16x32_bf16 v[76:79], v[28:31], a[252:255], v[76:79]
  v_mfma_f32_16x16x32_bf16 v[48:51], v[248:251], v[24:27], v[48:51]
  v_mfma_f32_16x16x32_bf16 v[52:55], v[248:251], v[28:31], v[52:55]
  v_mfma_f32_16x16x32_bf16 v[56:59], v[252:255], v[24:27], v[56:59]
  v_mfma_f32_16x16x32_bf16 v[60:63], v[252:255], v[28:31], v[60:63]
  s_lshl_b32 s73, s56, 5
  s_add_u32 s73, s73, s52
  s_lshr_b32 s59, s56, 1
  s_add_u32 s59, s59, 1
  s_lshl_b32 s73, s73, 13
  s_lshl_b32 s74, s54, 10
  s_add_u32 s60, s73, s74
  s_lshl_b32 s74, s54, 11
  s_add_u32 s61, s73, s74
  s_add_u32 s62, s60, 0x1200000
  s_add_u32 s60, s60, 0x200000
  s_add_u32 s61, s61, 0x2200000
  v_cvt_pk_bf16_f32 v80, v32, v33
  v_cvt_pk_bf16_f32 v81, v34, v35
  v_cvt_pk_bf16_f32 v82, v40, v41
  v_cvt_pk_bf16_f32 v83, v42, v43
  buffer_store_dwordx4 v[80:83], v1, s[4:7], s60 offen sc1
  v_cvt_pk_bf16_f32 v84, v36, v37
  v_cvt_pk_bf16_f32 v85, v38, v39
  v_cvt_pk_bf16_f32 v86, v44, v45
  v_cvt_pk_bf16_f32 v87, v46, v47
  s_add_u32 s60, s60, 4096
  buffer_store_dwordx4 v[84:87], v1, s[4:7], s60 offen sc1
  v_cvt_pk_bf16_f32 v88, v64, v65
  v_cvt_pk_bf16_f32 v89, v66, v67
  v_cvt_pk_bf16_f32 v90, v72, v73
  v_cvt_pk_bf16_f32 v91, v74, v75
  buffer_store_dwordx4 v[88:91], v1, s[4:7], s61 offen offset:0 sc1
  v_cvt_pk_bf16_f32 v92, v68, v69
  v_cvt_pk_bf16_f32 v93, v70, v71
  v_cvt_pk_bf16_f32 v94, v76, v77
  v_cvt_pk_bf16_f32 v95, v78, v79
  buffer_store_dwordx4 v[92:95], v1, s[4:7], s61 offen offset:1024 sc1
  v_cvt_pk_bf16_f32 v96, v48, v49
  v_cvt_pk_bf16_f32 v97, v50, v51
  v_cvt_pk_bf16_f32 v98, v56, v57
  v_cvt_pk_bf16_f32 v99, v58, v59
  buffer_store_dwordx4 v[96:99], v1, s[4:7], s62 offen sc1
  v_cvt_pk_bf16_f32 v100, v52, v53
  v_cvt_pk_bf16_f32 v101, v54, v55
  v_cvt_pk_bf16_f32 v102, v60, v61
  v_cvt_pk_bf16_f32 v103, v62, v63
  s_add_u32 s62, s62, 4096
  buffer_store_dwordx4 v[100:103], v1, s[4:7], s62 offen sc1
  s_cmp_lt_u32 s56, 6
  s_cbranch_scc0 L_pj_notfirst
  s_waitcnt vmcnt(0)
  s_barrier
  s_cmp_eq_u32 s54, 0
  s_cbranch_scc0 L_pj_f1
  s_mov_b64 exec, 1
  v_mov_b32 v15, 0
  v_mov_b32 v127, s59
  buffer_store_dword v127, v15, s[4:7], s63 offen sc1
  s_mov_b64 exec, -1
L_pj_f1:
L_pj_notfirst:
  s_xor_b32 s58, s58, 0x8000
  s_add_u32 s56, s56, 2
  s_cmp_lt_u32 s56, 64
  s_cbranch_scc1 L_pj_loop
  s_waitcnt vmcnt(0)
  s_barrier
  s_cmp_eq_u32 s54, 0
  s_cbranch_scc0 L_end
  s_mov_b64 exec, 1
  v_mov_b32 v15, 0
  v_mov_b32 v127, s59
  buffer_store_dword v127, v15, s[4:7], s63 offen sc1
  s_mov_b64 exec, -1
  s_branch L_end
L_role_chain:
  s_cmp_eq_u32 s55, 0
  s_cbranch_scc0 L_chain_s
L_chain_f:
  v_lshlrev_b32 v1, 4, v0
  s_cmp_eq_u32 s54, 0
  s_cbranch_scc0 L_ci_not0
  s_mov_b32 s8, s26
  s_and_b32 s9, s27, 0xffff
  s_mov_b32 s10, 0x2000
  s_mov_b32 s11, 0x20000
  v_and_b32 v15, 3, v0
  v_lshlrev_b32 v15, 11, v15
  v_lshrrev_b32 v127, 4, v0
  v_and_b32 v127, 1, v127
  v_lshlrev_b32 v127, 10, v127
  v_add_u32 v15, v15, v127
  v_lshrrev_b32 v127, 2, v0
  v_and_b32 v127, 1, v127
  v_lshlrev_b32 v127, 1, v127
  v_add_u32 v15, v15, v127
  s_lshr_b32 s72, s52, 3
  s_lshl_b32 s72, s72, 7
  v_add_u32 v15, s72, v15
  s_and_b32 s72, s52, 7
  s_lshl_b32 s72, s72, 2
  v_add_u32 v15, s72, v15
  buffer_load_ushort v92, v15, s[8:11], 0 offen offset:0
  buffer_load_ushort v93, v15, s[8:11], 0 offen offset:32
  buffer_load_ushort v94, v15, s[8:11], 0 offen offset:64
  buffer_load_ushort v95, v15, s[8:11], 0 offen offset:96
  buffer_load_ushort v96, v15, s[8:11], 0 offen offset:512
  buffer_load_ushort v97, v15, s[8:11], 0 offen offset:544
  buffer_load_ushort v98, v15, s[8:11], 0 offen offset:576
  buffer_load_ushort v99, v15, s[8:11], 0 offen offset:608
L_ci_not0:
  v_mov_b32 v122, -1
  v_mov_b32 v123, -1
  v_mov_b32 v124, -1
  v_mov_b32 v125, -1
  s_lshl_b32 s72, s52, 12
  s_lshr_b32 s73, s54, 1
  s_lshl_b32 s73, s73, 17
  s_add_u32 s72, s72, s73
  s_and_b32 s73, s54, 1
  s_lshl_b32 s73, s73, 11
  s_add_u32 s72, s72, s73
  s_add_u32 s73, s72, 0x4200000
  buffer_store_dwordx4 v[122:125], v1, s[4:7], s73 offen offset:0
  buffer_store_dwordx4 v[122:125], v1, s[4:7], s73 offen offset:1024
  s_add_u32 s73, s72, 0x4240000
  buffer_store_dwordx4 v[122:125], v1, s[4:7], s73 offen offset:0
  buffer_store_dwordx4 v[122:125], v1, s[4:7], s73 offen offset:1024
  s_add_u32 s73, s72, 0x4280000
  buffer_store_dwordx4 v[122:125], v1, s[4:7], s73 offen offset:0
  buffer_store_dwordx4 v[122:125], v1, s[4:7], s73 offen offset:1024
  s_cmp_eq_u32 s54, 1
  s_cbranch_scc0 L_ci_not1
  s_mov_b64 exec, 0xff
  s_lshl_b32 s72, s52, 7
  s_add_u32 s73, s72, 0x42c2000
  buffer_store_dwordx4 v[122:125], v1, s[4:7], s73 offen
  s_add_u32 s73, s72, 0x42c3000
  buffer_store_dwordx4 v[122:125], v1, s[4:7], s73 offen
  s_add_u32 s73, s72, 0x42c4000
  buffer_store_dwordx4 v[122:125], v1, s[4:7], s73 offen
  s_add_u32 s73, s72, 0x42c5000
  buffer_store_dwordx4 v[122:125], v1, s[4:7], s73 offen
  s_add_u32 s73, s72, 0x42c6000
  buffer_store_dwordx4 v[122:125], v1, s[4:7], s73 offen
  s_add_u32 s73, s72, 0x42c7000
  buffer_store_dwordx4 v[122:125], v1, s[4:7], s73 offen
  s_mov_b64 exec, -1
L_ci_not1:
  v_lshrrev_b32 v80, 4, v0
  v_and_b32 v80, 3, v80
  v_lshlrev_b32 v80, 13, v80
  v_and_b32 v127, 15, v0
  v_lshlrev_b32 v127, 4, v127
  v_add_u32 v80, v80, v127
  s_lshl_b32 s72, s54, 18
  v_add_u32 v80, s72, v80
  s_lshl_b32 s72, s52, 8
  v_add_u32 v80, s72, v80
  v_lshrrev_b32 v81, 3, v0
  v_and_b32 v81, 7, v81
  v_lshlrev_b32 v81, 10, v81
  v_and_b32 v127, 7, v0
  v_lshlrev_b32 v127, 4, v127
  v_add_u32 v81, v81, v127
  s_lshl_b32 s72, s54, 7
  v_add_u32 v81, s72, v81
  s_lshl_b32 s72, s52, 17
  v_add_u32 v81, s72, v81
  s_lshl_b32 s73, s54, 13
  s_add_u32 s73, s73, 0x20000
  v_lshrrev_b32 v82, 1, v0
  v_and_b32 v82, 7, v82
  v_lshrrev_b32 v15, 4, v0
  v_and_b32 v15, 3, v15
  v_xor_b32 v82, v82, v15
  v_lshlrev_b32 v82, 5, v82
  v_lshrrev_b32 v15, 4, v0
  v_and_b32 v15, 3, v15
  v_lshlrev_b32 v15, 8, v15
  v_and_b32 v127, 1, v0
  v_lshlrev_b32 v127, 4, v127
  v_add_u32 v15, v15, v127
  v_add_u32 v82, v82, v15
  v_add_u32 v82, s73, v82
  v_xor_b32 v88, 0x80, v82
  v_lshrrev_b32 v83, 4, v0
  v_and_b32 v83, 1, v83
  v_lshrrev_b32 v127, 3, v0
  v_and_b32 v127, 1, v127
  v_lshlrev_b32 v127, 1, v127
  v_add_u32 v83, v83, v127
  v_lshrrev_b32 v127, 2, v0
  v_and_b32 v127, 1, v127
  v_lshlrev_b32 v127, 2, v127
  v_add_u32 v83, v83, v127
  s_lshl_b32 s72, s54, 1
  v_xor_b32 v83, s72, v83
  v_lshlrev_b32 v83, 5, v83
  v_lshrrev_b32 v15, 2, v0
  v_and_b32 v15, 1, v15
  v_lshlrev_b32 v15, 12, v15
  v_lshrrev_b32 v127, 5, v0
  v_and_b32 v127, 1, v127
  v_lshlrev_b32 v127, 10, v127
  v_add_u32 v15, v15, v127
  v_lshrrev_b32 v127, 3, v0
  v_and_b32 v127, 1, v127
  v_lshlrev_b32 v127, 9, v127
  v_add_u32 v15, v15, v127
  v_lshrrev_b32 v127, 4, v0
  v_and_b32 v127, 1, v127
  v_lshlrev_b32 v127, 8, v127
  v_add_u32 v15, v15, v127
  v_and_b32 v127, 3, v0
  v_lshlrev_b32 v127, 3, v127
  v_add_u32 v15, v15, v127
  v_add_u32 v15, 0x20000, v15
  v_add_u32 v83, v83, v15
  v_xor_b32 v84, 32, v83
  v_lshrrev_b32 v85, 1, v0
  v_and_b32 v85, 3, v85
  v_lshrrev_b32 v15, 5, v0
  v_and_b32 v15, 1, v15
  v_xor_b32 v85, v85, v15
  v_lshlrev_b32 v85, 5, v85
  v_lshrrev_b32 v15, 3, v0
  v_and_b32 v15, 7, v15
  v_lshlrev_b32 v15, 7, v15
  v_and_b32 v127, 1, v0
  v_lshlrev_b32 v127, 4, v127
  v_add_u32 v15, v15, v127
  v_add_u32 v85, v85, v15
  v_add_u32 v85, s73, v85
  v_xor_b32 v86, 64, v85
  v_lshrrev_b32 v87, 4, v0
  v_and_b32 v87, 1, v87
  v_lshrrev_b32 v127, 3, v0
  v_and_b32 v127, 1, v127
  v_lshlrev_b32 v127, 1, v127
  v_add_u32 v87, v87, v127
  v_lshlrev_b32 v87, 5, v87
  v_lshrrev_b32 v15, 5, v0
  v_and_b32 v15, 1, v15
  v_lshlrev_b32 v15, 11, v15
  v_lshrrev_b32 v127, 4, v0
  v_and_b32 v127, 1, v127
  v_lshlrev_b32 v127, 9, v127
  v_add_u32 v15, v15, v127
  v_lshrrev_b32 v127, 3, v0
  v_and_b32 v127, 1, v127
  v_lshlrev_b32 v127, 10, v127
  v_add_u32 v15, v15, v127
  v_lshrrev_b32 v127, 2, v0
  v_and_b32 v127, 1, v127
  v_lshlrev_b32 v127, 7, v127
  v_add_u32 v15, v15, v127
  v_and_b32 v127, 3, v0
  v_lshlrev_b32 v127, 3, v127
  v_add_u32 v15, v15, v127
  v_add_u32 v87, v87, v15
  v_add_u32 v87, s73, v87
  s_lshl_b32 s72, s54, 15
  v_lshlrev_b32 v9, 4, v0
  v_add_u32 v9, s72, v9
  s_mov_b32 s8, s30
  s_and_b32 s9, s31, 0xffff
  s_mov_b32 s10, 0x400000
  s_mov_b32 s11, 0x20000
  s_mov_b32 s74, 0x100000
  buffer_load_dwordx4 v[16:19], v80, s[8:11], s74 offen
  s_mov_b32 s74, 0x108000
  buffer_load_dwordx4 v[20:23], v80, s[8:11], s74 offen
  s_mov_b32 s74, 0x110000
  buffer_load_dwordx4 v[24:27], v80, s[8:11], s74 offen
  s_mov_b32 s74, 0x118000
  buffer_load_dwordx4 v[28:31], v80, s[8:11], s74 offen
  s_mov_b32 s74, 0x120000
  buffer_load_dwordx4 v[32:35], v80, s[8:11], s74 offen
  s_mov_b32 s74, 0x128000
  buffer_load_dwordx4 v[36:39], v80, s[8:11], s74 offen
  s_mov_b32 s74, 0x130000
  buffer_load_dwordx4 v[40:43], v80, s[8:11], s74 offen
  s_mov_b32 s74, 0x138000
  buffer_load_dwordx4 v[44:47], v80, s[8:11], s74 offen
  s_mov_b32 s12, s30
  s_and_b32 s13, s31, 0xffff
  s_mov_b32 s14, 0x400000
  s_mov_b32 s15, 0x20000
  s_mov_b32 s74, 0x0
  buffer_load_dwordx4 a[0:3], v80, s[12:15], s74 offen
  s_mov_b32 s74, 0x8000
  buffer_load_dwordx4 a[4:7], v80, s[12:15], s74 offen
  s_mov_b32 s74, 0x10000
  buffer_load_dwordx4 a[8:11], v80, s[12:15], s74 offen
  s_mov_b32 s74, 0x18000
  buffer_load_dwordx4 a[12:15], v80, s[12:15], s74 offen
  s_mov_b32 s74, 0x20000
  buffer_load_dwordx4 a[16:19], v80, s[12:15], s74 offen
  s_mov_b32 s74, 0x28000
  buffer_load_dwordx4 a[20:23], v80, s[12:15], s74 offen
  s_mov_b32 s74, 0x30000
  buffer_load_dwordx4 a[24:27], v80, s[12:15], s74 offen
  s_mov_b32 s74, 0x38000
  buffer_load_dwordx4 a[28:31], v80, s[12:15], s74 offen
  s_waitcnt vmcnt(8)
  ds_write_b128 v82, v[16:19] offset:0
  ds_write_b128 v82, v[20:23] offset:1024
  ds_write_b128 v82, v[24:27] offset:2048
  ds_write_b128 v82, v[28:31] offset:3072
  ds_write_b128 v88, v[32:35] offset:4096
  ds_write_b128 v88, v[36:39] offset:5120
  ds_write_b128 v88, v[40:43] offset:6144
  ds_write_b128 v88, v[44:47] offset:7168
  s_waitcnt lgkmcnt(0)
  s_barrier
  ds_read_b64_tr_b16 v[16:17], v83 offset:0
  ds_read_b64_tr_b16 v[18:19], v83 offset:8192
  ds_read_b64_tr_b16 v[20:21], v83 offset:2048
  ds_read_b64_tr_b16 v[22:23], v83 offset:10240
  ds_read_b64_tr_b16 v[24:25], v84 offset:0
  ds_read_b64_tr_b16 v[26:27], v84 offset:8192
  ds_read_b64_tr_b16 v[28:29], v84 offset:2048
  ds_read_b64_tr_b16 v[30:31], v84 offset:10240
  s_waitcnt lgkmcnt(0)
  ds_read_b64_tr_b16 v[32:33], v83 offset:16384
  ds_read_b64_tr_b16 v[34:35], v83 offset:24576
  ds_read_b64_tr_b16 v[36:37], v83 offset:18432
  ds_read_b64_tr_b16 v[38:39], v83 offset:26624
  ds_read_b64_tr_b16 v[40:41], v84 offset:16384
  ds_read_b64_tr_b16 v[42:43], v84 offset:24576
  ds_read_b64_tr_b16 v[44:45], v84 offset:18432
  ds_read_b64_tr_b16 v[46:47], v84 offset:26624
  s_waitcnt lgkmcnt(0)
  s_barrier
  ds_write_b128 v9, v[16:19] offset:0
  ds_write_b128 v9, v[20:23] offset:1024
  ds_write_b128 v9, v[24:27] offset:2048
  ds_write_b128 v9, v[28:31] offset:3072
  ds_write_b128 v9, v[32:35] offset:4096
  ds_write_b128 v9, v[36:39] offset:5120
  ds_write_b128 v9, v[40:43] offset:6144
  ds_write_b128 v9, v[44:47] offset:7168
  s_waitcnt lgkmcnt(0)
  s_cmp_eq_u32 s54, 0
  s_cbranch_scc0 L_m0_skip
  v_and_b32 v12, 3, v0
  v_lshlrev_b32 v12, 5, v12
  v_lshrrev_b32 v127, 4, v0
  v_and_b32 v127, 1, v127
  v_lshlrev_b32 v127, 4, v127
  v_add_u32 v12, v12, v127
  v_lshrrev_b32 v127, 2, v0
  v_and_b32 v127, 1, v127
  v_lshlrev_b32 v127, 3, v127
  v_add_u32 v12, v12, v127
  s_lshl_b32 s72, s52, 7
  v_add_u32 v12, s72, v12
  s_mov_b32 exec_lo, 0x00ff00ff
  s_mov_b32 exec_hi, 0
  v_lshl_or_b32 v92, v93, 16, v92
  v_lshl_or_b32 v93, v95, 16, v94
  v_min_u32 v92, 0xfffffffe, v92
  v_min_u32 v93, 0xfffffffe, v93
  s_mov_b32 s73, 0x42c0000
  buffer_store_dwordx2 v[92:93], v12, s[4:7], s73 offen
  v_lshl_or_b32 v96, v97, 16, v96
  v_lshl_or_b32 v97, v99, 16, v98
  v_min_u32 v96, 0xfffffffe, v96
  v_min_u32 v97, 0xfffffffe, v97
  s_mov_b32 s73, 0x42c1000
  buffer_store_dwordx2 v[96:97], v12, s[4:7], s73 offen
  s_mov_b64 exec, -1
L_m0_skip:
  s_mov_b32 s8, s30
  s_and_b32 s9, s31, 0xffff
  s_mov_b32 s10, 0x400000
  s_mov_b32 s11, 0x20000
  s_mov_b32 s74, 0x200000
  buffer_load_dwordx4 a[32:35], v80, s[8:11], s74 offen
  s_mov_b32 s74, 0x208000
  buffer_load_dwordx4 a[36:39], v80, s[8:11], s74 offen
  s_mov_b32 s74, 0x210000
  buffer_load_dwordx4 a[40:43], v80, s[8:11], s74 offen
  s_mov_b32 s74, 0x218000
  buffer_load_dwordx4 a[44:47], v80, s[8:11], s74 offen
  s_mov_b32 s74, 0x220000
  buffer_load_dwordx4 a[48:51], v80, s[8:11], s74 offen
  s_mov_b32 s74, 0x228000
  buffer_load_dwordx4 a[52:55], v80, s[8:11], s74 offen
  s_mov_b32 s74, 0x230000
  buffer_load_dwordx4 a[56:59], v80, s[8:11], s74 offen
  s_mov_b32 s74, 0x238000
  buffer_load_dwordx4 a[60:63], v80, s[8:11], s74 offen
  s_waitcnt vmcnt(8)
  ds_write_b128 v82, a[0:3] offset:0
  ds_write_b128 v82, a[4:7] offset:1024
  ds_write_b128 v82, a[8:11] offset:2048
  ds_write_b128 v82, a[12:15] offset:3072
  ds_write_b128 v88, a[16:19] offset:4096
  ds_write_b128 v88, a[20:23] offset:5120
  ds_write_b128 v88, a[24:27] offset:6144
  ds_write_b128 v88, a[28:31] offset:7168
  s_waitcnt lgkmcnt(0)
  s_barrier
  ds_read_b64_tr_b16 a[0:1], v83 offset:0
  ds_read_b64_tr_b16 a[2:3], v83 offset:8192
  ds_read_b64_tr_b16 a[4:5], v83 offset:2048
  ds_read_b64_tr_b16 a[6:7], v83 offset:10240
  ds_read_b64_tr_b16 a[8:9], v84 offset:0
  ds_read_b64_tr_b16 a[10:11], v84 offset:8192
  ds_read_b64_tr_b16 a[12:13], v84 offset:2048
  ds_read_b64_tr_b16 a[14:15], v84 offset:10240
  s_waitcnt lgkmcnt(0)
  ds_read_b64_tr_b16 a[16:17], v83 offset:16384
  ds_read_b64_tr_b16 a[18:19], v83 offset:24576
  ds_read_b64_tr_b16 a[20:21], v83 offset:18432
  ds_read_b64_tr_b16 a[22:23], v83 offset:26624
  ds_read_b64_tr_b16 a[24:25], v84 offset:16384
  ds_read_b64_tr_b16 a[26:27], v84 offset:24576
  ds_read_b64_tr_b16 a[28:29], v84 offset:18432
  ds_read_b64_tr_b16 a[30:31], v84 offset:26624
  s_waitcnt lgkmcnt(0)
  s_barrier
  s_mov_b32 s12, s28
  s_and_b32 s13, s29, 0xffff
  s_mov_b32 s14, 0x400000
  s_mov_b32 s15, 0x20000
  s_mov_b32 s74, 0x0
  buffer_load_dwordx4 a[64:67], v80, s[12:15], s74 offen
  s_mov_b32 s74, 0x8000
  buffer_load_dwordx4 a[68:71], v80, s[12:15], s74 offen
  s_mov_b32 s74, 0x10000
  buffer_load_dwordx4 a[72:75], v80, s[12:15], s74 offen
  s_mov_b32 s74, 0x18000
  buffer_load_dwordx4 a[76:79], v80, s[12:15], s74 offen
  s_mov_b32 s74, 0x20000
  buffer_load_dwordx4 a[80:83], v80, s[12:15], s74 offen
  s_mov_b32 s74, 0x28000
  buffer_load_dwordx4 a[84:87], v80, s[12:15], s74 offen
  s_mov_b32 s74, 0x30000
  buffer_load_dwordx4 a[88:91], v80, s[12:15], s74 offen
  s_mov_b32 s74, 0x38000
  buffer_load_dwordx4 a[92:95], v80, s[12:15], s74 offen
  s_waitcnt vmcnt(8)
  ds_write_b128 v82, a[32:35] offset:0
  ds_write_b128 v82, a[36:39] offset:1024
  ds_write_b128 v82, a[40:43] offset:2048
  ds_write_b128 v82, a[44:47] offset:3072
  ds_write_b128 v88, a[48:51] offset:4096
  ds_write_b128 v88, a[52:55] offset:5120
  ds_write_b128 v88, a[56:59] offset:6144
  ds_write_b128 v88, a[60:63] offset:7168
  s_waitcnt lgkmcnt(0)
  s_barrier
  ds_read_b64_tr_b16 a[32:33], v83 offset:0
  ds_read_b64_tr_b16 a[34:35], v83 offset:8192
  ds_read_b64_tr_b16 a[36:37], v83 offset:2048
  ds_read_b64_tr_b16 a[38:39], v83 offset:10240
  ds_read_b64_tr_b16 a[40:41], v84 offset:0
  ds_read_b64_tr_b16 a[42:43], v84 offset:8192
  ds_read_b64_tr_b16 a[44:45], v84 offset:2048
  ds_read_b64_tr_b16 a[46:47], v84 offset:10240
  s_waitcnt lgkmcnt(0)
  ds_read_b64_tr_b16 a[48:49], v83 offset:16384
  ds_read_b64_tr_b16 a[50:51], v83 offset:24576
  ds_read_b64_tr_b16 a[52:53], v83 offset:18432
  ds_read_b64_tr_b16 a[54:55], v83 offset:26624
  ds_read_b64_tr_b16 a[56:57], v84 offset:16384
  ds_read_b64_tr_b16 a[58:59], v84 offset:24576
  ds_read_b64_tr_b16 a[60:61], v84 offset:18432
  ds_read_b64_tr_b16 a[62:63], v84 offset:26624
  s_waitcnt lgkmcnt(0)
  s_barrier
  s_mov_b32 s8, s28
  s_and_b32 s9, s29, 0xffff
  s_mov_b32 s10, 0x400000
  s_mov_b32 s11, 0x20000
  s_mov_b32 s74, 0x200000
  buffer_load_dwordx4 a[96:99], v80, s[8:11], s74 offen
  s_mov_b32 s74, 0x208000
  buffer_load_dwordx4 a[100:103], v80, s[8:11], s74 offen
  s_mov_b32 s74, 0x210000
  buffer_load_dwordx4 a[104:107], v80, s[8:11], s74 offen
  s_mov_b32 s74, 0x218000
  buffer_load_dwordx4 a[108:111], v80, s[8:11], s74 offen
  s_mov_b32 s74, 0x220000
  buffer_load_dwordx4 a[112:115], v80, s[8:11], s74 offen
  s_mov_b32 s74, 0x228000
  buffer_load_dwordx4 a[116:119], v80, s[8:11], s74 offen
  s_mov_b32 s74, 0x230000
  buffer_load_dwordx4 a[120:123], v80, s[8:11], s74 offen
  s_mov_b32 s74, 0x238000
  buffer_load_dwordx4 a[124:127], v80, s[8:11], s74 offen
  s_waitcnt vmcnt(8)
  ds_write_b128 v82, a[64:67] offset:0
  ds_write_b128 v82, a[68:71] offset:1024
  ds_write_b128 v82, a[72:75] offset:2048
  ds_write_b128 v82, a[76:79] offset:3072
  ds_write_b128 v88, a[80:83] offset:4096
  ds_write_b128 v88, a[84:87] offset:5120
  ds_write_b128 v88, a[88:91] offset:6144
  ds_write_b128 v88, a[92:95] offset:7168
  s_waitcnt lgkmcnt(0)
  s_barrier
  ds_read_b64_tr_b16 a[64:65], v83 offset:0
  ds_read_b64_tr_b16 a[66:67], v83 offset:8192
  ds_read_b64_tr_b16 a[68:69], v83 offset:2048
  ds_read_b64_tr_b16 a[70:71], v83 offset:10240
  ds_read_b64_tr_b16 a[72:73], v84 offset:0
  ds_read_b64_tr_b16 a[74:75], v84 offset:8192
  ds_read_b64_tr_b16 a[76:77], v84 offset:2048
  ds_read_b64_tr_b16 a[78:79], v84 offset:10240
  s_waitcnt lgkmcnt(0)
  ds_read_b64_tr_b16 a[80:81], v83 offset:16384
  ds_read_b64_tr_b16 a[82:83], v83 offset:24576
  ds_read_b64_tr_b16 a[84:85], v83 offset:18432
  ds_read_b64_tr_b16 a[86:87], v83 offset:26624
  ds_read_b64_tr_b16 a[88:89], v84 offset:16384
  ds_read_b64_tr_b16 a[90:91], v84 offset:24576
  ds_read_b64_tr_b16 a[92:93], v84 offset:18432
  ds_read_b64_tr_b16 a[94:95], v84 offset:26624
  s_waitcnt lgkmcnt(0)
  s_barrier
  s_mov_b32 s12, s28
  s_and_b32 s13, s29, 0xffff
  s_mov_b32 s14, 0x400000
  s_mov_b32 s15, 0x20000
  s_mov_b32 s74, 0x100000
  buffer_load_dwordx4 v[48:51], v80, s[12:15], s74 offen
  s_mov_b32 s74, 0x108000
  buffer_load_dwordx4 v[52:55], v80, s[12:15], s74 offen
  s_mov_b32 s74, 0x110000
  buffer_load_dwordx4 v[56:59], v80, s[12:15], s74 offen
  s_mov_b32 s74, 0x118000
  buffer_load_dwordx4 v[60:63], v80, s[12:15], s74 offen
  s_mov_b32 s74, 0x120000
  buffer_load_dwordx4 v[64:67], v80, s[12:15], s74 offen
  s_mov_b32 s74, 0x128000
  buffer_load_dwordx4 v[68:71], v80, s[12:15], s74 offen
  s_mov_b32 s74, 0x130000
  buffer_load_dwordx4 v[72:75], v80, s[12:15], s74 offen
  s_mov_b32 s74, 0x138000
  buffer_load_dwordx4 v[76:79], v80, s[12:15], s74 offen
  s_waitcnt vmcnt(8)
  ds_write_b128 v82, a[96:99] offset:0
  ds_write_b128 v82, a[100:103] offset:1024
  ds_write_b128 v82, a[104:107] offset:2048
  ds_write_b128 v82, a[108:111] offset:3072
  ds_write_b128 v88, a[112:115] offset:4096
  ds_write_b128 v88, a[116:119] offset:5120
  ds_write_b128 v88, a[120:123] offset:6144
  ds_write_b128 v88, a[124:127] offset:7168
  s_waitcnt lgkmcnt(0)
  s_barrier
  ds_read_b64_tr_b16 a[96:97], v83 offset:0
  ds_read_b64_tr_b16 a[98:99], v83 offset:8192
  ds_read_b64_tr_b16 a[100:101], v83 offset:2048
  ds_read_b64_tr_b16 a[102:103], v83 offset:10240
  ds_read_b64_tr_b16 a[104:105], v84 offset:0
  ds_read_b64_tr_b16 a[106:107], v84 offset:8192
  ds_read_b64_tr_b16 a[108:109], v84 offset:2048
  ds_read_b64_tr_b16 a[110:111], v84 offset:10240
  s_waitcnt lgkmcnt(0)
  ds_read_b64_tr_b16 a[112:113], v83 offset:16384
  ds_read_b64_tr_b16 a[114:115], v83 offset:24576
  ds_read_b64_tr_b16 a[116:117], v83 offset:18432
  ds_read_b64_tr_b16 a[118:119], v83 offset:26624
  ds_read_b64_tr_b16 a[120:121], v84 offset:16384
  ds_read_b64_tr_b16 a[122:123], v84 offset:24576
  ds_read_b64_tr_b16 a[124:125], v84 offset:18432
  ds_read_b64_tr_b16 a[126:127], v84 offset:26624
  s_waitcnt lgkmcnt(0)
  s_barrier
  s_mov_b32 s8, s28
  s_and_b32 s9, s29, 0xffff
  s_mov_b32 s10, 0x400000
  s_mov_b32 s11, 0x20000
  s_mov_b32 s74, 0x300000
  buffer_load_dwordx4 a[128:131], v80, s[8:11], s74 offen
  s_mov_b32 s74, 0x308000
  buffer_load_dwordx4 a[132:135], v80, s[8:11], s74 offen
  s_mov_b32 s74, 0x310000
  buffer_load_dwordx4 a[136:139], v80, s[8:11], s74 offen
  s_mov_b32 s74, 0x318000
  buffer_load_dwordx4 a[140:143], v80, s[8:11], s74 offen
  s_mov_b32 s74, 0x320000
  buffer_load_dwordx4 a[144:147], v80, s[8:11], s74 offen
  s_mov_b32 s74, 0x328000
  buffer_load_dwordx4 a[148:151], v80, s[8:11], s74 offen
  s_mov_b32 s74, 0x330000
  buffer_load_dwordx4 a[152:155], v80, s[8:11], s74 offen
  s_mov_b32 s74, 0x338000
  buffer_load_dwordx4 a[156:159], v80, s[8:11], s74 offen
  s_waitcnt vmcnt(8)
  ds_write_b128 v82, v[48:51] offset:0
  ds_write_b128 v82, v[52:55] offset:1024
  ds_write_b128 v82, v[56:59] offset:2048
  ds_write_b128 v82, v[60:63] offset:3072
  ds_write_b128 v88, v[64:67] offset:4096
  ds_write_b128 v88, v[68:71] offset:5120
  ds_write_b128 v88, v[72:75] offset:6144
  ds_write_b128 v88, v[76:79] offset:7168
  s_waitcnt lgkmcnt(0)
  s_barrier
  ds_read_b64_tr_b16 v[48:49], v83 offset:0
  ds_read_b64_tr_b16 v[50:51], v83 offset:8192
  ds_read_b64_tr_b16 v[52:53], v83 offset:2048
  ds_read_b64_tr_b16 v[54:55], v83 offset:10240
  ds_read_b64_tr_b16 v[56:57], v84 offset:0
  ds_read_b64_tr_b16 v[58:59], v84 offset:8192
  ds_read_b64_tr_b16 v[60:61], v84 offset:2048
  ds_read_b64_tr_b16 v[62:63], v84 offset:10240
  s_waitcnt lgkmcnt(0)
  ds_read_b64_tr_b16 v[64:65], v83 offset:16384
  ds_read_b64_tr_b16 v[66:67], v83 offset:24576
  ds_read_b64_tr_b16 v[68:69], v83 offset:18432
  ds_read_b64_tr_b16 v[70:71], v83 offset:26624
  ds_read_b64_tr_b16 v[72:73], v84 offset:16384
  ds_read_b64_tr_b16 v[74:75], v84 offset:24576
  ds_read_b64_tr_b16 v[76:77], v84 offset:18432
  ds_read_b64_tr_b16 v[78:79], v84 offset:26624
  s_waitcnt lgkmcnt(0)
  s_barrier
  ds_write_b128 v9, v[48:51] offset:8192
  ds_write_b128 v9, v[52:55] offset:9216
  ds_write_b128 v9, v[56:59] offset:10240
  ds_write_b128 v9, v[60:63] offset:11264
  ds_write_b128 v9, v[64:67] offset:12288
  ds_write_b128 v9, v[68:71] offset:13312
  ds_write_b128 v9, v[72:75] offset:14336
  ds_write_b128 v9, v[76:79] offset:15360
  s_waitcnt lgkmcnt(0)
  s_mov_b32 s12, s32
  s_and_b32 s13, s33, 0xffff
  s_mov_b32 s14, 0x400000
  s_mov_b32 s15, 0x20000
  s_mov_b32 s74, 0x0
  buffer_load_dwordx4 a[160:163], v80, s[12:15], s74 offen
  s_mov_b32 s74, 0x8000
  buffer_load_dwordx4 a[164:167], v80, s[12:15], s74 offen
  s_mov_b32 s74, 0x10000
  buffer_load_dwordx4 a[168:171], v80, s[12:15], s74 offen
  s_mov_b32 s74, 0x18000
  buffer_load_dwordx4 a[172:175], v80, s[12:15], s74 offen
  s_mov_b32 s74, 0x20000
  buffer_load_dwordx4 a[176:179], v80, s[12:15], s74 offen
  s_mov_b32 s74, 0x28000
  buffer_load_dwordx4 a[180:183], v80, s[12:15], s74 offen
  s_mov_b32 s74, 0x30000
  buffer_load_dwordx4 a[184:187], v80, s[12:15], s74 offen
  s_mov_b32 s74, 0x38000
  buffer_load_dwordx4 a[188:191], v80, s[12:15], s74 offen
  s_waitcnt vmcnt(8)
  ds_write_b128 v82, a[128:131] offset:0
  ds_write_b128 v82, a[132:135] offset:1024
  ds_write_b128 v82, a[136:139] offset:2048
  ds_write_b128 v82, a[140:143] offset:3072
  ds_write_b128 v88, a[144:147] offset:4096
  ds_write_b128 v88, a[148:151] offset:5120
  ds_write_b128 v88, a[152:155] offset:6144
  ds_write_b128 v88, a[156:159] offset:7168
  s_waitcnt lgkmcnt(0)
  s_barrier
  ds_read_b64_tr_b16 a[128:129], v83 offset:0
  ds_read_b64_tr_b16 a[130:131], v83 offset:8192
  ds_read_b64_tr_b16 a[132:133], v83 offset:2048
  ds_read_b64_tr_b16 a[134:135], v83 offset:10240
  ds_read_b64_tr_b16 a[136:137], v84 offset:0
  ds_read_b64_tr_b16 a[138:139], v84 offset:8192
  ds_read_b64_tr_b16 a[140:141], v84 offset:2048
  ds_read_b64_tr_b16 a[142:143], v84 offset:10240
  s_waitcnt lgkmcnt(0)
  ds_read_b64_tr_b16 a[144:145], v83 offset:16384
  ds_read_b64_tr_b16 a[146:147], v83 offset:24576
  ds_read_b64_tr_b16 a[148:149], v83 offset:18432
  ds_read_b64_tr_b16 a[150:151], v83 offset:26624
  ds_read_b64_tr_b16 a[152:153], v84 offset:16384
  ds_read_b64_tr_b16 a[154:155], v84 offset:24576
  ds_read_b64_tr_b16 a[156:157], v84 offset:18432
  ds_read_b64_tr_b16 a[158:159], v84 offset:26624
  s_waitcnt lgkmcnt(0)
  s_barrier
  s_mov_b32 s8, s32
  s_and_b32 s9, s33, 0xffff
  s_mov_b32 s10, 0x400000
  s_mov_b32 s11, 0x20000
  s_mov_b32 s74, 0x100000
  buffer_load_dwordx4 a[192:195], v80, s[8:11], s74 offen
  s_mov_b32 s74, 0x108000
  buffer_load_dwordx4 a[196:199], v80, s[8:11], s74 offen
  s_mov_b32 s74, 0x110000
  buffer_load_dwordx4 a[200:203], v80, s[8:11], s74 offen
  s_mov_b32 s74, 0x118000
  buffer_load_dwordx4 a[204:207], v80, s[8:11], s74 offen
  s_mov_b32 s74, 0x120000
  buffer_load_dwordx4 a[208:211], v80, s[8:11], s74 offen
  s_mov_b32 s74, 0x128000
  buffer_load_dwordx4 a[212:215], v80, s[8:11], s74 offen
  s_mov_b32 s74, 0x130000
  buffer_load_dwordx4 a[216:219], v80, s[8:11], s74 offen
  s_mov_b32 s74, 0x138000
  buffer_load_dwordx4 a[220:223], v80, s[8:11], s74 offen
  s_waitcnt vmcnt(8)
  ds_write_b128 v82, a[160:163] offset:0
  ds_write_b128 v82, a[164:167] offset:1024
  ds_write_b128 v82, a[168:171] offset:2048
  ds_write_b128 v82, a[172:175] offset:3072
  ds_write_b128 v88, a[176:179] offset:4096
  ds_write_b128 v88, a[180:183] offset:5120
  ds_write_b128 v88, a[184:187] offset:6144
  ds_write_b128 v88, a[188:191] offset:7168
  s_waitcnt lgkmcnt(0)
  s_barrier
  ds_read_b64_tr_b16 a[160:161], v83 offset:0
  ds_read_b64_tr_b16 a[162:163], v83 offset:8192
  ds_read_b64_tr_b16 a[164:165], v83 offset:2048
  ds_read_b64_tr_b16 a[166:167], v83 offset:10240
  ds_read_b64_tr_b16 a[168:169], v84 offset:0
  ds_read_b64_tr_b16 a[170:171], v84 offset:8192
  ds_read_b64_tr_b16 a[172:173], v84 offset:2048
  ds_read_b64_tr_b16 a[174:175], v84 offset:10240
  s_waitcnt lgkmcnt(0)
  ds_read_b64_tr_b16 a[176:177], v83 offset:16384
  ds_read_b64_tr_b16 a[178:179], v83 offset:24576
  ds_read_b64_tr_b16 a[180:181], v83 offset:18432
  ds_read_b64_tr_b16 a[182:183], v83 offset:26624
  ds_read_b64_tr_b16 a[184:185], v84 offset:16384
  ds_read_b64_tr_b16 a[186:187], v84 offset:24576
  ds_read_b64_tr_b16 a[188:189], v84 offset:18432
  ds_read_b64_tr_b16 a[190:191], v84 offset:26624
  s_waitcnt lgkmcnt(0)
  s_barrier
  s_cmp_eq_u32 s54, 0
  s_cbranch_scc0 L_ci_arr
  s_mov_b64 exec, 1
  v_mov_b32 v92, 8
  v_mov_b32 v93, 1
  buffer_atomic_add v93, v92, s[16:19], 0 offen
  s_mov_b64 exec, -1
L_ci_arr:
  s_mov_b32 s12, s32
  s_and_b32 s13, s33, 0xffff
  s_mov_b32 s14, 0x400000
  s_mov_b32 s15, 0x20000
  s_mov_b32 s74, 0x200000
  buffer_load_dwordx4 a[224:227], v80, s[12:15], s74 offen
  s_mov_b32 s74, 0x208000
  buffer_load_dwordx4 a[228:231], v80, s[12:15], s74 offen
  s_mov_b32 s74, 0x210000
  buffer_load_dwordx4 a[232:235], v80, s[12:15], s74 offen
  s_mov_b32 s74, 0x218000
  buffer_load_dwordx4 a[236:239], v80, s[12:15], s74 offen
  s_mov_b32 s74, 0x220000
  buffer_load_dwordx4 a[240:243], v80, s[12:15], s74 offen
  s_mov_b32 s74, 0x228000
  buffer_load_dwordx4 a[244:247], v80, s[12:15], s74 offen
  s_mov_b32 s74, 0x230000
  buffer_load_dwordx4 a[248:251], v80, s[12:15], s74 offen
  s_mov_b32 s74, 0x238000
  buffer_load_dwordx4 a[252:255], v80, s[12:15], s74 offen
  s_waitcnt vmcnt(8)
  ds_write_b128 v82, a[192:195] offset:0
  ds_write_b128 v82, a[196:199] offset:1024
  ds_write_b128 v82, a[200:203] offset:2048
  ds_write_b128 v82, a[204:207] offset:3072
  ds_write_b128 v88, a[208:211] offset:4096
  ds_write_b128 v88, a[212:215] offset:5120
  ds_write_b128 v88, a[216:219] offset:6144
  ds_write_b128 v88, a[220:223] offset:7168
  s_waitcnt lgkmcnt(0)
  s_barrier
  ds_read_b64_tr_b16 a[192:193], v83 offset:0
  ds_read_b64_tr_b16 a[194:195], v83 offset:8192
  ds_read_b64_tr_b16 a[196:197], v83 offset:2048
  ds_read_b64_tr_b16 a[198:199], v83 offset:10240
  ds_read_b64_tr_b16 a[200:201], v84 offset:0
  ds_read_b64_tr_b16 a[202:203], v84 offset:8192
  ds_read_b64_tr_b16 a[204:205], v84 offset:2048
  ds_read_b64_tr_b16 a[206:207], v84 offset:10240
  s_waitcnt lgkmcnt(0)
  ds_read_b64_tr_b16 a[208:209], v83 offset:16384
  ds_read_b64_tr_b16 a[210:211], v83 offset:24576
  ds_read_b64_tr_b16 a[212:213], v83 offset:18432
  ds_read_b64_tr_b16 a[214:215], v83 offset:26624
  ds_read_b64_tr_b16 a[216:217], v84 offset:16384
  ds_read_b64_tr_b16 a[218:219], v84 offset:24576
  ds_read_b64_tr_b16 a[220:221], v84 offset:18432
  ds_read_b64_tr_b16 a[222:223], v84 offset:26624
  s_waitcnt lgkmcnt(0)
  s_barrier
  s_mov_b32 s8, s30
  s_and_b32 s9, s31, 0xffff
  s_mov_b32 s10, 0x400000
  s_mov_b32 s11, 0x20000
  s_mov_b32 s74, 0x300000
  buffer_load_dwordx4 v[16:19], v80, s[8:11], s74 offen
  s_mov_b32 s74, 0x308000
  buffer_load_dwordx4 v[20:23], v80, s[8:11], s74 offen
  s_mov_b32 s74, 0x310000
  buffer_load_dwordx4 v[24:27], v80, s[8:11], s74 offen
  s_mov_b32 s74, 0x318000
  buffer_load_dwordx4 v[28:31], v80, s[8:11], s74 offen
  s_mov_b32 s74, 0x320000
  buffer_load_dwordx4 v[32:35], v80, s[8:11], s74 offen
  s_mov_b32 s74, 0x328000
  buffer_load_dwordx4 v[36:39], v80, s[8:11], s74 offen
  s_mov_b32 s74, 0x330000
  buffer_load_dwordx4 v[40:43], v80, s[8:11], s74 offen
  s_mov_b32 s74, 0x338000
  buffer_load_dwordx4 v[44:47], v80, s[8:11], s74 offen
  s_waitcnt vmcnt(8)
  ds_write_b128 v82, a[224:227] offset:0
  ds_write_b128 v82, a[228:231] offset:1024
  ds_write_b128 v82, a[232:235] offset:2048
  ds_write_b128 v82, a[236:239] offset:3072
  ds_write_b128 v88, a[240:243] offset:4096
  ds_write_b128 v88, a[244:247] offset:5120
  ds_write_b128 v88, a[248:251] offset:6144
  ds_write_b128 v88, a[252:255] offset:7168
  s_waitcnt lgkmcnt(0)
  s_barrier
  ds_read_b64_tr_b16 a[224:225], v83 offset:0
  ds_read_b64_tr_b16 a[226:227], v83 offset:8192
  ds_read_b64_tr_b16 a[228:229], v83 offset:2048
  ds_read_b64_tr_b16 a[230:231], v83 offset:10240
  ds_read_b64_tr_b16 a[232:233], v84 offset:0
  ds_read_b64_tr_b16 a[234:235], v84 offset:8192
  ds_read_b64_tr_b16 a[236:237], v84 offset:2048
  ds_read_b64_tr_b16 a[238:239], v84 offset:10240
  s_waitcnt lgkmcnt(0)
  ds_read_b64_tr_b16 a[240:241], v83 offset:16384
  ds_read_b64_tr_b16 a[242:243], v83 offset:24576
  ds_read_b64_tr_b16 a[244:245], v83 offset:18432
  ds_read_b64_tr_b16 a[246:247], v83 offset:26624
  ds_read_b64_tr_b16 a[248:249], v84 offset:16384
  ds_read_b64_tr_b16 a[250:251], v84 offset:24576
  ds_read_b64_tr_b16 a[252:253], v84 offset:18432
  ds_read_b64_tr_b16 a[254:255], v84 offset:26624
  s_waitcnt lgkmcnt(0)
  s_barrier
  s_mov_b32 s12, s32
  s_and_b32 s13, s33, 0xffff
  s_mov_b32 s14, 0x400000
  s_mov_b32 s15, 0x20000
  s_mov_b32 s74, 0x300000
  buffer_load_dwordx4 v[128:131], v80, s[12:15], s74 offen
  s_mov_b32 s74, 0x308000
  buffer_load_dwordx4 v[132:135], v80, s[12:15], s74 offen
  s_mov_b32 s74, 0x310000
  buffer_load_dwordx4 v[136:139], v80, s[12:15], s74 offen
  s_mov_b32 s74, 0x318000
  buffer_load_dwordx4 v[140:143], v80, s[12:15], s74 offen
  s_mov_b32 s74, 0x320000
  buffer_load_dwordx4 v[144:147], v80, s[12:15], s74 offen
  s_mov_b32 s74, 0x328000
  buffer_load_dwordx4 v[148:151], v80, s[12:15], s74 offen
  s_mov_b32 s74, 0x330000
  buffer_load_dwordx4 v[152:155], v80, s[12:15], s74 offen
  s_mov_b32 s74, 0x338000
  buffer_load_dwordx4 v[156:159], v80, s[12:15], s74 offen
  s_waitcnt vmcnt(8)
  ds_write_b128 v82, v[16:19] offset:0
  ds_write_b128 v82, v[20:23] offset:1024
  ds_write_b128 v82, v[24:27] offset:2048
  ds_write_b128 v82, v[28:31] offset:3072
  ds_write_b128 v88, v[32:35] offset:4096
  ds_write_b128 v88, v[36:39] offset:5120
  ds_write_b128 v88, v[40:43] offset:6144
  ds_write_b128 v88, v[44:47] offset:7168
  s_waitcnt lgkmcnt(0)
  s_barrier
  ds_read_b64_tr_b16 v[16:17], v83 offset:0
  ds_read_b64_tr_b16 v[18:19], v83 offset:8192
  ds_read_b64_tr_b16 v[20:21], v83 offset:2048
  ds_read_b64_tr_b16 v[22:23], v83 offset:10240
  ds_read_b64_tr_b16 v[24:25], v84 offset:0
  ds_read_b64_tr_b16 v[26:27], v84 offset:8192
  ds_read_b64_tr_b16 v[28:29], v84 offset:2048
  ds_read_b64_tr_b16 v[30:31], v84 offset:10240
  s_waitcnt lgkmcnt(0)
  ds_read_b64_tr_b16 v[32:33], v83 offset:16384
  ds_read_b64_tr_b16 v[34:35], v83 offset:24576
  ds_read_b64_tr_b16 v[36:37], v83 offset:18432
  ds_read_b64_tr_b16 v[38:39], v83 offset:26624
  ds_read_b64_tr_b16 v[40:41], v84 offset:16384
  ds_read_b64_tr_b16 v[42:43], v84 offset:24576
  ds_read_b64_tr_b16 v[44:45], v84 offset:18432
  ds_read_b64_tr_b16 v[46:47], v84 offset:26624
  s_waitcnt lgkmcnt(0)
  s_barrier
  ds_write_b128 v9, v[16:19] offset:16384
  ds_write_b128 v9, v[20:23] offset:17408
  ds_write_b128 v9, v[24:27] offset:18432
  ds_write_b128 v9, v[28:31] offset:19456
  ds_write_b128 v9, v[32:35] offset:20480
  ds_write_b128 v9, v[36:39] offset:21504
  ds_write_b128 v9, v[40:43] offset:22528
  ds_write_b128 v9, v[44:47] offset:23552
  s_waitcnt lgkmcnt(0)
  s_mov_b32 s8, s34
  s_and_b32 s9, s35, 0xffff
  s_mov_b32 s10, 0x400000
  s_mov_b32 s11, 0x20000
  s_mov_b32 s74, 0x0
  buffer_load_dwordx4 v[160:163], v81, s[8:11], s74 offen
  s_mov_b32 s74, 0x2000
  buffer_load_dwordx4 v[164:167], v81, s[8:11], s74 offen
  s_mov_b32 s74, 0x4000
  buffer_load_dwordx4 v[168:171], v81, s[8:11], s74 offen
  s_mov_b32 s74, 0x6000
  buffer_load_dwordx4 v[172:175], v81, s[8:11], s74 offen
  s_mov_b32 s74, 0x8000
  buffer_load_dwordx4 v[176:179], v81, s[8:11], s74 offen
  s_mov_b32 s74, 0xa000
  buffer_load_dwordx4 v[180:183], v81, s[8:11], s74 offen
  s_mov_b32 s74, 0xc000
  buffer_load_dwordx4 v[184:187], v81, s[8:11], s74 offen
  s_mov_b32 s74, 0xe000
  buffer_load_dwordx4 v[188:191], v81, s[8:11], s74 offen
  s_waitcnt vmcnt(8)
  ds_write_b128 v82, v[128:131] offset:0
  ds_write_b128 v82, v[132:135] offset:1024
  ds_write_b128 v82, v[136:139] offset:2048
  ds_write_b128 v82, v[140:143] offset:3072
  ds_write_b128 v88, v[144:147] offset:4096
  ds_write_b128 v88, v[148:151] offset:5120
  ds_write_b128 v88, v[152:155] offset:6144
  ds_write_b128 v88, v[156:159] offset:7168
  s_waitcnt lgkmcnt(0)
  s_barrier
  ds_read_b64_tr_b16 v[128:129], v83 offset:0
  ds_read_b64_tr_b16 v[130:131], v83 offset:8192
  ds_read_b64_tr_b16 v[132:133], v83 offset:2048
  ds_read_b64_tr_b16 v[134:135], v83 offset:10240
  ds_read_b64_tr_b16 v[136:137], v84 offset:0
  ds_read_b64_tr_b16 v[138:139], v84 offset:8192
  ds_read_b64_tr_b16 v[140:141], v84 offset:2048
  ds_read_b64_tr_b16 v[142:143], v84 offset:10240
  s_waitcnt lgkmcnt(0)
  ds_read_b64_tr_b16 v[144:145], v83 offset:16384
  ds_read_b64_tr_b16 v[146:147], v83 offset:24576
  ds_read_b64_tr_b16 v[148:149], v83 offset:18432
  ds_read_b64_tr_b16 v[150:151], v83 offset:26624
  ds_read_b64_tr_b16 v[152:153], v84 offset:16384
  ds_read_b64_tr_b16 v[154:155], v84 offset:24576
  ds_read_b64_tr_b16 v[156:157], v84 offset:18432
  ds_read_b64_tr_b16 v[158:159], v84 offset:26624
  s_waitcnt lgkmcnt(0)
  s_barrier
  s_mov_b32 s12, s34
  s_and_b32 s13, s35, 0xffff
  s_mov_b32 s14, 0x400000
  s_mov_b32 s15, 0x20000
  s_mov_b32 s74, 0x200
  buffer_load_dwordx4 v[192:195], v81, s[12:15], s74 offen
  s_mov_b32 s74, 0x2200
  buffer_load_dwordx4 v[196:199], v81, s[12:15], s74 offen
  s_mov_b32 s74, 0x4200
  buffer_load_dwordx4 v[200:203], v81, s[12:15], s74 offen
  s_mov_b32 s74, 0x6200
  buffer_load_dwordx4 v[204:207], v81, s[12:15], s74 offen
  s_mov_b32 s74, 0x8200
  buffer_load_dwordx4 v[208:211], v81, s[12:15], s74 offen
  s_mov_b32 s74, 0xa200
  buffer_load_dwordx4 v[212:215], v81, s[12:15], s74 offen
  s_mov_b32 s74, 0xc200
  buffer_load_dwordx4 v[216:219], v81, s[12:15], s74 offen
  s_mov_b32 s74, 0xe200
  buffer_load_dwordx4 v[220:223], v81, s[12:15], s74 offen
  s_waitcnt vmcnt(8)
  ds_write_b128 v85, v[160:163] offset:0
  ds_write_b128 v86, v[164:167] offset:1024
  ds_write_b128 v85, v[168:171] offset:2048
  ds_write_b128 v86, v[172:175] offset:3072
  ds_write_b128 v85, v[176:179] offset:4096
  ds_write_b128 v86, v[180:183] offset:5120
  ds_write_b128 v85, v[184:187] offset:6144
  ds_write_b128 v86, v[188:191] offset:7168
  s_waitcnt lgkmcnt(0)
  ds_read_b64_tr_b16 v[160:161], v87 offset:0
  ds_read_b64_tr_b16 v[162:163], v87 offset:256
  ds_read_b64_tr_b16 v[164:165], v87 offset:4096
  ds_read_b64_tr_b16 v[166:167], v87 offset:4352
  v_xor_b32 v15, 32, v87
  ds_read_b64_tr_b16 v[168:169], v15 offset:0
  ds_read_b64_tr_b16 v[170:171], v15 offset:256
  ds_read_b64_tr_b16 v[172:173], v15 offset:4096
  ds_read_b64_tr_b16 v[174:175], v15 offset:4352
  s_waitcnt lgkmcnt(0)
  v_xor_b32 v15, 64, v87
  ds_read_b64_tr_b16 v[176:177], v15 offset:0
  ds_read_b64_tr_b16 v[178:179], v15 offset:256
  ds_read_b64_tr_b16 v[180:181], v15 offset:4096
  ds_read_b64_tr_b16 v[182:183], v15 offset:4352
  v_xor_b32 v15, 96, v87
  ds_read_b64_tr_b16 v[184:185], v15 offset:0
  ds_read_b64_tr_b16 v[186:187], v15 offset:256
  ds_read_b64_tr_b16 v[188:189], v15 offset:4096
  ds_read_b64_tr_b16 v[190:191], v15 offset:4352
  s_waitcnt lgkmcnt(0)
  s_barrier
  s_mov_b32 s8, s34
  s_and_b32 s9, s35, 0xffff
  s_mov_b32 s10, 0x400000
  s_mov_b32 s11, 0x20000
  s_mov_b32 s74, 0x10000
  buffer_load_dwordx4 v[224:227], v81, s[8:11], s74 offen
  s_mov_b32 s74, 0x12000
  buffer_load_dwordx4 v[228:231], v81, s[8:11], s74 offen
  s_mov_b32 s74, 0x14000
  buffer_load_dwordx4 v[232:235], v81, s[8:11], s74 offen
  s_mov_b32 s74, 0x16000
  buffer_load_dwordx4 v[236:239], v81, s[8:11], s74 offen
  s_mov_b32 s74, 0x18000
  buffer_load_dwordx4 v[240:243], v81, s[8:11], s74 offen
  s_mov_b32 s74, 0x1a000
  buffer_load_dwordx4 v[244:247], v81, s[8:11], s74 offen
  s_mov_b32 s74, 0x1c000
  buffer_load_dwordx4 v[248:251], v81, s[8:11], s74 offen
  s_mov_b32 s74, 0x1e000
  buffer_load_dwordx4 v[252:255], v81, s[8:11], s74 offen
  s_waitcnt vmcnt(8)
  ds_write_b128 v85, v[192:195] offset:0
  ds_write_b128 v86, v[196:199] offset:1024
  ds_write_b128 v85, v[200:203] offset:2048
  ds_write_b128 v86, v[204:207] offset:3072
  ds_write_b128 v85, v[208:211] offset:4096
  ds_write_b128 v86, v[212:215] offset:5120
  ds_write_b128 v85, v[216:219] offset:6144
  ds_write_b128 v86, v[220:223] offset:7168
  s_waitcnt lgkmcnt(0)
  ds_read_b64_tr_b16 v[192:193], v87 offset:0
  ds_read_b64_tr_b16 v[194:195], v87 offset:256
  ds_read_b64_tr_b16 v[196:197], v87 offset:4096
  ds_read_b64_tr_b16 v[198:199], v87 offset:4352
  v_xor_b32 v15, 32, v87
  ds_read_b64_tr_b16 v[200:201], v15 offset:0
  ds_read_b64_tr_b16 v[202:203], v15 offset:256
  ds_read_b64_tr_b16 v[204:205], v15 offset:4096
  ds_read_b64_tr_b16 v[206:207], v15 offset:4352
  s_waitcnt lgkmcnt(0)
  v_xor_b32 v15, 64, v87
  ds_read_b64_tr_b16 v[208:209], v15 offset:0
  ds_read_b64_tr_b16 v[210:211], v15 offset:256
  ds_read_b64_tr_b16 v[212:213], v15 offset:4096
  ds_read_b64_tr_b16 v[214:215], v15 offset:4352
  v_xor_b32 v15, 96, v87
  ds_read_b64_tr_b16 v[216:217], v15 offset:0
  ds_read_b64_tr_b16 v[218:219], v15 offset:256
  ds_read_b64_tr_b16 v[220:221], v15 offset:4096
  ds_read_b64_tr_b16 v[222:223], v15 offset:4352
  s_waitcnt lgkmcnt(0)
  s_barrier
  v_lshlrev_b32 v100, 4, v0
  v_add_u32 v100, 112, v100
  v_cmp_eq_u32 vcc, 0, v0
  s_nop 1
  v_cndmask_b32 v100, v100, 0, vcc
  s_mov_b64 exec, 0xff
  buffer_load_dwordx2 v[102:103], v100, s[16:19], 0 offen sc1
  s_mov_b64 exec, -1
  s_mov_b32 s12, s34
  s_and_b32 s13, s35, 0xffff
  s_mov_b32 s14, 0x400000
  s_mov_b32 s15, 0x20000
  s_mov_b32 s74, 0x10200
  buffer_load_dwordx4 v[48:51], v81, s[12:15], s74 offen
  s_mov_b32 s74, 0x12200
  buffer_load_dwordx4 v[52:55], v81, s[12:15], s74 offen
  s_mov_b32 s74, 0x14200
  buffer_load_dwordx4 v[56:59], v81, s[12:15], s74 offen
  s_mov_b32 s74, 0x16200
  buffer_load_dwordx4 v[60:63], v81, s[12:15], s74 offen
  s_mov_b32 s74, 0x18200
  buffer_load_dwordx4 v[64:67], v81, s[12:15], s74 offen
  s_mov_b32 s74, 0x1a200
  buffer_load_dwordx4 v[68:71], v81, s[12:15], s74 offen
  s_mov_b32 s74, 0x1c200
  buffer_load_dwordx4 v[72:75], v81, s[12:15], s74 offen
  s_mov_b32 s74, 0x1e200
  buffer_load_dwordx4 v[76:79], v81, s[12:15], s74 offen
  s_waitcnt vmcnt(8)
  ds_write_b128 v85, v[224:227] offset:0
  ds_write_b128 v86, v[228:231] offset:1024
  ds_write_b128 v85, v[232:235] offset:2048
  ds_write_b128 v86, v[236:239] offset:3072
  ds_write_b128 v85, v[240:243] offset:4096
  ds_write_b128 v86, v[244:247] offset:5120
  ds_write_b128 v85, v[248:251] offset:6144
  ds_write_b128 v86, v[252:255] offset:7168
  s_waitcnt lgkmcnt(0)
  ds_read_b64_tr_b16 v[224:225], v87 offset:0
  ds_read_b64_tr_b16 v[226:227], v87 offset:256
  ds_read_b64_tr_b16 v[228:229], v87 offset:4096
  ds_read_b64_tr_b16 v[230:231], v87 offset:4352
  v_xor_b32 v15, 32, v87
  ds_read_b64_tr_b16 v[232:233], v15 offset:0
  ds_read_b64_tr_b16 v[234:235], v15 offset:256
  ds_read_b64_tr_b16 v[236:237], v15 offset:4096
  ds_read_b64_tr_b16 v[238:239], v15 offset:4352
  s_waitcnt lgkmcnt(0)
  v_xor_b32 v15, 64, v87
  ds_read_b64_tr_b16 v[240:241], v15 offset:0
  ds_read_b64_tr_b16 v[242:243], v15 offset:256
  ds_read_b64_tr_b16 v[244:245], v15 offset:4096
  ds_read_b64_tr_b16 v[246:247], v15 offset:4352
  v_xor_b32 v15, 96, v87
  ds_read_b64_tr_b16 v[248:249], v15 offset:0
  ds_read_b64_tr_b16 v[250:251], v15 offset:256
  ds_read_b64_tr_b16 v[252:253], v15 offset:4096
  ds_read_b64_tr_b16 v[254:255], v15 offset:4352
  s_waitcnt lgkmcnt(0)
  s_barrier
  s_waitcnt vmcnt(0)
  ds_write_b128 v85, v[48:51] offset:0
  ds_write_b128 v86, v[52:55] offset:1024
  ds_write_b128 v85, v[56:59] offset:2048
  ds_write_b128 v86, v[60:63] offset:3072
  ds_write_b128 v85, v[64:67] offset:4096
  ds_write_b128 v86, v[68:71] offset:5120
  ds_write_b128 v85, v[72:75] offset:6144
  ds_write_b128 v86, v[76:79] offset:7168
  s_waitcnt lgkmcnt(0)
  ds_read_b64_tr_b16 v[48:49], v87 offset:0
  ds_read_b64_tr_b16 v[50:51], v87 offset:256
  ds_read_b64_tr_b16 v[52:53], v87 offset:4096
  ds_read_b64_tr_b16 v[54:55], v87 offset:4352
  v_xor_b32 v15, 32, v87
  ds_read_b64_tr_b16 v[56:57], v15 offset:0
  ds_read_b64_tr_b16 v[58:59], v15 offset:256
  ds_read_b64_tr_b16 v[60:61], v15 offset:4096
  ds_read_b64_tr_b16 v[62:63], v15 offset:4352
  s_waitcnt lgkmcnt(0)
  v_xor_b32 v15, 64, v87
  ds_read_b64_tr_b16 v[64:65], v15 offset:0
  ds_read_b64_tr_b16 v[66:67], v15 offset:256
  ds_read_b64_tr_b16 v[68:69], v15 offset:4096
  ds_read_b64_tr_b16 v[70:71], v15 offset:4352
  v_xor_b32 v15, 96, v87
  ds_read_b64_tr_b16 v[72:73], v15 offset:0
  ds_read_b64_tr_b16 v[74:75], v15 offset:256
  ds_read_b64_tr_b16 v[76:77], v15 offset:4096
  ds_read_b64_tr_b16 v[78:79], v15 offset:4352
  s_waitcnt lgkmcnt(0)
  s_barrier
  ds_write_b128 v9, v[48:51] offset:24576
  ds_write_b128 v9, v[52:55] offset:25600
  ds_write_b128 v9, v[56:59] offset:26624
  ds_write_b128 v9, v[60:63] offset:27648
  ds_write_b128 v9, v[64:67] offset:28672
  ds_write_b128 v9, v[68:71] offset:29696
  ds_write_b128 v9, v[72:75] offset:30720
  ds_write_b128 v9, v[76:79] offset:31744
  s_waitcnt lgkmcnt(0)
  s_waitcnt lgkmcnt(0)
  s_barrier
  v_lshlrev_b32 v122, 4, v0
  v_add_u32 v122, 112, v122
  v_cmp_eq_u32 vcc, 0, v0
  s_nop 1
  v_cndmask_b32 v122, v122, 0, vcc
  v_lshlrev_b32 v1, 4, v0
  s_lshl_b32 s72, s54, 10
  s_add_u32 s72, s72, 0x24000
  v_add_u32 v2, s72, v1
  v_lshrrev_b32 v3, 4, v0
  v_and_b32 v3, 3, v3
  v_lshlrev_b32 v3, 8, v3
  v_lshrrev_b32 v127, 1, v0
  v_and_b32 v127, 1, v127
  v_lshlrev_b32 v127, 7, v127
  v_add_u32 v3, v3, v127
  v_lshrrev_b32 v127, 2, v0
  v_and_b32 v127, 3, v127
  v_lshlrev_b32 v127, 5, v127
  v_add_u32 v3, v3, v127
  v_and_b32 v127, 1, v0
  v_lshlrev_b32 v127, 4, v127
  v_add_u32 v3, v3, v127
  v_add_u32 v3, 0x24000, v3
  v_and_b32 v5, 15, v0
  v_lshlrev_b32 v5, 4, v5
  v_lshrrev_b32 v127, 4, v0
  v_and_b32 v127, 3, v127
  v_lshlrev_b32 v127, 2, v127
  v_add_u32 v5, v5, v127
  v_add_u32 v5, 0x26000, v5
  s_lshl_b32 s72, s54, 9
  v_add_u32 v5, s72, v5
  v_and_b32 v4, 15, v0
  v_lshlrev_b32 v4, 5, v4
  v_lshrrev_b32 v127, 4, v0
  v_and_b32 v127, 3, v127
  v_lshlrev_b32 v127, 3, v127
  v_add_u32 v4, v4, v127
  v_add_u32 v4, 0x26800, v4
  s_lshl_b32 s72, s54, 10
  v_add_u32 v4, s72, v4
  v_lshrrev_b32 v6, 4, v0
  v_and_b32 v6, 3, v6
  v_lshlrev_b32 v6, 6, v6
  v_lshrrev_b32 v127, 2, v0
  v_and_b32 v127, 3, v127
  v_lshlrev_b32 v127, 4, v127
  v_add_u32 v6, v6, v127
  v_and_b32 v127, 1, v0
  v_lshlrev_b32 v127, 3, v127
  v_add_u32 v6, v6, v127
  v_add_u32 v6, 0x26000, v6
  v_lshrrev_b32 v7, 1, v0
  v_and_b32 v7, 3, v7
  v_lshlrev_b32 v7, 6, v7
  v_lshrrev_b32 v127, 5, v0
  v_and_b32 v127, 1, v127
  v_lshlrev_b32 v127, 5, v127
  v_add_u32 v7, v7, v127
  v_and_b32 v127, 1, v0
  v_lshlrev_b32 v127, 4, v127
  v_add_u32 v7, v7, v127
  v_lshrrev_b32 v127, 4, v0
  v_and_b32 v127, 1, v127
  v_lshlrev_b32 v127, 3, v127
  v_add_u32 v7, v7, v127
  v_add_u32 v7, 0x27800, v7
  s_lshl_b32 s72, s54, 9
  v_add_u32 v7, s72, v7
  v_add_u32 v8, 0x27800, v1
  v_add_u32 v10, 0x20000, v1
  v_lshrrev_b32 v11, 1, v0
  v_and_b32 v11, 7, v11
  v_lshlrev_b32 v11, 12, v11
  v_and_b32 v127, 1, v0
  v_lshlrev_b32 v127, 6, v127
  v_add_u32 v11, v11, v127
  v_lshrrev_b32 v127, 4, v0
  v_and_b32 v127, 3, v127
  v_lshlrev_b32 v127, 4, v127
  v_add_u32 v11, v11, v127
  s_lshl_b32 s72, s54, 15
  v_add_u32 v11, s72, v11
  s_lshl_b32 s72, s52, 7
  v_add_u32 v11, s72, v11
  v_and_b32 v12, 3, v0
  v_lshlrev_b32 v12, 5, v12
  v_lshrrev_b32 v127, 4, v0
  v_and_b32 v127, 1, v127
  v_lshlrev_b32 v127, 4, v127
  v_add_u32 v12, v12, v127
  v_lshrrev_b32 v127, 2, v0
  v_and_b32 v127, 1, v127
  v_lshlrev_b32 v127, 3, v127
  v_add_u32 v12, v12, v127
  s_lshl_b32 s72, s52, 7
  v_add_u32 v12, s72, v12
  v_mov_b32 v13, 0x4444
  v_mov_b32 v15, 0xeeee
  v_lshrrev_b32 v14, 1, v0
  v_and_b32 v14, 1, v14
  v_cmp_eq_u32 vcc, 1, v14
  s_nop 1
  v_cndmask_b32 v13, v13, v15, vcc
  v_and_b32 v15, 1, v0
  v_lshlrev_b32 v15, 4, v15
  v_mov_b32 v14, 0x3f80
  v_lshlrev_b32 v14, v15, v14
  s_mov_b32 s71, 0x3e0293ee
  s_mov_b32 s2, 0x3e0293ee
  s_mov_b32 s3, 0x3e0293ee
  v_lshlrev_b32 v0, 3, v0
  v_add_u32 v0, 0x26800, v0
  s_mov_b32 s56, 0
  s_and_b32 s72, s54, 1
  s_lshl_b32 s20, s72, 12
  s_lshl_b32 s21, s54, 10
  s_lshl_b32 s22, s72, 17
  s_lshl_b32 s73, s52, 12
  s_add_u32 s22, s22, s73
  s_lshl_b32 s23, s72, 11
  s_add_u32 s23, s23, s73
  s_lshr_b32 s72, s54, 1
  s_lshl_b32 s72, s72, 17
  s_add_u32 s23, s23, s72
  s_mov_b32 s77, 0x42c0000
  s_add_u32 s57, s77, s21
  s_mov_b32 s60, 0x4240000
  s_lshl_b32 s73, s54, 11
  s_lshl_b32 s72, s56, 5
  s_add_u32 s72, s72, s52
  s_lshl_b32 s63, s72, 13
  s_add_u32 s63, s63, s73
  s_add_u32 s64, s63, 0x240000
  s_add_u32 s63, s63, 0x2200000
  s_lshl_b32 s65, s72, 12
  s_lshl_b32 s73, s54, 10
  s_add_u32 s65, s65, s73
  s_add_u32 s66, s65, 0x3a00000
  s_add_u32 s65, s65, 0x3200000
  s_lshl_b32 s72, s52, 7
  s_add_u32 s67, s72, 0x42d1000
  s_add_u32 s68, s72, 0x42d5000
  s_add_u32 s72, s56, 1
  s_and_b32 s72, s72, 1
  s_lshl_b32 s72, s72, 13
  s_lshl_b32 s73, s54, 11
  s_add_u32 s72, s72, s73
  s_add_u32 s69, s72, 0x20000
  s_lshl_b32 s72, s56, 7
  s_lshl_b32 s73, s52, 13
  s_add_u32 s72, s72, s73
  s_lshl_b32 s73, s54, 5
  s_add_u32 s72, s72, s73
  s_add_u32 s76, s72, 0x5000000
  s_waitcnt vmcnt(0)
L_clr_check_f:
  v_readlane_b32 s96, v103, 0
  v_readlane_b32 s97, v103, 1
  v_readlane_b32 s98, v103, 2
  v_readlane_b32 s99, v103, 3
  v_readlane_b32 s100, v103, 4
  v_readlane_b32 s101, v103, 5
  v_readlane_b32 s80, v103, 6
  v_readlane_b32 s81, v103, 7
  s_nop 3
  s_add_u32 s74, s96, s97
  s_add_u32 s74, s74, s98
  s_add_u32 s74, s74, s99
  s_add_u32 s74, s74, s100
  s_add_u32 s74, s74, s101
  s_add_u32 s74, s74, s80
  s_add_u32 s74, s74, s81
  s_cmp_ge_u32 s74, 0x100
  s_cbranch_scc1 L_clr_ok_f
  s_sub_u32 s70, s70, 16
  s_cselect_b32 s70, 0, s70
  s_cbranch_scc1 L_clr_ok_f
  s_sleep 2
  s_mov_b64 exec, 0xff
  buffer_load_dwordx2 v[102:103], v122, s[16:19], 0 offen sc1
  s_mov_b64 exec, -1
  s_waitcnt vmcnt(0)
  s_branch L_clr_check_f
L_clr_ok_f:
  v_readlane_b32 s96, v102, 0
  v_readlane_b32 s97, v102, 1
  v_readlane_b32 s98, v102, 2
  v_readlane_b32 s99, v102, 3
  v_readlane_b32 s100, v102, 4
  v_readlane_b32 s101, v102, 5
  v_readlane_b32 s80, v102, 6
  v_readlane_b32 s81, v102, 7
  s_nop 3
  s_mov_b32 s74, 0
  s_cmp_eq_u32 s96, 32
  s_cselect_b32 s74, s74, 1
  s_cmp_eq_u32 s97, 32
  s_cselect_b32 s74, s74, 1
  s_cmp_eq_u32 s98, 32
  s_cselect_b32 s74, s74, 1
  s_cmp_eq_u32 s99, 32
  s_cselect_b32 s74, s74, 1
  s_cmp_eq_u32 s100, 32
  s_cselect_b32 s74, s74, 1
  s_cmp_eq_u32 s101, 32
  s_cselect_b32 s74, s74, 1
  s_cmp_eq_u32 s80, 32
  s_cselect_b32 s74, s74, 1
  s_cmp_eq_u32 s81, 32
  s_cselect_b32 s74, s74, 1
  s_cmp_eq_u32 s74, 0
  s_cbranch_scc0 L_to_fallback_f
L_start_poll_f:
  s_mov_b64 exec, 0xff
  buffer_load_dwordx4 v[16:19], v122, s[16:19], 0 offen sc1
  s_mov_b64 exec, -1
  buffer_load_dwordx2 v[20:21], off, s[4:7], s67 sc1
  s_waitcnt vmcnt(0)
  v_readlane_b32 s74, v18, 0
  v_readfirstlane_b32 s72, v20
  v_readfirstlane_b32 s73, v21
  s_nop 3
  s_cmp_ge_u32 s74, 32
  s_cbranch_scc0 L_start_again_f
  s_lshl_b32 s72, s72, 1
  s_lshl_b32 s73, s73, 1
  s_add_u32 s73, s73, 1
  s_min_u32 s75, s72, s73
  s_cmp_ge_u32 s75, 1
  s_cbranch_scc1 L_start_ok_f
L_start_again_f:
  s_sub_u32 s70, s70, 16
  s_cselect_b32 s70, 0, s70
  s_cbranch_scc1 L_start_ok_f
  s_sleep 2
  s_branch L_start_poll_f
L_to_fallback_f:
  v_lshrrev_b32 v0, 4, v1
  s_branch L_fallback
L_start_ok_f:
  s_xor_b32 s73, s69, 0x2000
  s_mov_b32 m0, s73
  s_sub_u32 s74, s64, 262144
  buffer_load_dwordx4 v1, s[4:7], s74 offen sc1 lds
  s_add_u32 m0, s73, 1024
  s_add_u32 s74, s74, 1024
  buffer_load_dwordx4 v1, s[4:7], s74 offen sc1 lds
  ds_read_b128 v[48:51], v9 offset:0
  ds_read_b128 v[52:55], v9 offset:1024
  ds_read_b128 v[56:59], v9 offset:2048
  ds_read_b128 v[60:63], v9 offset:3072
  ds_read_b128 v[64:67], v9 offset:4096
  ds_read_b128 v[68:71], v9 offset:5120
  ds_read_b128 v[72:75], v9 offset:6144
  ds_read_b128 v[76:79], v9 offset:7168
  v_mov_b64 v[80:81], 0
  v_mov_b64 v[82:83], 0
  v_mov_b64 v[84:85], 0
  v_mov_b64 v[86:87], 0
  v_mov_b64 v[88:89], 0
  v_mov_b64 v[90:91], 0
  v_mov_b64 v[92:93], 0
  v_mov_b64 v[94:95], 0
  v_mov_b64 v[96:97], 0
  v_mov_b64 v[98:99], 0
  v_mov_b64 v[100:101], 0
  v_mov_b64 v[102:103], 0
  v_mov_b64 v[126:127], 0
L_poll2_f:
  buffer_load_dwordx4 v[112:115], v1, s[4:7], s57 offen sc1
  s_add_u32 s62, s60, s23
  s_xor_b32 s60, s60, 0x40000
  s_add_u32 s61, s60, s22
  s_mov_b32 s78, s77
  s_add_u32 s59, s78, s20
  s_add_u32 s77, s77, 0x2000
  s_and_b32 s77, s77, 0xffff7fff
  s_add_u32 s58, s77, s20
  s_nop 15
  s_nop 1
  buffer_load_dwordx4 v[120:123], v1, s[4:7], s57 offen sc1
L_p2loop_f:
  s_waitcnt vmcnt(1)
  s_waitcnt lgkmcnt(14)
  ds_write_b128 v2, v[112:115]
  v_max3_u32 v15, v112, v113, v114
  v_max_u32 v15, v15, v115
  v_cmp_eq_u32 vcc, -1, v15
  s_nop 0
  s_cbranch_vccnz L_p2n0_f
L_got2_f:
  s_add_u32 s72, s57, 4096
  buffer_load_dwordx4 v[116:119], v1, s[4:7], s72 offen sc1
  s_waitcnt lgkmcnt(0)
  s_barrier
  ds_read_b128 v[16:19], v3 offset:0
  ds_read_b128 v[20:23], v3 offset:1024
  ds_read_b128 v[24:27], v3 offset:2048
  ds_read_b128 v[28:31], v3 offset:3072
  s_waitcnt lgkmcnt(3)
  v_smfmac_f32_16x16x64_bf16 v[80:83], v[16:19], a[0:7], v13
  v_smfmac_f32_16x16x64_bf16 v[84:87], v[16:19], a[8:15], v13
  s_waitcnt lgkmcnt(2)
  buffer_load_dwordx4 v[104:107], v1, s[4:7], s63 offen sc1
  v_smfmac_f32_16x16x64_bf16 v[80:83], v[20:23], a[16:23], v13
  v_smfmac_f32_16x16x64_bf16 v[84:87], v[20:23], a[24:31], v13
  s_waitcnt lgkmcnt(1)
  buffer_load_dwordx4 v[108:111], v1, s[4:7], s63 offen offset:1024 sc1
  v_smfmac_f32_16x16x64_bf16 v[80:83], v[24:27], v[48:55], v13
  ds_read_b128 v[48:51], v9 offset:8192
  ds_read_b128 v[52:55], v9 offset:9216
  v_smfmac_f32_16x16x64_bf16 v[84:87], v[24:27], v[56:63], v13
  s_waitcnt lgkmcnt(2)
  ds_read_b128 v[56:59], v9 offset:10240
  ds_read_b128 v[60:63], v9 offset:11264
  v_smfmac_f32_16x16x64_bf16 v[80:83], v[28:31], v[64:71], v13
  ds_read_b128 v[64:67], v9 offset:12288
  ds_read_b128 v[68:71], v9 offset:13312
  v_smfmac_f32_16x16x64_bf16 v[84:87], v[28:31], v[72:79], v13
  ds_read_b128 v[72:75], v9 offset:14336
  ds_read_b128 v[76:79], v9 offset:15360
  v_smfmac_f32_16x16x64_bf16 v[88:91], v[16:19], a[64:71], v13
  s_waitcnt vmcnt(2)
L_check2b_f:
  v_max3_u32 v15, v116, v117, v118
  v_max_u32 v15, v15, v119
  v_smfmac_f32_16x16x64_bf16 v[92:95], v[16:19], a[72:79], v13
  v_cmp_eq_u32 vcc, -1, v15
  s_nop 0
  s_cbranch_vccnz L_retry2b_f
L_got2b_f:
  ds_write_b128 v2, v[116:119] offset:4096
  v_smfmac_f32_16x16x64_bf16 v[88:91], v[20:23], a[80:87], v13
  v_smfmac_f32_16x16x64_bf16 v[92:95], v[20:23], a[88:95], v13
  v_mov_b64 v[122:123], -1
  s_waitcnt lgkmcnt(0)
  s_barrier
  v_smfmac_f32_16x16x64_bf16 v[88:91], v[24:27], v[48:55], v13
  ds_read_b128 v[32:35], v3 offset:4096
  v_mov_b64 v[124:125], -1
  v_smfmac_f32_16x16x64_bf16 v[92:95], v[24:27], v[56:63], v13
  ds_read_b128 v[36:39], v3 offset:5120
  ds_read_b128 v[48:51], v9 offset:16384
  v_smfmac_f32_16x16x64_bf16 v[88:91], v[28:31], v[64:71], v13
  s_sub_u32 s72, s75, s56
  s_cmp_lt_u32 s72, 6
  s_cbranch_scc0 L_nokvpf_f
  v_readfirstlane_b32 s72, v126
  v_readfirstlane_b32 s73, v127
  s_nop 3
  s_lshl_b32 s72, s72, 1
  s_lshl_b32 s73, s73, 1
  s_add_u32 s73, s73, 1
  s_min_u32 s72, s72, s73
  s_max_u32 s75, s75, s72
  buffer_load_dwordx2 v[126:127], off, s[4:7], s67 sc1
L_nokvpf_f:
  ds_read_b128 v[52:55], v9 offset:17408
  ds_read_b128 v[40:43], v3 offset:6144
  ds_read_b128 v[56:59], v9 offset:18432
  v_smfmac_f32_16x16x64_bf16 v[92:95], v[28:31], v[72:79], v13
  ds_read_b128 v[60:63], v9 offset:19456
  ds_read_b128 v[64:67], v9 offset:20480
  v_smfmac_f32_16x16x64_bf16 v[96:99], v[16:19], a[160:167], v13
  ds_read_b128 v[68:71], v9 offset:21504
  ds_read_b128 v[44:47], v3 offset:7168
  v_smfmac_f32_16x16x64_bf16 v[100:103], v[16:19], a[168:175], v13
  s_waitcnt lgkmcnt(9)
  buffer_store_dwordx4 v[122:125], v1, s[4:7], s62 offen
  ds_read_b128 v[72:75], v9 offset:22528
  v_smfmac_f32_16x16x64_bf16 v[80:83], v[32:35], a[32:39], v13
  ds_read_b128 v[76:79], v9 offset:23552
  v_smfmac_f32_16x16x64_bf16 v[84:87], v[32:35], a[40:47], v13
  s_waitcnt lgkmcnt(10)
  v_smfmac_f32_16x16x64_bf16 v[80:83], v[36:39], a[48:55], v13
  s_add_u32 s74, s56, 1
  s_cmp_lt_u32 s74, s75
  s_cbranch_scc0 L_kvspin_f
L_kvok_f:
  s_mov_b32 m0, s69
  s_nop 0
  buffer_load_dwordx4 v1, s[4:7], s64 offen sc1 lds
  v_smfmac_f32_16x16x64_bf16 v[84:87], v[36:39], a[56:63], v13
  s_waitcnt lgkmcnt(7)
  v_smfmac_f32_16x16x64_bf16 v[80:83], v[40:43], v[48:55], v13
  s_waitcnt lgkmcnt(5)
  v_smfmac_f32_16x16x64_bf16 v[84:87], v[40:43], v[56:63], v13
  s_waitcnt lgkmcnt(2)
  v_mov_b32 v15, s56
  v_smfmac_f32_16x16x64_bf16 v[80:83], v[44:47], v[64:71], v13
  s_waitcnt lgkmcnt(0)
  s_cmp_eq_u32 s54, 2
  s_cselect_b64 exec, 1, 0
  buffer_store_dword v15, off, s[4:7], s68 sc1
  s_mov_b64 exec, -1
  v_smfmac_f32_16x16x64_bf16 v[84:87], v[44:47], v[72:79], v13
  v_smfmac_f32_16x16x64_bf16 v[88:91], v[32:35], a[96:103], v13
  s_nop 2
  v_smfmac_f32_16x16x64_bf16 v[92:95], v[32:35], a[104:111], v13
  s_nop 2
  v_smfmac_f32_16x16x64_bf16 v[88:91], v[36:39], a[112:119], v13
  buffer_store_dwordx4 v[122:125], v1, s[4:7], s62 offen offset:1024
  v_add_f32 v80, v80, v82
  v_smfmac_f32_16x16x64_bf16 v[92:95], v[36:39], a[120:127], v13
  v_add_f32 v81, v81, v83
  v_cvt_pk_bf16_f32 v80, v80, v81
  v_smfmac_f32_16x16x64_bf16 v[88:91], v[40:43], a[128:135], v13
  v_add_f32 v84, v84, v86
  v_add_f32 v85, v85, v87
  v_smfmac_f32_16x16x64_bf16 v[92:95], v[40:43], a[136:143], v13
  v_cvt_pk_bf16_f32 v84, v84, v85
  ds_write2_b32 v4, v80, v80 offset0:0 offset1:1
  v_smfmac_f32_16x16x64_bf16 v[88:91], v[44:47], a[144:151], v13
  s_add_u32 m0, s69, 1024
  s_add_u32 s73, s64, 1024
  buffer_load_dwordx4 v1, s[4:7], s73 offen sc1 lds
  ds_write2_b32 v4, v84, v84 offset0:128 offset1:129
  v_smfmac_f32_16x16x64_bf16 v[92:95], v[44:47], a[152:159], v13
  ds_read_b128 v[16:19], v10 offset:0
  v_smfmac_f32_16x16x64_bf16 v[96:99], v[20:23], a[176:183], v13
  s_nop 2
  v_smfmac_f32_16x16x64_bf16 v[100:103], v[20:23], a[184:191], v13
  s_nop 2
  v_smfmac_f32_16x16x64_bf16 v[96:99], v[24:27], a[192:199], v13
  v_add_f32 v88, v88, v90
  v_add_f32 v89, v89, v91
  v_cvt_pk_bf16_f32 v88, v88, v89
  v_add_f32 v92, v92, v94
  v_smfmac_f32_16x16x64_bf16 v[100:103], v[24:27], a[200:207], v13
  v_add_f32 v93, v93, v95
  v_cvt_pk_bf16_f32 v92, v92, v93
  ds_write2_b32 v5, v88, v92 offset0:0 offset1:64
  v_smfmac_f32_16x16x64_bf16 v[96:99], v[28:31], a[208:215], v13
  s_waitcnt lgkmcnt(0)
  s_barrier
  v_smfmac_f32_16x16x64_bf16 v[100:103], v[28:31], a[216:223], v13
  ds_read_b64_tr_b16 v[64:65], v0 offset:0
  ds_read_b64_tr_b16 v[66:67], v0 offset:512
  v_smfmac_f32_16x16x64_bf16 v[96:99], v[32:35], a[224:231], v13
  ds_read_b64_tr_b16 v[48:49], v6 offset:0
  ds_read_b64_tr_b16 v[50:51], v6 offset:256
  v_smfmac_f32_16x16x64_bf16 v[100:103], v[32:35], a[232:239], v13
  ds_read_b64_tr_b16 v[68:69], v0 offset:1024
  ds_read_b64_tr_b16 v[70:71], v0 offset:1536
  v_smfmac_f32_16x16x64_bf16 v[96:99], v[36:39], a[240:247], v13
  ds_read_b64_tr_b16 v[52:53], v6 offset:512
  ds_read_b64_tr_b16 v[54:55], v6 offset:768
  v_smfmac_f32_16x16x64_bf16 v[100:103], v[36:39], a[248:255], v13
  ds_read_b64_tr_b16 v[72:73], v0 offset:2048
  ds_read_b64_tr_b16 v[74:75], v0 offset:2560
  v_smfmac_f32_16x16x64_bf16 v[96:99], v[40:43], v[128:135], v13
  ds_read_b64_tr_b16 v[56:57], v6 offset:1024
  ds_read_b64_tr_b16 v[58:59], v6 offset:1280
  v_smfmac_f32_16x16x64_bf16 v[100:103], v[40:43], v[136:143], v13
  ds_read_b64_tr_b16 v[76:77], v0 offset:3072
  ds_read_b64_tr_b16 v[78:79], v0 offset:3584
  v_smfmac_f32_16x16x64_bf16 v[96:99], v[44:47], v[144:151], v13
  ds_read_b64_tr_b16 v[60:61], v6 offset:1536
  v_smfmac_f32_16x16x64_bf16 v[100:103], v[44:47], v[152:159], v13
  s_waitcnt lgkmcnt(14)
  ds_read_b64_tr_b16 v[62:63], v6 offset:1792
  s_waitcnt lgkmcnt(12)
  v_mfma_f32_16x16x32_bf16 v[80:83], v[64:67], v[48:51], 0
  s_waitcnt lgkmcnt(8)
  ds_read_b128 v[20:23], v10 offset:1024
  ds_read_b128 v[24:27], v10 offset:2048
  s_lshl_b32 s72, s54, 10
  v_mfma_f32_16x16x32_bf16 v[80:83], v[68:71], v[52:55], v[80:83]
  s_waitcnt lgkmcnt(6)
  v_add_u32 v15, s72, v0
  ds_read_b128 v[28:31], v10 offset:3072
  v_mfma_f32_16x16x32_bf16 v[80:83], v[72:75], v[56:59], v[80:83]
  s_waitcnt lgkmcnt(3)
  ds_read_b64_tr_b16 v[122:123], v15 offset:0
  ds_read_b64_tr_b16 v[124:125], v15 offset:512
  v_mfma_f32_16x16x32_bf16 v[80:83], v[76:79], v[60:63], v[80:83]
  ds_read_b128 v[32:35], v10 offset:4096
  ds_read_b128 v[36:39], v10 offset:5120
  v_mfma_f32_16x16x32_bf16 v[84:87], v[16:19], v[48:51], 0
  s_waitcnt lgkmcnt(6)
  ds_read_b128 v[40:43], v10 offset:6144
  v_cvt_pk_bf16_f32 v118, v96, v97
  v_mfma_f32_16x16x32_bf16 v[84:87], v[20:23], v[52:55], v[84:87]
  s_waitcnt lgkmcnt(3)
  buffer_store_dwordx4 v[122:125], v1, s[4:7], s65 offen sc1
  v_cvt_pk_bf16_f32 v119, v98, v99
  v_mfma_f32_16x16x32_bf16 v[84:87], v[24:27], v[56:59], v[84:87]
  v_cvt_pk_bf16_f32 v120, v100, v101
  v_cvt_pk_bf16_f32 v121, v102, v103
  v_mfma_f32_16x16x32_bf16 v[84:87], v[28:31], v[60:63], v[84:87]
  s_waitcnt lgkmcnt(2)
  ds_read_b128 v[44:47], v10 offset:7168
  v_mfma_f32_16x16x32_bf16 v[88:91], v[32:35], v[48:51], 0
  s_waitcnt lgkmcnt(2)
  buffer_store_dwordx4 v[118:121], v1, s[4:7], s66 offen sc1
  v_mfma_f32_16x16x32_bf16 v[88:91], v[36:39], v[52:55], v[88:91]
  s_waitcnt lgkmcnt(1)
  v_max3_f32 v92, v80, v81, v80
  v_mfma_f32_16x16x32_bf16 v[88:91], v[40:43], v[56:59], v[88:91]
  s_waitcnt lgkmcnt(0)
  v_max3_f32 v92, v92, v84, v85
  v_mfma_f32_16x16x32_bf16 v[88:91], v[44:47], v[60:63], v[88:91]
  v_max3_f32 v92, v92, v86, v87
  s_cmp_eq_u32 s56, 63
  s_cbranch_scc1 L_chain_last_f
  s_nop 4
  v_max3_f32 v92, v92, v88, v89
  v_max3_f32 v92, v92, v90, v91
  v_mov_b32 v93, v92
  s_nop 1
  v_permlane16_swap_b32 v92, v93
  v_max_f32 v92, v92, v93
  v_mov_b32 v93, v92
  s_nop 1
  v_permlane32_swap_b32 v92, v93
  v_max_f32 v92, v92, v93
  v_mul_f32 v92, s71, v92
  v_pk_fma_f32 v[84:85], v[84:85], s[2:3], v[92:93] op_sel_hi:[1,1,0] neg_lo:[0,0,1] neg_hi:[0,0,1]
  v_pk_fma_f32 v[86:87], v[86:87], s[2:3], v[92:93] op_sel_hi:[1,1,0] neg_lo:[0,0,1] neg_hi:[0,0,1]
  v_pk_fma_f32 v[88:89], v[88:89], s[2:3], v[92:93] op_sel_hi:[1,1,0] neg_lo:[0,0,1] neg_hi:[0,0,1]
  v_pk_fma_f32 v[90:91], v[90:91], s[2:3], v[92:93] op_sel_hi:[1,1,0] neg_lo:[0,0,1] neg_hi:[0,0,1]
  v_pk_fma_f32 v[80:81], v[80:81], s[2:3], v[92:93] op_sel_hi:[1,1,0] neg_lo:[0,0,1] neg_hi:[0,0,1]
  v_exp_f32 v84, v84
  v_exp_f32 v85, v85
  v_exp_f32 v86, v86
  v_cvt_pk_bf16_f32 v112, v84, v85
  v_exp_f32 v87, v87
  v_exp_f32 v88, v88
  v_cvt_pk_bf16_f32 v113, v86, v87
  v_exp_f32 v89, v89
  v_exp_f32 v90, v90
  v_cvt_pk_bf16_f32 v114, v88, v89
  v_exp_f32 v91, v91
  v_exp_f32 v80, v80
  v_cvt_pk_bf16_f32 v115, v90, v91
  v_exp_f32 v81, v81
  v_add_f32 v93, v84, v85
  s_waitcnt vmcnt(8)
  v_mfma_f32_16x16x32_bf16 v[96:99], v[104:107], v[112:115], 0
  s_waitcnt vmcnt(7)
  v_cvt_pk_bf16_f32 v116, v80, v81
  v_cvt_pk_bf16_f32 v117, v80, v81
  v_mfma_f32_16x16x32_bf16 v[100:103], v[108:111], v[112:115], 0
  v_add_f32 v92, v86, v87
  v_add_f32 v93, v93, v88
  v_add_f32 v92, v92, v89
  v_add_f32 v93, v93, v90
  v_add_f32 v92, v92, v91
  v_mfma_f32_16x16x16_bf16 v[96:99], v[118:119], v[116:117], v[96:99]
  v_add_f32 v93, v93, v80
  v_add_f32 v92, v92, v81
  v_mfma_f32_16x16x16_bf16 v[100:103], v[120:121], v[116:117], v[100:103]
  v_add_f32 v92, v92, v93
  v_mov_b32 v93, v92
  s_nop 1
  v_permlane16_swap_b32 v92, v93
  v_add_f32 v92, v92, v93
  v_mov_b32 v93, v92
  s_nop 1
  v_permlane32_swap_b32 v92, v93
  v_add_f32 v92, v92, v93
  v_rcp_f32 v92, v92
  s_nop 0
  v_pk_mul_f32 v[96:97], v[96:97], v[92:93] op_sel_hi:[1,0]
  v_pk_mul_f32 v[98:99], v[98:99], v[92:93] op_sel_hi:[1,0]
  v_pk_mul_f32 v[100:101], v[100:101], v[92:93] op_sel_hi:[1,0]
  v_pk_mul_f32 v[102:103], v[102:103], v[92:93] op_sel_hi:[1,0]
  v_cvt_pk_bf16_f32 v96, v96, v97
  v_cvt_pk_bf16_f32 v97, v98, v99
  v_cvt_pk_bf16_f32 v98, v100, v101
  v_cvt_pk_bf16_f32 v99, v102, v103
  ds_write_b64 v7, v[96:97]
  ds_write_b64 v7, v[98:99] offset:256
  v_mov_b64 v[16:17], 0
  v_mov_b64 v[18:19], 0
  v_mov_b64 v[20:21], 0
  v_mov_b64 v[22:23], 0
  v_mov_b64 v[24:25], 0
  v_mov_b64 v[26:27], 0
  s_waitcnt lgkmcnt(0) vmcnt(3)
  s_barrier
  ds_read_b128 v[112:115], v8
  ds_read_b128 v[116:119], v8 offset:1024
  v_mov_b64 v[28:29], 0
  v_mov_b64 v[30:31], 0
  v_mov_b64 v[32:33], 0
  v_mov_b64 v[34:35], 0
  v_mov_b64 v[36:37], 0
  v_mov_b64 v[38:39], 0
  v_mov_b64 v[40:41], 0
  v_mov_b64 v[42:43], 0
  v_mov_b64 v[44:45], 0
  v_mov_b64 v[46:47], 0
  s_waitcnt lgkmcnt(1)
  v_smfmac_f32_16x16x64_bf16 v[16:19], v[112:115], v[160:167], v13
  ds_read_b128 v[48:51], v9 offset:24576
  ds_read_b128 v[52:55], v9 offset:25600
  v_smfmac_f32_16x16x64_bf16 v[20:23], v[112:115], v[168:175], v13
  s_waitcnt lgkmcnt(2)
  ds_read_b128 v[56:59], v9 offset:26624
  ds_read_b128 v[60:63], v9 offset:27648
  v_smfmac_f32_16x16x64_bf16 v[16:19], v[116:119], v[224:231], v13
  ds_read_b128 v[64:67], v9 offset:28672
  ds_read_b128 v[68:71], v9 offset:29696
  v_smfmac_f32_16x16x64_bf16 v[20:23], v[116:119], v[232:239], v13
  ds_read_b128 v[72:75], v9 offset:30720
  ds_read_b128 v[76:79], v9 offset:31744
  v_smfmac_f32_16x16x64_bf16 v[24:27], v[112:115], v[176:183], v13
  v_smfmac_f32_16x16x64_bf16 v[28:31], v[112:115], v[184:191], v13
  s_nop 0
  v_add_f32 v16, v16, v18
  v_add_f32 v17, v17, v19
  v_smfmac_f32_16x16x64_bf16 v[24:27], v[116:119], v[240:247], v13
  v_add_f32 v20, v20, v22
  v_add_f32 v21, v21, v23
  v_smfmac_f32_16x16x64_bf16 v[28:31], v[116:119], v[248:255], v13
  v_cvt_pk_bf16_f32 v80, v16, v20
  v_cvt_pk_bf16_f32 v82, v17, v21
  v_smfmac_f32_16x16x64_bf16 v[32:35], v[112:115], v[192:199], v13
  v_smfmac_f32_16x16x64_bf16 v[36:39], v[112:115], v[200:207], v13
  s_waitcnt lgkmcnt(6)
  v_add_f32 v24, v24, v26
  v_add_f32 v25, v25, v27
  v_smfmac_f32_16x16x64_bf16 v[32:35], v[116:119], v[48:55], v13
  s_waitcnt lgkmcnt(4)
  v_add_f32 v28, v28, v30
  v_add_f32 v29, v29, v31
  v_smfmac_f32_16x16x64_bf16 v[36:39], v[116:119], v[56:63], v13
  v_cvt_pk_bf16_f32 v81, v24, v28
  v_cvt_pk_bf16_f32 v83, v25, v29
  v_smfmac_f32_16x16x64_bf16 v[40:43], v[112:115], v[208:215], v13
  s_add_u32 s72, s60, 0x20000
  buffer_store_dwordx4 v[80:83], v11, s[4:7], s60 offen
  v_smfmac_f32_16x16x64_bf16 v[44:47], v[112:115], v[216:223], v13
  s_waitcnt lgkmcnt(2)
  v_add_f32 v32, v32, v34
  v_add_f32 v33, v33, v35
  v_smfmac_f32_16x16x64_bf16 v[40:43], v[116:119], v[64:71], v13
  s_waitcnt lgkmcnt(0)
  v_add_f32 v36, v36, v38
  v_add_f32 v37, v37, v39
  v_smfmac_f32_16x16x64_bf16 v[44:47], v[116:119], v[72:79], v13
  v_cvt_pk_bf16_f32 v84, v32, v36
  v_cvt_pk_bf16_f32 v86, v33, v37
  s_nop 1
  v_add_f32 v40, v40, v42
  v_add_f32 v41, v41, v43
  s_nop 1
  v_add_f32 v44, v44, v46
  v_add_f32 v45, v45, v47
  v_cvt_pk_bf16_f32 v85, v40, v44
  v_cvt_pk_bf16_f32 v87, v41, v45
  buffer_store_dwordx4 v[84:87], v11, s[4:7], s72 offen
  s_cmp_lt_u32 s54, 2
  s_cbranch_scc0 L_nored_f
  v_lshrrev_b32 v15, 5, v1
  v_and_b32 v15, 7, v15
  v_cmp_eq_u32 vcc, 0, v15
  v_cmp_eq_u32 s[96:97], 1, v15
  v_cmp_eq_u32 s[98:99], 2, v15
  v_cmp_eq_u32 s[100:101], 3, v15
  v_cndmask_b32 v104, 0, v14, vcc
  v_cndmask_b32 v105, 0, v14, s[96:97]
  v_cndmask_b32 v106, 0, v14, s[98:99]
  v_cndmask_b32 v107, 0, v14, s[100:101]
  s_nop 15
  s_nop 15
  s_nop 5
  s_cmp_eq_u32 s54, 0
  s_cbranch_scc1 L_nod1b_f
  s_nop 15
  s_nop 9
L_nod1b_f:
  buffer_load_dwordx4 v[16:19], v1, s[4:7], s61 offen offset:0 sc1
  buffer_load_dwordx4 v[20:23], v1, s[4:7], s61 offen offset:1024 sc1
  buffer_load_dwordx4 v[24:27], v1, s[4:7], s61 offen offset:2048 sc1
  buffer_load_dwordx4 v[28:31], v1, s[4:7], s61 offen offset:3072 sc1
  v_xor_b32 v10, 0x2000, v10
  ds_read_b128 v[48:51], v9 offset:0
  ds_read_b128 v[52:55], v9 offset:1024
  ds_read_b128 v[56:59], v9 offset:2048
  ds_read_b128 v[60:63], v9 offset:3072
  ds_read_b128 v[64:67], v9 offset:4096
  ds_read_b128 v[68:71], v9 offset:5120
  ds_read_b128 v[72:75], v9 offset:6144
  ds_read_b128 v[76:79], v9 offset:7168
  v_mov_b64 v[80:81], 0
  v_mov_b64 v[82:83], 0
  v_mov_b64 v[84:85], 0
  v_mov_b64 v[86:87], 0
  v_mov_b64 v[88:89], 0
  v_mov_b64 v[90:91], 0
  v_mov_b64 v[92:93], 0
  v_mov_b64 v[94:95], 0
  v_mov_b64 v[96:97], 0
  v_mov_b64 v[98:99], 0
  v_mov_b64 v[100:101], 0
  v_mov_b64 v[102:103], 0
  s_add_u32 s56, s56, 1
  s_add_u32 s63, s63, 262144
  s_add_u32 s64, s64, 262144
  s_add_u32 s65, s65, 131072
  s_add_u32 s66, s66, 131072
  s_xor_b32 s69, s69, 0x2000
  s_add_u32 s76, s76, 128
  buffer_load_dwordx4 v[32:35], v1, s[4:7], s61 offen offset:0 sc1
  buffer_load_dwordx4 v[36:39], v1, s[4:7], s61 offen offset:1024 sc1
  buffer_load_dwordx4 v[40:43], v1, s[4:7], s61 offen offset:2048 sc1
  buffer_load_dwordx4 v[44:47], v1, s[4:7], s61 offen offset:3072 sc1
L_check1_f:
  s_waitcnt vmcnt(7)
  v_max3_u32 v15, v16, v17, v18
  v_max_u32 v15, v15, v19
  v_mfma_f32_16x16x32_bf16 v[108:111], v[104:107], v[16:19], 0
  s_waitcnt vmcnt(6)
  v_max3_u32 v15, v15, v20, v21
  v_max3_u32 v15, v15, v22, v23
  v_mfma_f32_16x16x32_bf16 v[108:111], v[104:107], v[20:23], v[108:111]
  s_waitcnt vmcnt(5)
  v_max3_u32 v15, v15, v24, v25
  v_max3_u32 v15, v15, v26, v27
  v_mfma_f32_16x16x32_bf16 v[108:111], v[104:107], v[24:27], v[108:111]
  s_waitcnt vmcnt(4)
  v_max3_u32 v15, v15, v28, v29
  v_max3_u32 v15, v15, v30, v31
  v_mfma_f32_16x16x32_bf16 v[108:111], v[104:107], v[28:31], v[108:111]
  v_cmp_eq_u32 vcc, -1, v15
  s_nop 0
  s_cbranch_vccnz L_retry1_f
L_got1_f:
  v_mov_b64 v[124:125], -1
  s_mov_b32 exec_hi, 0
  s_nop 2
  v_add_f32_dpp v108, v108, v108 row_ror:8 row_mask:0xf bank_mask:0xf
  v_add_f32_dpp v109, v109, v109 row_ror:8 row_mask:0xf bank_mask:0xf
  v_add_f32_dpp v110, v110, v110 row_ror:8 row_mask:0xf bank_mask:0xf
  v_add_f32_dpp v111, v111, v111 row_ror:8 row_mask:0xf bank_mask:0xf
  s_mov_b32 exec_lo, 0x00ff00ff
  v_cvt_pk_bf16_f32 v122, v108, v109
  v_cvt_pk_bf16_f32 v123, v110, v111
  buffer_store_dwordx2 v[122:123], v12, s[4:7], s58 offen
  buffer_store_dwordx2 v[124:125], v12, s[4:7], s59 offen
  s_mov_b64 exec, -1
  s_branch L_red_done_f
L_nored_f:
  v_xor_b32 v10, 0x2000, v10
  ds_read_b128 v[48:51], v9 offset:0
  ds_read_b128 v[52:55], v9 offset:1024
  ds_read_b128 v[56:59], v9 offset:2048
  ds_read_b128 v[60:63], v9 offset:3072
  ds_read_b128 v[64:67], v9 offset:4096
  ds_read_b128 v[68:71], v9 offset:5120
  ds_read_b128 v[72:75], v9 offset:6144
  s_waitcnt lgkmcnt(14)
  ds_read_b128 v[76:79], v9 offset:7168
  v_mov_b64 v[80:81], 0
  v_mov_b64 v[82:83], 0
  v_mov_b64 v[84:85], 0
  v_mov_b64 v[86:87], 0
  v_mov_b64 v[88:89], 0
  v_mov_b64 v[90:91], 0
  v_mov_b64 v[92:93], 0
  v_mov_b64 v[94:95], 0
  v_mov_b64 v[96:97], 0
  v_mov_b64 v[98:99], 0
  v_mov_b64 v[100:101], 0
  v_mov_b64 v[102:103], 0
  s_add_u32 s56, s56, 1
  s_add_u32 s63, s63, 262144
  s_add_u32 s64, s64, 262144
  s_add_u32 s65, s65, 131072
  s_add_u32 s66, s66, 131072
  s_xor_b32 s69, s69, 0x2000
  s_add_u32 s76, s76, 128
  s_waitcnt vmcnt(0)
L_red_done_f:
  s_barrier
  s_add_u32 s57, s77, s21
  s_branch L_poll2_f
L_p2s_f:
  buffer_load_dwordx4 v[112:115], v1, s[4:7], s57 offen sc1
  s_sub_u32 s70, s70, 1
  s_cbranch_scc0 L_p2loop_f
  s_mov_b32 s70, 0
  s_waitcnt vmcnt(0)
  ds_write_b128 v2, v[112:115]
  s_branch L_got2_f
L_p2n0_f:
  buffer_load_dwordx4 v[112:115], v1, s[4:7], s57 offen sc1
  s_waitcnt vmcnt(1)
  ds_write_b128 v2, v[120:123]
  v_max3_u32 v15, v120, v121, v122
  v_max_u32 v15, v15, v123
  v_cmp_eq_u32 vcc, -1, v15
  s_nop 0
  s_cbranch_vccnz L_p2n1_f
  s_branch L_got2_f
L_p2n1_f:
  buffer_load_dwordx4 v[120:123], v1, s[4:7], s57 offen sc1
  s_sub_u32 s70, s70, 1
  s_cbranch_scc0 L_p2loop_f
  s_mov_b32 s70, 0
  s_waitcnt vmcnt(0)
  ds_write_b128 v2, v[112:115]
  s_branch L_got2_f
L_retry2b_f:
  s_sub_u32 s70, s70, 1
  s_cbranch_scc1 L_giveup2b_f
  s_add_u32 s72, s57, 4096
  buffer_load_dwordx4 v[116:119], v1, s[4:7], s72 offen sc1
  s_waitcnt vmcnt(0)
  v_max3_u32 v15, v116, v117, v118
  v_max_u32 v15, v15, v119
  v_cmp_eq_u32 vcc, -1, v15
  s_nop 0
  s_cbranch_vccnz L_retry2b_f
  s_branch L_got2b_f
L_giveup2b_f:
  s_mov_b32 s70, 0
  s_branch L_got2b_f
L_retry1s_f:
  buffer_load_dwordx4 v[16:19], v1, s[4:7], s61 offen offset:0 sc1
  buffer_load_dwordx4 v[20:23], v1, s[4:7], s61 offen offset:1024 sc1
  buffer_load_dwordx4 v[24:27], v1, s[4:7], s61 offen offset:2048 sc1
  buffer_load_dwordx4 v[28:31], v1, s[4:7], s61 offen offset:3072 sc1
  s_sub_u32 s70, s70, 1
  s_nop 0
  s_mov_b32 s70, 0
  s_waitcnt vmcnt(0)
  s_branch L_got1_f
L_retry1_f:
  buffer_load_dwordx4 v[16:19], v1, s[4:7], s61 offen offset:0 sc1
  buffer_load_dwordx4 v[20:23], v1, s[4:7], s61 offen offset:1024 sc1
  buffer_load_dwordx4 v[24:27], v1, s[4:7], s61 offen offset:2048 sc1
  buffer_load_dwordx4 v[28:31], v1, s[4:7], s61 offen offset:3072 sc1
  s_waitcnt vmcnt(7)
  v_max3_u32 v15, v32, v33, v34
  v_max_u32 v15, v15, v35
  v_mfma_f32_16x16x32_bf16 v[108:111], v[104:107], v[32:35], 0
  s_waitcnt vmcnt(6)
  v_max3_u32 v15, v15, v36, v37
  v_max3_u32 v15, v15, v38, v39
  v_mfma_f32_16x16x32_bf16 v[108:111], v[104:107], v[36:39], v[108:111]
  s_waitcnt vmcnt(5)
  v_max3_u32 v15, v15, v40, v41
  v_max3_u32 v15, v15, v42, v43
  v_mfma_f32_16x16x32_bf16 v[108:111], v[104:107], v[40:43], v[108:111]
  s_waitcnt vmcnt(4)
  v_max3_u32 v15, v15, v44, v45
  v_max3_u32 v15, v15, v46, v47
  v_mfma_f32_16x16x32_bf16 v[108:111], v[104:107], v[44:47], v[108:111]
  v_cmp_eq_u32 vcc, -1, v15
  s_nop 0
  s_cbranch_vccz L_got1_f
  buffer_load_dwordx4 v[32:35], v1, s[4:7], s61 offen offset:0 sc1
  buffer_load_dwordx4 v[36:39], v1, s[4:7], s61 offen offset:1024 sc1
  buffer_load_dwordx4 v[40:43], v1, s[4:7], s61 offen offset:2048 sc1
  buffer_load_dwordx4 v[44:47], v1, s[4:7], s61 offen offset:3072 sc1
  s_sub_u32 s70, s70, 1
  s_cbranch_scc0 L_check1_f
  s_mov_b32 s70, 0
  s_waitcnt vmcnt(0)
  s_branch L_got1_f
L_kvspin_f:
  s_min_u32 s74, s74, 63
L_kvspin_l_f:
  buffer_load_dwordx2 v[112:113], off, s[4:7], s67 sc1
  s_waitcnt vmcnt(0)
  v_readfirstlane_b32 s72, v112
  v_readfirstlane_b32 s73, v113
  s_nop 3
  s_lshl_b32 s72, s72, 1
  s_lshl_b32 s73, s73, 1
  s_add_u32 s73, s73, 1
  s_min_u32 s75, s72, s73
  s_cmp_lt_u32 s74, s75
  s_cbranch_scc1 L_kvspin_l_f_ok
  s_sub_u32 s70, s70, 16
  s_cselect_b32 s70, 0, s70
  s_cbranch_scc1 L_kvspin_l_f_ok
  s_branch L_kvspin_l_f
L_kvspin_l_f_ok:
  s_branch L_kvok_f
L_chain_last_f:
  v_mov_b32 v15, 0
  v_mov_b32 v127, 64
  s_waitcnt vmcnt(0)
  s_barrier
  s_cmp_eq_u32 s54, 0
  s_cbranch_scc0 L_end
  s_mov_b64 exec, 1
  buffer_store_dword v127, v15, s[4:7], s68 offen sc1
  s_branch L_end
L_chain_s:
  v_lshlrev_b32 v1, 4, v0
  s_cmp_eq_u32 s54, 0
  s_cbranch_scc0 L_ci_not0sc1
  s_mov_b32 s8, s26
  s_and_b32 s9, s27, 0xffff
  s_mov_b32 s10, 0x2000
  s_mov_b32 s11, 0x20000
  v_and_b32 v15, 3, v0
  v_lshlrev_b32 v15, 11, v15
  v_lshrrev_b32 v127, 4, v0
  v_and_b32 v127, 1, v127
  v_lshlrev_b32 v127, 10, v127
  v_add_u32 v15, v15, v127
  v_lshrrev_b32 v127, 2, v0
  v_and_b32 v127, 1, v127
  v_lshlrev_b32 v127, 1, v127
  v_add_u32 v15, v15, v127
  s_lshr_b32 s72, s52, 3
  s_lshl_b32 s72, s72, 7
  v_add_u32 v15, s72, v15
  s_and_b32 s72, s52, 7
  s_lshl_b32 s72, s72, 2
  v_add_u32 v15, s72, v15
  buffer_load_ushort v92, v15, s[8:11], 0 offen offset:0
  buffer_load_ushort v93, v15, s[8:11], 0 offen offset:32
  buffer_load_ushort v94, v15, s[8:11], 0 offen offset:64
  buffer_load_ushort v95, v15, s[8:11], 0 offen offset:96
  buffer_load_ushort v96, v15, s[8:11], 0 offen offset:512
  buffer_load_ushort v97, v15, s[8:11], 0 offen offset:544
  buffer_load_ushort v98, v15, s[8:11], 0 offen offset:576
  buffer_load_ushort v99, v15, s[8:11], 0 offen offset:608
L_ci_not0sc1:
  v_mov_b32 v122, -1
  v_mov_b32 v123, -1
  v_mov_b32 v124, -1
  v_mov_b32 v125, -1
  s_lshl_b32 s72, s52, 12
  s_lshr_b32 s73, s54, 1
  s_lshl_b32 s73, s73, 17
  s_add_u32 s72, s72, s73
  s_and_b32 s73, s54, 1
  s_lshl_b32 s73, s73, 11
  s_add_u32 s72, s72, s73
  s_add_u32 s73, s72, 0x4200000
  buffer_store_dwordx4 v[122:125], v1, s[4:7], s73 offen offset:0 sc1
  buffer_store_dwordx4 v[122:125], v1, s[4:7], s73 offen offset:1024 sc1
  s_add_u32 s73, s72, 0x4240000
  buffer_store_dwordx4 v[122:125], v1, s[4:7], s73 offen offset:0 sc1
  buffer_store_dwordx4 v[122:125], v1, s[4:7], s73 offen offset:1024 sc1
  s_add_u32 s73, s72, 0x4280000
  buffer_store_dwordx4 v[122:125], v1, s[4:7], s73 offen offset:0 sc1
  buffer_store_dwordx4 v[122:125], v1, s[4:7], s73 offen offset:1024 sc1
  s_cmp_eq_u32 s54, 1
  s_cbranch_scc0 L_ci_not1sc1
  s_mov_b64 exec, 0xff
  s_lshl_b32 s72, s52, 7
  s_add_u32 s73, s72, 0x42c2000
  buffer_store_dwordx4 v[122:125], v1, s[4:7], s73 offen sc1
  s_add_u32 s73, s72, 0x42c3000
  buffer_store_dwordx4 v[122:125], v1, s[4:7], s73 offen sc1
  s_add_u32 s73, s72, 0x42c4000
  buffer_store_dwordx4 v[122:125], v1, s[4:7], s73 offen sc1
  s_add_u32 s73, s72, 0x42c5000
  buffer_store_dwordx4 v[122:125], v1, s[4:7], s73 offen sc1
  s_add_u32 s73, s72, 0x42c6000
  buffer_store_dwordx4 v[122:125], v1, s[4:7], s73 offen sc1
  s_add_u32 s73, s72, 0x42c7000
  buffer_store_dwordx4 v[122:125], v1, s[4:7], s73 offen sc1
  s_mov_b64 exec, -1
L_ci_not1sc1:
  v_lshrrev_b32 v80, 4, v0
  v_and_b32 v80, 3, v80
  v_lshlrev_b32 v80, 13, v80
  v_and_b32 v127, 15, v0
  v_lshlrev_b32 v127, 4, v127
  v_add_u32 v80, v80, v127
  s_lshl_b32 s72, s54, 18
  v_add_u32 v80, s72, v80
  s_lshl_b32 s72, s52, 8
  v_add_u32 v80, s72, v80
  v_lshrrev_b32 v81, 3, v0
  v_and_b32 v81, 7, v81
  v_lshlrev_b32 v81, 10, v81
  v_and_b32 v127, 7, v0
  v_lshlrev_b32 v127, 4, v127
  v_add_u32 v81, v81, v127
  s_lshl_b32 s72, s54, 7
  v_add_u32 v81, s72, v81
  s_lshl_b32 s72, s52, 17
  v_add_u32 v81, s72, v81
  s_lshl_b32 s73, s54, 13
  s_add_u32 s73, s73, 0x20000
  v_lshrrev_b32 v82, 1, v0
  v_and_b32 v82, 7, v82
  v_lshrrev_b32 v15, 4, v0
  v_and_b32 v15, 3, v15
  v_xor_b32 v82, v82, v15
  v_lshlrev_b32 v82, 5, v82
  v_lshrrev_b32 v15, 4, v0
  v_and_b32 v15, 3, v15
  v_lshlrev_b32 v15, 8, v15
  v_and_b32 v127, 1, v0
  v_lshlrev_b32 v127, 4, v127
  v_add_u32 v15, v15, v127
  v_add_u32 v82, v82, v15
  v_add_u32 v82, s73, v82
  v_xor_b32 v88, 0x80, v82
  v_lshrrev_b32 v83, 4, v0
  v_and_b32 v83, 1, v83
  v_lshrrev_b32 v127, 3, v0
  v_and_b32 v127, 1, v127
  v_lshlrev_b32 v127, 1, v127
  v_add_u32 v83, v83, v127
  v_lshrrev_b32 v127, 2, v0
  v_and_b32 v127, 1, v127
  v_lshlrev_b32 v127, 2, v127
  v_add_u32 v83, v83, v127
  s_lshl_b32 s72, s54, 1
  v_xor_b32 v83, s72, v83
  v_lshlrev_b32 v83, 5, v83
  v_lshrrev_b32 v15, 2, v0
  v_and_b32 v15, 1, v15
  v_lshlrev_b32 v15, 12, v15
  v_lshrrev_b32 v127, 5, v0
  v_and_b32 v127, 1, v127
  v_lshlrev_b32 v127, 10, v127
  v_add_u32 v15, v15, v127
  v_lshrrev_b32 v127, 3, v0
  v_and_b32 v127, 1, v127
  v_lshlrev_b32 v127, 9, v127
  v_add_u32 v15, v15, v127
  v_lshrrev_b32 v127, 4, v0
  v_and_b32 v127, 1, v127
  v_lshlrev_b32 v127, 8, v127
  v_add_u32 v15, v15, v127
  v_and_b32 v127, 3, v0
  v_lshlrev_b32 v127, 3, v127
  v_add_u32 v15, v15, v127
  v_add_u32 v15, 0x20000, v15
  v_add_u32 v83, v83, v15
  v_xor_b32 v84, 32, v83
  v_lshrrev_b32 v85, 1, v0
  v_and_b32 v85, 3, v85
  v_lshrrev_b32 v15, 5, v0
  v_and_b32 v15, 1, v15
  v_xor_b32 v85, v85, v15
  v_lshlrev_b32 v85, 5, v85
  v_lshrrev_b32 v15, 3, v0
  v_and_b32 v15, 7, v15
  v_lshlrev_b32 v15, 7, v15
  v_and_b32 v127, 1, v0
  v_lshlrev_b32 v127, 4, v127
  v_add_u32 v15, v15, v127
  v_add_u32 v85, v85, v15
  v_add_u32 v85, s73, v85
  v_xor_b32 v86, 64, v85
  v_lshrrev_b32 v87, 4, v0
  v_and_b32 v87, 1, v87
  v_lshrrev_b32 v127, 3, v0
  v_and_b32 v127, 1, v127
  v_lshlrev_b32 v127, 1, v127
  v_add_u32 v87, v87, v127
  v_lshlrev_b32 v87, 5, v87
  v_lshrrev_b32 v15, 5, v0
  v_and_b32 v15, 1, v15
  v_lshlrev_b32 v15, 11, v15
  v_lshrrev_b32 v127, 4, v0
  v_and_b32 v127, 1, v127
  v_lshlrev_b32 v127, 9, v127
  v_add_u32 v15, v15, v127
  v_lshrrev_b32 v127, 3, v0
  v_and_b32 v127, 1, v127
  v_lshlrev_b32 v127, 10, v127
  v_add_u32 v15, v15, v127
  v_lshrrev_b32 v127, 2, v0
  v_and_b32 v127, 1, v127
  v_lshlrev_b32 v127, 7, v127
  v_add_u32 v15, v15, v127
  v_and_b32 v127, 3, v0
  v_lshlrev_b32 v127, 3, v127
  v_add_u32 v15, v15, v127
  v_add_u32 v87, v87, v15
  v_add_u32 v87, s73, v87
  s_lshl_b32 s72, s54, 15
  v_lshlrev_b32 v9, 4, v0
  v_add_u32 v9, s72, v9
  s_mov_b32 s8, s30
  s_and_b32 s9, s31, 0xffff
  s_mov_b32 s10, 0x400000
  s_mov_b32 s11, 0x20000
  s_mov_b32 s74, 0x100000
  buffer_load_dwordx4 v[16:19], v80, s[8:11], s74 offen
  s_mov_b32 s74, 0x108000
  buffer_load_dwordx4 v[20:23], v80, s[8:11], s74 offen
  s_mov_b32 s74, 0x110000
  buffer_load_dwordx4 v[24:27], v80, s[8:11], s74 offen
  s_mov_b32 s74, 0x118000
  buffer_load_dwordx4 v[28:31], v80, s[8:11], s74 offen
  s_mov_b32 s74, 0x120000
  buffer_load_dwordx4 v[32:35], v80, s[8:11], s74 offen
  s_mov_b32 s74, 0x128000
  buffer_load_dwordx4 v[36:39], v80, s[8:11], s74 offen
  s_mov_b32 s74, 0x130000
  buffer_load_dwordx4 v[40:43], v80, s[8:11], s74 offen
  s_mov_b32 s74, 0x138000
  buffer_load_dwordx4 v[44:47], v80, s[8:11], s74 offen
  s_mov_b32 s12, s30
  s_and_b32 s13, s31, 0xffff
  s_mov_b32 s14, 0x400000
  s_mov_b32 s15, 0x20000
  s_mov_b32 s74, 0x0
  buffer_load_dwordx4 a[0:3], v80, s[12:15], s74 offen
  s_mov_b32 s74, 0x8000
  buffer_load_dwordx4 a[4:7], v80, s[12:15], s74 offen
  s_mov_b32 s74, 0x10000
  buffer_load_dwordx4 a[8:11], v80, s[12:15], s74 offen
  s_mov_b32 s74, 0x18000
  buffer_load_dwordx4 a[12:15], v80, s[12:15], s74 offen
  s_mov_b32 s74, 0x20000
  buffer_load_dwordx4 a[16:19], v80, s[12:15], s74 offen
  s_mov_b32 s74, 0x28000
  buffer_load_dwordx4 a[20:23], v80, s[12:15], s74 offen
  s_mov_b32 s74, 0x30000
  buffer_load_dwordx4 a[24:27], v80, s[12:15], s74 offen
  s_mov_b32 s74, 0x38000
  buffer_load_dwordx4 a[28:31], v80, s[12:15], s74 offen
  s_waitcnt vmcnt(8)
  ds_write_b128 v82, v[16:19] offset:0
  ds_write_b128 v82, v[20:23] offset:1024
  ds_write_b128 v82, v[24:27] offset:2048
  ds_write_b128 v82, v[28:31] offset:3072
  ds_write_b128 v88, v[32:35] offset:4096
  ds_write_b128 v88, v[36:39] offset:5120
  ds_write_b128 v88, v[40:43] offset:6144
  ds_write_b128 v88, v[44:47] offset:7168
  s_waitcnt lgkmcnt(0)
  s_barrier
  ds_read_b64_tr_b16 v[16:17], v83 offset:0
  ds_read_b64_tr_b16 v[18:19], v83 offset:8192
  ds_read_b64_tr_b16 v[20:21], v83 offset:2048
  ds_read_b64_tr_b16 v[22:23], v83 offset:10240
  ds_read_b64_tr_b16 v[24:25], v84 offset:0
  ds_read_b64_tr_b16 v[26:27], v84 offset:8192
  ds_read_b64_tr_b16 v[28:29], v84 offset:2048
  ds_read_b64_tr_b16 v[30:31], v84 offset:10240
  s_waitcnt lgkmcnt(0)
  ds_read_b64_tr_b16 v[32:33], v83 offset:16384
  ds_read_b64_tr_b16 v[34:35], v83 offset:24576
  ds_read_b64_tr_b16 v[36:37], v83 offset:18432
  ds_read_b64_tr_b16 v[38:39], v83 offset:26624
  ds_read_b64_tr_b16 v[40:41], v84 offset:16384
  ds_read_b64_tr_b16 v[42:43], v84 offset:24576
  ds_read_b64_tr_b16 v[44:45], v84 offset:18432
  ds_read_b64_tr_b16 v[46:47], v84 offset:26624
  s_waitcnt lgkmcnt(0)
  s_barrier
  ds_write_b128 v9, v[16:19] offset:0
  ds_write_b128 v9, v[20:23] offset:1024
  ds_write_b128 v9, v[24:27] offset:2048
  ds_write_b128 v9, v[28:31] offset:3072
  ds_write_b128 v9, v[32:35] offset:4096
  ds_write_b128 v9, v[36:39] offset:5120
  ds_write_b128 v9, v[40:43] offset:6144
  ds_write_b128 v9, v[44:47] offset:7168
  s_waitcnt lgkmcnt(0)
  s_cmp_eq_u32 s54, 0
  s_cbranch_scc0 L_m0_skipsc1
  v_and_b32 v12, 3, v0
  v_lshlrev_b32 v12, 5, v12
  v_lshrrev_b32 v127, 4, v0
  v_and_b32 v127, 1, v127
  v_lshlrev_b32 v127, 4, v127
  v_add_u32 v12, v12, v127
  v_lshrrev_b32 v127, 2, v0
  v_and_b32 v127, 1, v127
  v_lshlrev_b32 v127, 3, v127
  v_add_u32 v12, v12, v127
  s_lshl_b32 s72, s52, 7
  v_add_u32 v12, s72, v12
  s_mov_b32 exec_lo, 0x00ff00ff
  s_mov_b32 exec_hi, 0
  v_lshl_or_b32 v92, v93, 16, v92
  v_lshl_or_b32 v93, v95, 16, v94
  v_min_u32 v92, 0xfffffffe, v92
  v_min_u32 v93, 0xfffffffe, v93
  s_mov_b32 s73, 0x42c0000
  buffer_store_dwordx2 v[92:93], v12, s[4:7], s73 offen sc1
  v_lshl_or_b32 v96, v97, 16, v96
  v_lshl_or_b32 v97, v99, 16, v98
  v_min_u32 v96, 0xfffffffe, v96
  v_min_u32 v97, 0xfffffffe, v97
  s_mov_b32 s73, 0x42c1000
  buffer_store_dwordx2 v[96:97], v12, s[4:7], s73 offen sc1
  s_mov_b64 exec, -1
L_m0_skipsc1:
  s_mov_b32 s8, s30
  s_and_b32 s9, s31, 0xffff
  s_mov_b32 s10, 0x400000
  s_mov_b32 s11, 0x20000
  s_mov_b32 s74, 0x200000
  buffer_load_dwordx4 a[32:35], v80, s[8:11], s74 offen
  s_mov_b32 s74, 0x208000
  buffer_load_dwordx4 a[36:39], v80, s[8:11], s74 offen
  s_mov_b32 s74, 0x210000
  buffer_load_dwordx4 a[40:43], v80, s[8:11], s74 offen
  s_mov_b32 s74, 0x218000
  buffer_load_dwordx4 a[44:47], v80, s[8:11], s74 offen
  s_mov_b32 s74, 0x220000
  buffer_load_dwordx4 a[48:51], v80, s[8:11], s74 offen
  s_mov_b32 s74, 0x228000
  buffer_load_dwordx4 a[52:55], v80, s[8:11], s74 offen
  s_mov_b32 s74, 0x230000
  buffer_load_dwordx4 a[56:59], v80, s[8:11], s74 offen
  s_mov_b32 s74, 0x238000
  buffer_load_dwordx4 a[60:63], v80, s[8:11], s74 offen
  s_waitcnt vmcnt(8)
  ds_write_b128 v82, a[0:3] offset:0
  ds_write_b128 v82, a[4:7] offset:1024
  ds_write_b128 v82, a[8:11] offset:2048
  ds_write_b128 v82, a[12:15] offset:3072
  ds_write_b128 v88, a[16:19] offset:4096
  ds_write_b128 v88, a[20:23] offset:5120
  ds_write_b128 v88, a[24:27] offset:6144
  ds_write_b128 v88, a[28:31] offset:7168
  s_waitcnt lgkmcnt(0)
  s_barrier
  ds_read_b64_tr_b16 a[0:1], v83 offset:0
  ds_read_b64_tr_b16 a[2:3], v83 offset:8192
  ds_read_b64_tr_b16 a[4:5], v83 offset:2048
  ds_read_b64_tr_b16 a[6:7], v83 offset:10240
  ds_read_b64_tr_b16 a[8:9], v84 offset:0
  ds_read_b64_tr_b16 a[10:11], v84 offset:8192
  ds_read_b64_tr_b16 a[12:13], v84 offset:2048
  ds_read_b64_tr_b16 a[14:15], v84 offset:10240
  s_waitcnt lgkmcnt(0)
  ds_read_b64_tr_b16 a[16:17], v83 offset:16384
  ds_read_b64_tr_b16 a[18:19], v83 offset:24576
  ds_read_b64_tr_b16 a[20:21], v83 offset:18432
  ds_read_b64_tr_b16 a[22:23], v83 offset:26624
  ds_read_b64_tr_b16 a[24:25], v84 offset:16384
  ds_read_b64_tr_b16 a[26:27], v84 offset:24576
  ds_read_b64_tr_b16 a[28:29], v84 offset:18432
  ds_read_b64_tr_b16 a[30:31], v84 offset:26624
  s_waitcnt lgkmcnt(0)
  s_barrier
  s_mov_b32 s12, s28
  s_and_b32 s13, s29, 0xffff
  s_mov_b32 s14, 0x400000
  s_mov_b32 s15, 0x20000
  s_mov_b32 s74, 0x0
  buffer_load_dwordx4 a[64:67], v80, s[12:15], s74 offen
  s_mov_b32 s74, 0x8000
  buffer_load_dwordx4 a[68:71], v80, s[12:15], s74 offen
  s_mov_b32 s74, 0x10000
  buffer_load_dwordx4 a[72:75], v80, s[12:15], s74 offen
  s_mov_b32 s74, 0x18000
  buffer_load_dwordx4 a[76:79], v80, s[12:15], s74 offen
  s_mov_b32 s74, 0x20000
  buffer_load_dwordx4 a[80:83], v80, s[12:15], s74 offen
  s_mov_b32 s74, 0x28000
  buffer_load_dwordx4 a[84:87], v80, s[12:15], s74 offen
  s_mov_b32 s74, 0x30000
  buffer_load_dwordx4 a[88:91], v80, s[12:15], s74 offen
  s_mov_b32 s74, 0x38000
  buffer_load_dwordx4 a[92:95], v80, s[12:15], s74 offen
  s_waitcnt vmcnt(8)
  ds_write_b128 v82, a[32:35] offset:0
  ds_write_b128 v82, a[36:39] offset:1024
  ds_write_b128 v82, a[40:43] offset:2048
  ds_write_b128 v82, a[44:47] offset:3072
  ds_write_b128 v88, a[48:51] offset:4096
  ds_write_b128 v88, a[52:55] offset:5120
  ds_write_b128 v88, a[56:59] offset:6144
  ds_write_b128 v88, a[60:63] offset:7168
  s_waitcnt lgkmcnt(0)
  s_barrier
  ds_read_b64_tr_b16 a[32:33], v83 offset:0
  ds_read_b64_tr_b16 a[34:35], v83 offset:8192
  ds_read_b64_tr_b16 a[36:37], v83 offset:2048
  ds_read_b64_tr_b16 a[38:39], v83 offset:10240
  ds_read_b64_tr_b16 a[40:41], v84 offset:0
  ds_read_b64_tr_b16 a[42:43], v84 offset:8192
  ds_read_b64_tr_b16 a[44:45], v84 offset:2048
  ds_read_b64_tr_b16 a[46:47], v84 offset:10240
  s_waitcnt lgkmcnt(0)
  ds_read_b64_tr_b16 a[48:49], v83 offset:16384
  ds_read_b64_tr_b16 a[50:51], v83 offset:24576
  ds_read_b64_tr_b16 a[52:53], v83 offset:18432
  ds_read_b64_tr_b16 a[54:55], v83 offset:26624
  ds_read_b64_tr_b16 a[56:57], v84 offset:16384
  ds_read_b64_tr_b16 a[58:59], v84 offset:24576
  ds_read_b64_tr_b16 a[60:61], v84 offset:18432
  ds_read_b64_tr_b16 a[62:63], v84 offset:26624
  s_waitcnt lgkmcnt(0)
  s_barrier
  s_mov_b32 s8, s28
  s_and_b32 s9, s29, 0xffff
  s_mov_b32 s10, 0x400000
  s_mov_b32 s11, 0x20000
  s_mov_b32 s74, 0x200000
  buffer_load_dwordx4 a[96:99], v80, s[8:11], s74 offen
  s_mov_b32 s74, 0x208000
  buffer_load_dwordx4 a[100:103], v80, s[8:11], s74 offen
  s_mov_b32 s74, 0x210000
  buffer_load_dwordx4 a[104:107], v80, s[8:11], s74 offen
  s_mov_b32 s74, 0x218000
  buffer_load_dwordx4 a[108:111], v80, s[8:11], s74 offen
  s_mov_b32 s74, 0x220000
  buffer_load_dwordx4 a[112:115], v80, s[8:11], s74 offen
  s_mov_b32 s74, 0x228000
  buffer_load_dwordx4 a[116:119], v80, s[8:11], s74 offen
  s_mov_b32 s74, 0x230000
  buffer_load_dwordx4 a[120:123], v80, s[8:11], s74 offen
  s_mov_b32 s74, 0x238000
  buffer_load_dwordx4 a[124:127], v80, s[8:11], s74 offen
  s_waitcnt vmcnt(8)
  ds_write_b128 v82, a[64:67] offset:0
  ds_write_b128 v82, a[68:71] offset:1024
  ds_write_b128 v82, a[72:75] offset:2048
  ds_write_b128 v82, a[76:79] offset:3072
  ds_write_b128 v88, a[80:83] offset:4096
  ds_write_b128 v88, a[84:87] offset:5120
  ds_write_b128 v88, a[88:91] offset:6144
  ds_write_b128 v88, a[92:95] offset:7168
  s_waitcnt lgkmcnt(0)
  s_barrier
  ds_read_b64_tr_b16 a[64:65], v83 offset:0
  ds_read_b64_tr_b16 a[66:67], v83 offset:8192
  ds_read_b64_tr_b16 a[68:69], v83 offset:2048
  ds_read_b64_tr_b16 a[70:71], v83 offset:10240
  ds_read_b64_tr_b16 a[72:73], v84 offset:0
  ds_read_b64_tr_b16 a[74:75], v84 offset:8192
  ds_read_b64_tr_b16 a[76:77], v84 offset:2048
  ds_read_b64_tr_b16 a[78:79], v84 offset:10240
  s_waitcnt lgkmcnt(0)
  ds_read_b64_tr_b16 a[80:81], v83 offset:16384
  ds_read_b64_tr_b16 a[82:83], v83 offset:24576
  ds_read_b64_tr_b16 a[84:85], v83 offset:18432
  ds_read_b64_tr_b16 a[86:87], v83 offset:26624
  ds_read_b64_tr_b16 a[88:89], v84 offset:16384
  ds_read_b64_tr_b16 a[90:91], v84 offset:24576
  ds_read_b64_tr_b16 a[92:93], v84 offset:18432
  ds_read_b64_tr_b16 a[94:95], v84 offset:26624
  s_waitcnt lgkmcnt(0)
  s_barrier
  s_mov_b32 s12, s28
  s_and_b32 s13, s29, 0xffff
  s_mov_b32 s14, 0x400000
  s_mov_b32 s15, 0x20000
  s_mov_b32 s74, 0x100000
  buffer_load_dwordx4 v[48:51], v80, s[12:15], s74 offen
  s_mov_b32 s74, 0x108000
  buffer_load_dwordx4 v[52:55], v80, s[12:15], s74 offen
  s_mov_b32 s74, 0x110000
  buffer_load_dwordx4 v[56:59], v80, s[12:15], s74 offen
  s_mov_b32 s74, 0x118000
  buffer_load_dwordx4 v[60:63], v80, s[12:15], s74 offen
  s_mov_b32 s74, 0x120000
  buffer_load_dwordx4 v[64:67], v80, s[12:15], s74 offen
  s_mov_b32 s74, 0x128000
  buffer_load_dwordx4 v[68:71], v80, s[12:15], s74 offen
  s_mov_b32 s74, 0x130000
  buffer_load_dwordx4 v[72:75], v80, s[12:15], s74 offen
  s_mov_b32 s74, 0x138000
  buffer_load_dwordx4 v[76:79], v80, s[12:15], s74 offen
  s_waitcnt vmcnt(8)
  ds_write_b128 v82, a[96:99] offset:0
  ds_write_b128 v82, a[100:103] offset:1024
  ds_write_b128 v82, a[104:107] offset:2048
  ds_write_b128 v82, a[108:111] offset:3072
  ds_write_b128 v88, a[112:115] offset:4096
  ds_write_b128 v88, a[116:119] offset:5120
  ds_write_b128 v88, a[120:123] offset:6144
  ds_write_b128 v88, a[124:127] offset:7168
  s_waitcnt lgkmcnt(0)
  s_barrier
  ds_read_b64_tr_b16 a[96:97], v83 offset:0
  ds_read_b64_tr_b16 a[98:99], v83 offset:8192
  ds_read_b64_tr_b16 a[100:101], v83 offset:2048
  ds_read_b64_tr_b16 a[102:103], v83 offset:10240
  ds_read_b64_tr_b16 a[104:105], v84 offset:0
  ds_read_b64_tr_b16 a[106:107], v84 offset:8192
  ds_read_b64_tr_b16 a[108:109], v84 offset:2048
  ds_read_b64_tr_b16 a[110:111], v84 offset:10240
  s_waitcnt lgkmcnt(0)
  ds_read_b64_tr_b16 a[112:113], v83 offset:16384
  ds_read_b64_tr_b16 a[114:115], v83 offset:24576
  ds_read_b64_tr_b16 a[116:117], v83 offset:18432
  ds_read_b64_tr_b16 a[118:119], v83 offset:26624
  ds_read_b64_tr_b16 a[120:121], v84 offset:16384
  ds_read_b64_tr_b16 a[122:123], v84 offset:24576
  ds_read_b64_tr_b16 a[124:125], v84 offset:18432
  ds_read_b64_tr_b16 a[126:127], v84 offset:26624
  s_waitcnt lgkmcnt(0)
  s_barrier
  s_mov_b32 s8, s28
  s_and_b32 s9, s29, 0xffff
  s_mov_b32 s10, 0x400000
  s_mov_b32 s11, 0x20000
  s_mov_b32 s74, 0x300000
  buffer_load_dwordx4 a[128:131], v80, s[8:11], s74 offen
  s_mov_b32 s74, 0x308000
  buffer_load_dwordx4 a[132:135], v80, s[8:11], s74 offen
  s_mov_b32 s74, 0x310000
  buffer_load_dwordx4 a[136:139], v80, s[8:11], s74 offen
  s_mov_b32 s74, 0x318000
  buffer_load_dwordx4 a[140:143], v80, s[8:11], s74 offen
  s_mov_b32 s74, 0x320000
  buffer_load_dwordx4 a[144:147], v80, s[8:11], s74 offen
  s_mov_b32 s74, 0x328000
  buffer_load_dwordx4 a[148:151], v80, s[8:11], s74 offen
  s_mov_b32 s74, 0x330000
  buffer_load_dwordx4 a[152:155], v80, s[8:11], s74 offen
  s_mov_b32 s74, 0x338000
  buffer_load_dwordx4 a[156:159], v80, s[8:11], s74 offen
  s_waitcnt vmcnt(8)
  ds_write_b128 v82, v[48:51] offset:0
  ds_write_b128 v82, v[52:55] offset:1024
  ds_write_b128 v82, v[56:59] offset:2048
  ds_write_b128 v82, v[60:63] offset:3072
  ds_write_b128 v88, v[64:67] offset:4096
  ds_write_b128 v88, v[68:71] offset:5120
  ds_write_b128 v88, v[72:75] offset:6144
  ds_write_b128 v88, v[76:79] offset:7168
  s_waitcnt lgkmcnt(0)
  s_barrier
  ds_read_b64_tr_b16 v[48:49], v83 offset:0
  ds_read_b64_tr_b16 v[50:51], v83 offset:8192
  ds_read_b64_tr_b16 v[52:53], v83 offset:2048
  ds_read_b64_tr_b16 v[54:55], v83 offset:10240
  ds_read_b64_tr_b16 v[56:57], v84 offset:0
  ds_read_b64_tr_b16 v[58:59], v84 offset:8192
  ds_read_b64_tr_b16 v[60:61], v84 offset:2048
  ds_read_b64_tr_b16 v[62:63], v84 offset:10240
  s_waitcnt lgkmcnt(0)
  ds_read_b64_tr_b16 v[64:65], v83 offset:16384
  ds_read_b64_tr_b16 v[66:67], v83 offset:24576
  ds_read_b64_tr_b16 v[68:69], v83 offset:18432
  ds_read_b64_tr_b16 v[70:71], v83 offset:26624
  ds_read_b64_tr_b16 v[72:73], v84 offset:16384
  ds_read_b64_tr_b16 v[74:75], v84 offset:24576
  ds_read_b64_tr_b16 v[76:77], v84 offset:18432
  ds_read_b64_tr_b16 v[78:79], v84 offset:26624
  s_waitcnt lgkmcnt(0)
  s_barrier
  ds_write_b128 v9, v[48:51] offset:8192
  ds_write_b128 v9, v[52:55] offset:9216
  ds_write_b128 v9, v[56:59] offset:10240
  ds_write_b128 v9, v[60:63] offset:11264
  ds_write_b128 v9, v[64:67] offset:12288
  ds_write_b128 v9, v[68:71] offset:13312
  ds_write_b128 v9, v[72:75] offset:14336
  ds_write_b128 v9, v[76:79] offset:15360
  s_waitcnt lgkmcnt(0)
  s_mov_b32 s12, s32
  s_and_b32 s13, s33, 0xffff
  s_mov_b32 s14, 0x400000
  s_mov_b32 s15, 0x20000
  s_mov_b32 s74, 0x0
  buffer_load_dwordx4 a[160:163], v80, s[12:15], s74 offen
  s_mov_b32 s74, 0x8000
  buffer_load_dwordx4 a[164:167], v80, s[12:15], s74 offen
  s_mov_b32 s74, 0x10000
  buffer_load_dwordx4 a[168:171], v80, s[12:15], s74 offen
  s_mov_b32 s74, 0x18000
  buffer_load_dwordx4 a[172:175], v80, s[12:15], s74 offen
  s_mov_b32 s74, 0x20000
  buffer_load_dwordx4 a[176:179], v80, s[12:15], s74 offen
  s_mov_b32 s74, 0x28000
  buffer_load_dwordx4 a[180:183], v80, s[12:15], s74 offen
  s_mov_b32 s74, 0x30000
  buffer_load_dwordx4 a[184:187], v80, s[12:15], s74 offen
  s_mov_b32 s74, 0x38000
  buffer_load_dwordx4 a[188:191], v80, s[12:15], s74 offen
  s_waitcnt vmcnt(8)
  ds_write_b128 v82, a[128:131] offset:0
  ds_write_b128 v82, a[132:135] offset:1024
  ds_write_b128 v82, a[136:139] offset:2048
  ds_write_b128 v82, a[140:143] offset:3072
  ds_write_b128 v88, a[144:147] offset:4096
  ds_write_b128 v88, a[148:151] offset:5120
  ds_write_b128 v88, a[152:155] offset:6144
  ds_write_b128 v88, a[156:159] offset:7168
  s_waitcnt lgkmcnt(0)
  s_barrier
  ds_read_b64_tr_b16 a[128:129], v83 offset:0
  ds_read_b64_tr_b16 a[130:131], v83 offset:8192
  ds_read_b64_tr_b16 a[132:133], v83 offset:2048
  ds_read_b64_tr_b16 a[134:135], v83 offset:10240
  ds_read_b64_tr_b16 a[136:137], v84 offset:0
  ds_read_b64_tr_b16 a[138:139], v84 offset:8192
  ds_read_b64_tr_b16 a[140:141], v84 offset:2048
  ds_read_b64_tr_b16 a[142:143], v84 offset:10240
  s_waitcnt lgkmcnt(0)
  ds_read_b64_tr_b16 a[144:145], v83 offset:16384
  ds_read_b64_tr_b16 a[146:147], v83 offset:24576
  ds_read_b64_tr_b16 a[148:149], v83 offset:18432
  ds_read_b64_tr_b16 a[150:151], v83 offset:26624
  ds_read_b64_tr_b16 a[152:153], v84 offset:16384
  ds_read_b64_tr_b16 a[154:155], v84 offset:24576
  ds_read_b64_tr_b16 a[156:157], v84 offset:18432
  ds_read_b64_tr_b16 a[158:159], v84 offset:26624
  s_waitcnt lgkmcnt(0)
  s_barrier
  s_mov_b32 s8, s32
  s_and_b32 s9, s33, 0xffff
  s_mov_b32 s10, 0x400000
  s_mov_b32 s11, 0x20000
  s_mov_b32 s74, 0x100000
  buffer_load_dwordx4 a[192:195], v80, s[8:11], s74 offen
  s_mov_b32 s74, 0x108000
  buffer_load_dwordx4 a[196:199], v80, s[8:11], s74 offen
  s_mov_b32 s74, 0x110000
  buffer_load_dwordx4 a[200:203], v80, s[8:11], s74 offen
  s_mov_b32 s74, 0x118000
  buffer_load_dwordx4 a[204:207], v80, s[8:11], s74 offen
  s_mov_b32 s74, 0x120000
  buffer_load_dwordx4 a[208:211], v80, s[8:11], s74 offen
  s_mov_b32 s74, 0x128000
  buffer_load_dwordx4 a[212:215], v80, s[8:11], s74 offen
  s_mov_b32 s74, 0x130000
  buffer_load_dwordx4 a[216:219], v80, s[8:11], s74 offen
  s_mov_b32 s74, 0x138000
  buffer_load_dwordx4 a[220:223], v80, s[8:11], s74 offen
  s_waitcnt vmcnt(8)
  ds_write_b128 v82, a[160:163] offset:0
  ds_write_b128 v82, a[164:167] offset:1024
  ds_write_b128 v82, a[168:171] offset:2048
  ds_write_b128 v82, a[172:175] offset:3072
  ds_write_b128 v88, a[176:179] offset:4096
  ds_write_b128 v88, a[180:183] offset:5120
  ds_write_b128 v88, a[184:187] offset:6144
  ds_write_b128 v88, a[188:191] offset:7168
  s_waitcnt lgkmcnt(0)
  s_barrier
  ds_read_b64_tr_b16 a[160:161], v83 offset:0
  ds_read_b64_tr_b16 a[162:163], v83 offset:8192
  ds_read_b64_tr_b16 a[164:165], v83 offset:2048
  ds_read_b64_tr_b16 a[166:167], v83 offset:10240
  ds_read_b64_tr_b16 a[168:169], v84 offset:0
  ds_read_b64_tr_b16 a[170:171], v84 offset:8192
  ds_read_b64_tr_b16 a[172:173], v84 offset:2048
  ds_read_b64_tr_b16 a[174:175], v84 offset:10240
  s_waitcnt lgkmcnt(0)
  ds_read_b64_tr_b16 a[176:177], v83 offset:16384
  ds_read_b64_tr_b16 a[178:179], v83 offset:24576
  ds_read_b64_tr_b16 a[180:181], v83 offset:18432
  ds_read_b64_tr_b16 a[182:183], v83 offset:26624
  ds_read_b64_tr_b16 a[184:185], v84 offset:16384
  ds_read_b64_tr_b16 a[186:187], v84 offset:24576
  ds_read_b64_tr_b16 a[188:189], v84 offset:18432
  ds_read_b64_tr_b16 a[190:191], v84 offset:26624
  s_waitcnt lgkmcnt(0)
  s_barrier
  s_cmp_eq_u32 s54, 0
  s_cbranch_scc0 L_ci_arrsc1
  s_mov_b64 exec, 1
  v_mov_b32 v92, 136
  v_mov_b32 v93, 1
  buffer_atomic_add v93, v92, s[16:19], 0 offen
  s_mov_b64 exec, -1
L_ci_arrsc1:
  s_mov_b32 s12, s32
  s_and_b32 s13, s33, 0xffff
  s_mov_b32 s14, 0x400000
  s_mov_b32 s15, 0x20000
  s_mov_b32 s74, 0x200000
  buffer_load_dwordx4 a[224:227], v80, s[12:15], s74 offen
  s_mov_b32 s74, 0x208000
  buffer_load_dwordx4 a[228:231], v80, s[12:15], s74 offen
  s_mov_b32 s74, 0x210000
  buffer_load_dwordx4 a[232:235], v80, s[12:15], s74 offen
  s_mov_b32 s74, 0x218000
  buffer_load_dwordx4 a[236:239], v80, s[12:15], s74 offen
  s_mov_b32 s74, 0x220000
  buffer_load_dwordx4 a[240:243], v80, s[12:15], s74 offen
  s_mov_b32 s74, 0x228000
  buffer_load_dwordx4 a[244:247], v80, s[12:15], s74 offen
  s_mov_b32 s74, 0x230000
  buffer_load_dwordx4 a[248:251], v80, s[12:15], s74 offen
  s_mov_b32 s74, 0x238000
  buffer_load_dwordx4 a[252:255], v80, s[12:15], s74 offen
  s_waitcnt vmcnt(8)
  ds_write_b128 v82, a[192:195] offset:0
  ds_write_b128 v82, a[196:199] offset:1024
  ds_write_b128 v82, a[200:203] offset:2048
  ds_write_b128 v82, a[204:207] offset:3072
  ds_write_b128 v88, a[208:211] offset:4096
  ds_write_b128 v88, a[212:215] offset:5120
  ds_write_b128 v88, a[216:219] offset:6144
  ds_write_b128 v88, a[220:223] offset:7168
  s_waitcnt lgkmcnt(0)
  s_barrier
  ds_read_b64_tr_b16 a[192:193], v83 offset:0
  ds_read_b64_tr_b16 a[194:195], v83 offset:8192
  ds_read_b64_tr_b16 a[196:197], v83 offset:2048
  ds_read_b64_tr_b16 a[198:199], v83 offset:10240
  ds_read_b64_tr_b16 a[200:201], v84 offset:0
  ds_read_b64_tr_b16 a[202:203], v84 offset:8192
  ds_read_b64_tr_b16 a[204:205], v84 offset:2048
  ds_read_b64_tr_b16 a[206:207], v84 offset:10240
  s_waitcnt lgkmcnt(0)
  ds_read_b64_tr_b16 a[208:209], v83 offset:16384
  ds_read_b64_tr_b16 a[210:211], v83 offset:24576
  ds_read_b64_tr_b16 a[212:213], v83 offset:18432
  ds_read_b64_tr_b16 a[214:215], v83 offset:26624
  ds_read_b64_tr_b16 a[216:217], v84 offset:16384
  ds_read_b64_tr_b16 a[218:219], v84 offset:24576
  ds_read_b64_tr_b16 a[220:221], v84 offset:18432
  ds_read_b64_tr_b16 a[222:223], v84 offset:26624
  s_waitcnt lgkmcnt(0)
  s_barrier
  s_mov_b32 s8, s30
  s_and_b32 s9, s31, 0xffff
  s_mov_b32 s10, 0x400000
  s_mov_b32 s11, 0x20000
  s_mov_b32 s74, 0x300000
  buffer_load_dwordx4 v[16:19], v80, s[8:11], s74 offen
  s_mov_b32 s74, 0x308000
  buffer_load_dwordx4 v[20:23], v80, s[8:11], s74 offen
  s_mov_b32 s74, 0x310000
  buffer_load_dwordx4 v[24:27], v80, s[8:11], s74 offen
  s_mov_b32 s74, 0x318000
  buffer_load_dwordx4 v[28:31], v80, s[8:11], s74 offen
  s_mov_b32 s74, 0x320000
  buffer_load_dwordx4 v[32:35], v80, s[8:11], s74 offen
  s_mov_b32 s74, 0x328000
  buffer_load_dwordx4 v[36:39], v80, s[8:11], s74 offen
  s_mov_b32 s74, 0x330000
  buffer_load_dwordx4 v[40:43], v80, s[8:11], s74 offen
  s_mov_b32 s74, 0x338000
  buffer_load_dwordx4 v[44:47], v80, s[8:11], s74 offen
  s_waitcnt vmcnt(8)
  ds_write_b128 v82, a[224:227] offset:0
  ds_write_b128 v82, a[228:231] offset:1024
  ds_write_b128 v82, a[232:235] offset:2048
  ds_write_b128 v82, a[236:239] offset:3072
  ds_write_b128 v88, a[240:243] offset:4096
  ds_write_b128 v88, a[244:247] offset:5120
  ds_write_b128 v88, a[248:251] offset:6144
  ds_write_b128 v88, a[252:255] offset:7168
  s_waitcnt lgkmcnt(0)
  s_barrier
  ds_read_b64_tr_b16 a[224:225], v83 offset:0
  ds_read_b64_tr_b16 a[226:227], v83 offset:8192
  ds_read_b64_tr_b16 a[228:229], v83 offset:2048
  ds_read_b64_tr_b16 a[230:231], v83 offset:10240
  ds_read_b64_tr_b16 a[232:233], v84 offset:0
  ds_read_b64_tr_b16 a[234:235], v84 offset:8192
  ds_read_b64_tr_b16 a[236:237], v84 offset:2048
  ds_read_b64_tr_b16 a[238:239], v84 offset:10240
  s_waitcnt lgkmcnt(0)
  ds_read_b64_tr_b16 a[240:241], v83 offset:16384
  ds_read_b64_tr_b16 a[242:243], v83 offset:24576
  ds_read_b64_tr_b16 a[244:245], v83 offset:18432
  ds_read_b64_tr_b16 a[246:247], v83 offset:26624
  ds_read_b64_tr_b16 a[248:249], v84 offset:16384
  ds_read_b64_tr_b16 a[250:251], v84 offset:24576
  ds_read_b64_tr_b16 a[252:253], v84 offset:18432
  ds_read_b64_tr_b16 a[254:255], v84 offset:26624
  s_waitcnt lgkmcnt(0)
  s_barrier
  s_mov_b32 s12, s32
  s_and_b32 s13, s33, 0xffff
  s_mov_b32 s14, 0x400000
  s_mov_b32 s15, 0x20000
  s_mov_b32 s74, 0x300000
  buffer_load_dwordx4 v[128:131], v80, s[12:15], s74 offen
  s_mov_b32 s74, 0x308000
  buffer_load_dwordx4 v[132:135], v80, s[12:15], s74 offen
  s_mov_b32 s74, 0x310000
  buffer_load_dwordx4 v[136:139], v80, s[12:15], s74 offen
  s_mov_b32 s74, 0x318000
  buffer_load_dwordx4 v[140:143], v80, s[12:15], s74 offen
  s_mov_b32 s74, 0x320000
  buffer_load_dwordx4 v[144:147], v80, s[12:15], s74 offen
  s_mov_b32 s74, 0x328000
  buffer_load_dwordx4 v[148:151], v80, s[12:15], s74 offen
  s_mov_b32 s74, 0x330000
  buffer_load_dwordx4 v[152:155], v80, s[12:15], s74 offen
  s_mov_b32 s74, 0x338000
  buffer_load_dwordx4 v[156:159], v80, s[12:15], s74 offen
  s_waitcnt vmcnt(8)
  ds_write_b128 v82, v[16:19] offset:0
  ds_write_b128 v82, v[20:23] offset:1024
  ds_write_b128 v82, v[24:27] offset:2048
  ds_write_b128 v82, v[28:31] offset:3072
  ds_write_b128 v88, v[32:35] offset:4096
  ds_write_b128 v88, v[36:39] offset:5120
  ds_write_b128 v88, v[40:43] offset:6144
  ds_write_b128 v88, v[44:47] offset:7168
  s_waitcnt lgkmcnt(0)
  s_barrier
  ds_read_b64_tr_b16 v[16:17], v83 offset:0
  ds_read_b64_tr_b16 v[18:19], v83 offset:8192
  ds_read_b64_tr_b16 v[20:21], v83 offset:2048
  ds_read_b64_tr_b16 v[22:23], v83 offset:10240
  ds_read_b64_tr_b16 v[24:25], v84 offset:0
  ds_read_b64_tr_b16 v[26:27], v84 offset:8192
  ds_read_b64_tr_b16 v[28:29], v84 offset:2048
  ds_read_b64_tr_b16 v[30:31], v84 offset:10240
  s_waitcnt lgkmcnt(0)
  ds_read_b64_tr_b16 v[32:33], v83 offset:16384
  ds_read_b64_tr_b16 v[34:35], v83 offset:24576
  ds_read_b64_tr_b16 v[36:37], v83 offset:18432
  ds_read_b64_tr_b16 v[38:39], v83 offset:26624
  ds_read_b64_tr_b16 v[40:41], v84 offset:16384
  ds_read_b64_tr_b16 v[42:43], v84 offset:24576
  ds_read_b64_tr_b16 v[44:45], v84 offset:18432
  ds_read_b64_tr_b16 v[46:47], v84 offset:26624
  s_waitcnt lgkmcnt(0)
  s_barrier
  ds_write_b128 v9, v[16:19] offset:16384
  ds_write_b128 v9, v[20:23] offset:17408
  ds_write_b128 v9, v[24:27] offset:18432
  ds_write_b128 v9, v[28:31] offset:19456
  ds_write_b128 v9, v[32:35] offset:20480
  ds_write_b128 v9, v[36:39] offset:21504
  ds_write_b128 v9, v[40:43] offset:22528
  ds_write_b128 v9, v[44:47] offset:23552
  s_waitcnt lgkmcnt(0)
  s_mov_b32 s8, s34
  s_and_b32 s9, s35, 0xffff
  s_mov_b32 s10, 0x400000
  s_mov_b32 s11, 0x20000
  s_mov_b32 s74, 0x0
  buffer_load_dwordx4 v[160:163], v81, s[8:11], s74 offen
  s_mov_b32 s74, 0x2000
  buffer_load_dwordx4 v[164:167], v81, s[8:11], s74 offen
  s_mov_b32 s74, 0x4000
  buffer_load_dwordx4 v[168:171], v81, s[8:11], s74 offen
  s_mov_b32 s74, 0x6000
  buffer_load_dwordx4 v[172:175], v81, s[8:11], s74 offen
  s_mov_b32 s74, 0x8000
  buffer_load_dwordx4 v[176:179], v81, s[8:11], s74 offen
  s_mov_b32 s74, 0xa000
  buffer_load_dwordx4 v[180:183], v81, s[8:11], s74 offen
  s_mov_b32 s74, 0xc000
  buffer_load_dwordx4 v[184:187], v81, s[8:11], s74 offen
  s_mov_b32 s74, 0xe000
  buffer_load_dwordx4 v[188:191], v81, s[8:11], s74 offen
  s_waitcnt vmcnt(8)
  ds_write_b128 v82, v[128:131] offset:0
  ds_write_b128 v82, v[132:135] offset:1024
  ds_write_b128 v82, v[136:139] offset:2048
  ds_write_b128 v82, v[140:143] offset:3072
  ds_write_b128 v88, v[144:147] offset:4096
  ds_write_b128 v88, v[148:151] offset:5120
  ds_write_b128 v88, v[152:155] offset:6144
  ds_write_b128 v88, v[156:159] offset:7168
  s_waitcnt lgkmcnt(0)
  s_barrier
  ds_read_b64_tr_b16 v[128:129], v83 offset:0
  ds_read_b64_tr_b16 v[130:131], v83 offset:8192
  ds_read_b64_tr_b16 v[132:133], v83 offset:2048
  ds_read_b64_tr_b16 v[134:135], v83 offset:10240
  ds_read_b64_tr_b16 v[136:137], v84 offset:0
  ds_read_b64_tr_b16 v[138:139], v84 offset:8192
  ds_read_b64_tr_b16 v[140:141], v84 offset:2048
  ds_read_b64_tr_b16 v[142:143], v84 offset:10240
  s_waitcnt lgkmcnt(0)
  ds_read_b64_tr_b16 v[144:145], v83 offset:16384
  ds_read_b64_tr_b16 v[146:147], v83 offset:24576
  ds_read_b64_tr_b16 v[148:149], v83 offset:18432
  ds_read_b64_tr_b16 v[150:151], v83 offset:26624
  ds_read_b64_tr_b16 v[152:153], v84 offset:16384
  ds_read_b64_tr_b16 v[154:155], v84 offset:24576
  ds_read_b64_tr_b16 v[156:157], v84 offset:18432
  ds_read_b64_tr_b16 v[158:159], v84 offset:26624
  s_waitcnt lgkmcnt(0)
  s_barrier
  s_mov_b32 s12, s34
  s_and_b32 s13, s35, 0xffff
  s_mov_b32 s14, 0x400000
  s_mov_b32 s15, 0x20000
  s_mov_b32 s74, 0x200
  buffer_load_dwordx4 v[192:195], v81, s[12:15], s74 offen
  s_mov_b32 s74, 0x2200
  buffer_load_dwordx4 v[196:199], v81, s[12:15], s74 offen
  s_mov_b32 s74, 0x4200
  buffer_load_dwordx4 v[200:203], v81, s[12:15], s74 offen
  s_mov_b32 s74, 0x6200
  buffer_load_dwordx4 v[204:207], v81, s[12:15], s74 offen
  s_mov_b32 s74, 0x8200
  buffer_load_dwordx4 v[208:211], v81, s[12:15], s74 offen
  s_mov_b32 s74, 0xa200
  buffer_load_dwordx4 v[212:215], v81, s[12:15], s74 offen
  s_mov_b32 s74, 0xc200
  buffer_load_dwordx4 v[216:219], v81, s[12:15], s74 offen
  s_mov_b32 s74, 0xe200
  buffer_load_dwordx4 v[220:223], v81, s[12:15], s74 offen
  s_waitcnt vmcnt(8)
  ds_write_b128 v85, v[160:163] offset:0
  ds_write_b128 v86, v[164:167] offset:1024
  ds_write_b128 v85, v[168:171] offset:2048
  ds_write_b128 v86, v[172:175] offset:3072
  ds_write_b128 v85, v[176:179] offset:4096
  ds_write_b128 v86, v[180:183] offset:5120
  ds_write_b128 v85, v[184:187] offset:6144
  ds_write_b128 v86, v[188:191] offset:7168
  s_waitcnt lgkmcnt(0)
  ds_read_b64_tr_b16 v[160:161], v87 offset:0
  ds_read_b64_tr_b16 v[162:163], v87 offset:256
  ds_read_b64_tr_b16 v[164:165], v87 offset:4096
  ds_read_b64_tr_b16 v[166:167], v87 offset:4352
  v_xor_b32 v15, 32, v87
  ds_read_b64_tr_b16 v[168:169], v15 offset:0
  ds_read_b64_tr_b16 v[170:171], v15 offset:256
  ds_read_b64_tr_b16 v[172:173], v15 offset:4096
  ds_read_b64_tr_b16 v[174:175], v15 offset:4352
  s_waitcnt lgkmcnt(0)
  v_xor_b32 v15, 64, v87
  ds_read_b64_tr_b16 v[176:177], v15 offset:0
  ds_read_b64_tr_b16 v[178:179], v15 offset:256
  ds_read_b64_tr_b16 v[180:181], v15 offset:4096
  ds_read_b64_tr_b16 v[182:183], v15 offset:4352
  v_xor_b32 v15, 96, v87
  ds_read_b64_tr_b16 v[184:185], v15 offset:0
  ds_read_b64_tr_b16 v[186:187], v15 offset:256
  ds_read_b64_tr_b16 v[188:189], v15 offset:4096
  ds_read_b64_tr_b16 v[190:191], v15 offset:4352
  s_waitcnt lgkmcnt(0)
  s_barrier
  s_mov_b32 s8, s34
  s_and_b32 s9, s35, 0xffff
  s_mov_b32 s10, 0x400000
  s_mov_b32 s11, 0x20000
  s_mov_b32 s74, 0x10000
  buffer_load_dwordx4 v[224:227], v81, s[8:11], s74 offen
  s_mov_b32 s74, 0x12000
  buffer_load_dwordx4 v[228:231], v81, s[8:11], s74 offen
  s_mov_b32 s74, 0x14000
  buffer_load_dwordx4 v[232:235], v81, s[8:11], s74 offen
  s_mov_b32 s74, 0x16000
  buffer_load_dwordx4 v[236:239], v81, s[8:11], s74 offen
  s_mov_b32 s74, 0x18000
  buffer_load_dwordx4 v[240:243], v81, s[8:11], s74 offen
  s_mov_b32 s74, 0x1a000
  buffer_load_dwordx4 v[244:247], v81, s[8:11], s74 offen
  s_mov_b32 s74, 0x1c000
  buffer_load_dwordx4 v[248:251], v81, s[8:11], s74 offen
  s_mov_b32 s74, 0x1e000
  buffer_load_dwordx4 v[252:255], v81, s[8:11], s74 offen
  s_waitcnt vmcnt(8)
  ds_write_b128 v85, v[192:195] offset:0
  ds_write_b128 v86, v[196:199] offset:1024
  ds_write_b128 v85, v[200:203] offset:2048
  ds_write_b128 v86, v[204:207] offset:3072
  ds_write_b128 v85, v[208:211] offset:4096
  ds_write_b128 v86, v[212:215] offset:5120
  ds_write_b128 v85, v[216:219] offset:6144
  ds_write_b128 v86, v[220:223] offset:7168
  s_waitcnt lgkmcnt(0)
  ds_read_b64_tr_b16 v[192:193], v87 offset:0
  ds_read_b64_tr_b16 v[194:195], v87 offset:256
  ds_read_b64_tr_b16 v[196:197], v87 offset:4096
  ds_read_b64_tr_b16 v[198:199], v87 offset:4352
  v_xor_b32 v15, 32, v87
  ds_read_b64_tr_b16 v[200:201], v15 offset:0
  ds_read_b64_tr_b16 v[202:203], v15 offset:256
  ds_read_b64_tr_b16 v[204:205], v15 offset:4096
  ds_read_b64_tr_b16 v[206:207], v15 offset:4352
  s_waitcnt lgkmcnt(0)
  v_xor_b32 v15, 64, v87
  ds_read_b64_tr_b16 v[208:209], v15 offset:0
  ds_read_b64_tr_b16 v[210:211], v15 offset:256
  ds_read_b64_tr_b16 v[212:213], v15 offset:4096
  ds_read_b64_tr_b16 v[214:215], v15 offset:4352
  v_xor_b32 v15, 96, v87
  ds_read_b64_tr_b16 v[216:217], v15 offset:0
  ds_read_b64_tr_b16 v[218:219], v15 offset:256
  ds_read_b64_tr_b16 v[220:221], v15 offset:4096
  ds_read_b64_tr_b16 v[222:223], v15 offset:4352
  s_waitcnt lgkmcnt(0)
  s_barrier
  v_lshlrev_b32 v100, 4, v0
  v_add_u32 v100, 112, v100
  v_cmp_eq_u32 vcc, 0, v0
  s_nop 1
  v_cndmask_b32 v100, v100, 0, vcc
  s_mov_b64 exec, 0xff
  buffer_load_dwordx2 v[102:103], v100, s[16:19], 0 offen sc1
  s_mov_b64 exec, -1
  s_mov_b32 s12, s34
  s_and_b32 s13, s35, 0xffff
  s_mov_b32 s14, 0x400000
  s_mov_b32 s15, 0x20000
  s_mov_b32 s74, 0x10200
  buffer_load_dwordx4 v[48:51], v81, s[12:15], s74 offen
  s_mov_b32 s74, 0x12200
  buffer_load_dwordx4 v[52:55], v81, s[12:15], s74 offen
  s_mov_b32 s74, 0x14200
  buffer_load_dwordx4 v[56:59], v81, s[12:15], s74 offen
  s_mov_b32 s74, 0x16200
  buffer_load_dwordx4 v[60:63], v81, s[12:15], s74 offen
  s_mov_b32 s74, 0x18200
  buffer_load_dwordx4 v[64:67], v81, s[12:15], s74 offen
  s_mov_b32 s74, 0x1a200
  buffer_load_dwordx4 v[68:71], v81, s[12:15], s74 offen
  s_mov_b32 s74, 0x1c200
  buffer_load_dwordx4 v[72:75], v81, s[12:15], s74 offen
  s_mov_b32 s74, 0x1e200
  buffer_load_dwordx4 v[76:79], v81, s[12:15], s74 offen
  s_waitcnt vmcnt(8)
  ds_write_b128 v85, v[224:227] offset:0
  ds_write_b128 v86, v[228:231] offset:1024
  ds_write_b128 v85, v[232:235] offset:2048
  ds_write_b128 v86, v[236:239] offset:3072
  ds_write_b128 v85, v[240:243] offset:4096
  ds_write_b128 v86, v[244:247] offset:5120
  ds_write_b128 v85, v[248:251] offset:6144
  ds_write_b128 v86, v[252:255] offset:7168
  s_waitcnt lgkmcnt(0)
  ds_read_b64_tr_b16 v[224:225], v87 offset:0
  ds_read_b64_tr_b16 v[226:227], v87 offset:256
  ds_read_b64_tr_b16 v[228:229], v87 offset:4096
  ds_read_b64_tr_b16 v[230:231], v87 offset:4352
  v_xor_b32 v15, 32, v87
  ds_read_b64_tr_b16 v[232:233], v15 offset:0
  ds_read_b64_tr_b16 v[234:235], v15 offset:256
  ds_read_b64_tr_b16 v[236:237], v15 offset:4096
  ds_read_b64_tr_b16 v[238:239], v15 offset:4352
  s_waitcnt lgkmcnt(0)
  v_xor_b32 v15, 64, v87
  ds_read_b64_tr_b16 v[240:241], v15 offset:0
  ds_read_b64_tr_b16 v[242:243], v15 offset:256
  ds_read_b64_tr_b16 v[244:245], v15 offset:4096
  ds_read_b64_tr_b16 v[246:247], v15 offset:4352
  v_xor_b32 v15, 96, v87
  ds_read_b64_tr_b16 v[248:249], v15 offset:0
  ds_read_b64_tr_b16 v[250:251], v15 offset:256
  ds_read_b64_tr_b16 v[252:253], v15 offset:4096
  ds_read_b64_tr_b16 v[254:255], v15 offset:4352
  s_waitcnt lgkmcnt(0)
  s_barrier
  s_waitcnt vmcnt(0)
  ds_write_b128 v85, v[48:51] offset:0
  ds_write_b128 v86, v[52:55] offset:1024
  ds_write_b128 v85, v[56:59] offset:2048
  ds_write_b128 v86, v[60:63] offset:3072
  ds_write_b128 v85, v[64:67] offset:4096
  ds_write_b128 v86, v[68:71] offset:5120
  ds_write_b128 v85, v[72:75] offset:6144
  ds_write_b128 v86, v[76:79] offset:7168
  s_waitcnt lgkmcnt(0)
  ds_read_b64_tr_b16 v[48:49], v87 offset:0
  ds_read_b64_tr_b16 v[50:51], v87 offset:256
  ds_read_b64_tr_b16 v[52:53], v87 offset:4096
  ds_read_b64_tr_b16 v[54:55], v87 offset:4352
  v_xor_b32 v15, 32, v87
  ds_read_b64_tr_b16 v[56:57], v15 offset:0
  ds_read_b64_tr_b16 v[58:59], v15 offset:256
  ds_read_b64_tr_b16 v[60:61], v15 offset:4096
  ds_read_b64_tr_b16 v[62:63], v15 offset:4352
  s_waitcnt lgkmcnt(0)
  v_xor_b32 v15, 64, v87
  ds_read_b64_tr_b16 v[64:65], v15 offset:0
  ds_read_b64_tr_b16 v[66:67], v15 offset:256
  ds_read_b64_tr_b16 v[68:69], v15 offset:4096
  ds_read_b64_tr_b16 v[70:71], v15 offset:4352
  v_xor_b32 v15, 96, v87
  ds_read_b64_tr_b16 v[72:73], v15 offset:0
  ds_read_b64_tr_b16 v[74:75], v15 offset:256
  ds_read_b64_tr_b16 v[76:77], v15 offset:4096
  ds_read_b64_tr_b16 v[78:79], v15 offset:4352
  s_waitcnt lgkmcnt(0)
  s_barrier
  ds_write_b128 v9, v[48:51] offset:24576
  ds_write_b128 v9, v[52:55] offset:25600
  ds_write_b128 v9, v[56:59] offset:26624
  ds_write_b128 v9, v[60:63] offset:27648
  ds_write_b128 v9, v[64:67] offset:28672
  ds_write_b128 v9, v[68:71] offset:29696
  ds_write_b128 v9, v[72:75] offset:30720
  ds_write_b128 v9, v[76:79] offset:31744
  s_waitcnt lgkmcnt(0)
  s_waitcnt lgkmcnt(0)
  s_barrier
  v_lshlrev_b32 v122, 4, v0
  v_add_u32 v122, 112, v122
  v_cmp_eq_u32 vcc, 0, v0
  s_nop 1
  v_cndmask_b32 v122, v122, 0, vcc
  v_lshlrev_b32 v1, 4, v0
  s_lshl_b32 s72, s54, 10
  s_add_u32 s72, s72, 0x24000
  v_add_u32 v2, s72, v1
  v_lshrrev_b32 v3, 4, v0
  v_and_b32 v3, 3, v3
  v_lshlrev_b32 v3, 8, v3
  v_lshrrev_b32 v127, 1, v0
  v_and_b32 v127, 1, v127
  v_lshlrev_b32 v127, 7, v127
  v_add_u32 v3, v3, v127
  v_lshrrev_b32 v127, 2, v0
  v_and_b32 v127, 3, v127
  v_lshlrev_b32 v127, 5, v127
  v_add_u32 v3, v3, v127
  v_and_b32 v127, 1, v0
  v_lshlrev_b32 v127, 4, v127
  v_add_u32 v3, v3, v127
  v_add_u32 v3, 0x24000, v3
  v_and_b32 v5, 15, v0
  v_lshlrev_b32 v5, 4, v5
  v_lshrrev_b32 v127, 4, v0
  v_and_b32 v127, 3, v127
  v_lshlrev_b32 v127, 2, v127
  v_add_u32 v5, v5, v127
  v_add_u32 v5, 0x26000, v5
  s_lshl_b32 s72, s54, 9
  v_add_u32 v5, s72, v5
  v_and_b32 v4, 15, v0
  v_lshlrev_b32 v4, 5, v4
  v_lshrrev_b32 v127, 4, v0
  v_and_b32 v127, 3, v127
  v_lshlrev_b32 v127, 3, v127
  v_add_u32 v4, v4, v127
  v_add_u32 v4, 0x26800, v4
  s_lshl_b32 s72, s54, 10
  v_add_u32 v4, s72, v4
  v_lshrrev_b32 v6, 4, v0
  v_and_b32 v6, 3, v6
  v_lshlrev_b32 v6, 6, v6
  v_lshrrev_b32 v127, 2, v0
  v_and_b32 v127, 3, v127
  v_lshlrev_b32 v127, 4, v127
  v_add_u32 v6, v6, v127
  v_and_b32 v127, 1, v0
  v_lshlrev_b32 v127, 3, v127
  v_add_u32 v6, v6, v127
  v_add_u32 v6, 0x26000, v6
  v_lshrrev_b32 v7, 1, v0
  v_and_b32 v7, 3, v7
  v_lshlrev_b32 v7, 6, v7
  v_lshrrev_b32 v127, 5, v0
  v_and_b32 v127, 1, v127
  v_lshlrev_b32 v127, 5, v127
  v_add_u32 v7, v7, v127
  v_and_b32 v127, 1, v0
  v_lshlrev_b32 v127, 4, v127
  v_add_u32 v7, v7, v127
  v_lshrrev_b32 v127, 4, v0
  v_and_b32 v127, 1, v127
  v_lshlrev_b32 v127, 3, v127
  v_add_u32 v7, v7, v127
  v_add_u32 v7, 0x27800, v7
  s_lshl_b32 s72, s54, 9
  v_add_u32 v7, s72, v7
  v_add_u32 v8, 0x27800, v1
  v_add_u32 v10, 0x20000, v1
  v_lshrrev_b32 v11, 1, v0
  v_and_b32 v11, 7, v11
  v_lshlrev_b32 v11, 12, v11
  v_and_b32 v127, 1, v0
  v_lshlrev_b32 v127, 6, v127
  v_add_u32 v11, v11, v127
  v_lshrrev_b32 v127, 4, v0
  v_and_b32 v127, 3, v127
  v_lshlrev_b32 v127, 4, v127
  v_add_u32 v11, v11, v127
  s_lshl_b32 s72, s54, 15
  v_add_u32 v11, s72, v11
  s_lshl_b32 s72, s52, 7
  v_add_u32 v11, s72, v11
  v_and_b32 v12, 3, v0
  v_lshlrev_b32 v12, 5, v12
  v_lshrrev_b32 v127, 4, v0
  v_and_b32 v127, 1, v127
  v_lshlrev_b32 v127, 4, v127
  v_add_u32 v12, v12, v127
  v_lshrrev_b32 v127, 2, v0
  v_and_b32 v127, 1, v127
  v_lshlrev_b32 v127, 3, v127
  v_add_u32 v12, v12, v127
  s_lshl_b32 s72, s52, 7
  v_add_u32 v12, s72, v12
  v_mov_b32 v13, 0x4444
  v_mov_b32 v15, 0xeeee
  v_lshrrev_b32 v14, 1, v0
  v_and_b32 v14, 1, v14
  v_cmp_eq_u32 vcc, 1, v14
  s_nop 1
  v_cndmask_b32 v13, v13, v15, vcc
  v_and_b32 v15, 1, v0
  v_lshlrev_b32 v15, 4, v15
  v_mov_b32 v14, 0x3f80
  v_lshlrev_b32 v14, v15, v14
  s_mov_b32 s71, 0x3e0293ee
  s_mov_b32 s2, 0x3e0293ee
  s_mov_b32 s3, 0x3e0293ee
  v_lshlrev_b32 v0, 3, v0
  v_add_u32 v0, 0x26800, v0
  s_mov_b32 s56, 0
  s_and_b32 s72, s54, 1
  s_lshl_b32 s20, s72, 12
  s_lshl_b32 s21, s54, 10
  s_lshl_b32 s22, s72, 17
  s_lshl_b32 s73, s52, 12
  s_add_u32 s22, s22, s73
  s_lshl_b32 s23, s72, 11
  s_add_u32 s23, s23, s73
  s_lshr_b32 s72, s54, 1
  s_lshl_b32 s72, s72, 17
  s_add_u32 s23, s23, s72
  s_mov_b32 s77, 0x42c0000
  s_add_u32 s57, s77, s21
  s_mov_b32 s60, 0x4240000
  s_lshl_b32 s73, s54, 11
  s_lshl_b32 s72, s56, 5
  s_add_u32 s72, s72, s52
  s_lshl_b32 s63, s72, 13
  s_add_u32 s63, s63, s73
  s_add_u32 s64, s63, 0x240000
  s_add_u32 s63, s63, 0x2200000
  s_lshl_b32 s65, s72, 12
  s_lshl_b32 s73, s54, 10
  s_add_u32 s65, s65, s73
  s_add_u32 s66, s65, 0x3a00000
  s_add_u32 s65, s65, 0x3200000
  s_lshl_b32 s72, s52, 7
  s_add_u32 s67, s72, 0x42d1000
  s_add_u32 s68, s72, 0x42d5000
  s_add_u32 s72, s56, 1
  s_and_b32 s72, s72, 1
  s_lshl_b32 s72, s72, 13
  s_lshl_b32 s73, s54, 11
  s_add_u32 s72, s72, s73
  s_add_u32 s69, s72, 0x20000
  s_lshl_b32 s72, s56, 7
  s_lshl_b32 s73, s52, 13
  s_add_u32 s72, s72, s73
  s_lshl_b32 s73, s54, 5
  s_add_u32 s72, s72, s73
  s_add_u32 s76, s72, 0x5000000
  s_waitcnt vmcnt(0)
L_clr_check_s:
  v_readlane_b32 s96, v103, 0
  v_readlane_b32 s97, v103, 1
  v_readlane_b32 s98, v103, 2
  v_readlane_b32 s99, v103, 3
  v_readlane_b32 s100, v103, 4
  v_readlane_b32 s101, v103, 5
  v_readlane_b32 s80, v103, 6
  v_readlane_b32 s81, v103, 7
  s_nop 3
  s_add_u32 s74, s96, s97
  s_add_u32 s74, s74, s98
  s_add_u32 s74, s74, s99
  s_add_u32 s74, s74, s100
  s_add_u32 s74, s74, s101
  s_add_u32 s74, s74, s80
  s_add_u32 s74, s74, s81
  s_cmp_ge_u32 s74, 0x100
  s_cbranch_scc1 L_clr_ok_s
  s_sub_u32 s70, s70, 16
  s_cselect_b32 s70, 0, s70
  s_cbranch_scc1 L_clr_ok_s
  s_sleep 2
  s_mov_b64 exec, 0xff
  buffer_load_dwordx2 v[102:103], v122, s[16:19], 0 offen sc1
  s_mov_b64 exec, -1
  s_waitcnt vmcnt(0)
  s_branch L_clr_check_s
L_clr_ok_s:
L_start_poll_s:
  s_mov_b64 exec, 0xff
  buffer_load_dwordx4 v[16:19], v122, s[16:19], 0 offen sc1
  s_mov_b64 exec, -1
  buffer_load_dwordx2 v[20:21], off, s[4:7], s67 sc1
  s_waitcnt vmcnt(0)
  v_readlane_b32 s74, v18, 1
  v_readfirstlane_b32 s72, v20
  v_readfirstlane_b32 s73, v21
  s_nop 3
  s_cmp_ge_u32 s74, 32
  s_cbranch_scc0 L_start_again_s
  s_lshl_b32 s72, s72, 1
  s_lshl_b32 s73, s73, 1
  s_add_u32 s73, s73, 1
  s_min_u32 s75, s72, s73
  s_cmp_ge_u32 s75, 1
  s_cbranch_scc1 L_start_ok_s
L_start_again_s:
  s_sub_u32 s70, s70, 16
  s_cselect_b32 s70, 0, s70
  s_cbranch_scc1 L_start_ok_s
  s_sleep 2
  s_branch L_start_poll_s
L_start_ok_s:
  s_xor_b32 s73, s69, 0x2000
  s_mov_b32 m0, s73
  s_sub_u32 s74, s64, 262144
  buffer_load_dwordx4 v1, s[4:7], s74 offen sc1 lds
  s_add_u32 m0, s73, 1024
  s_add_u32 s74, s74, 1024
  buffer_load_dwordx4 v1, s[4:7], s74 offen sc1 lds
  ds_read_b128 v[48:51], v9 offset:0
  ds_read_b128 v[52:55], v9 offset:1024
  ds_read_b128 v[56:59], v9 offset:2048
  ds_read_b128 v[60:63], v9 offset:3072
  ds_read_b128 v[64:67], v9 offset:4096
  ds_read_b128 v[68:71], v9 offset:5120
  ds_read_b128 v[72:75], v9 offset:6144
  ds_read_b128 v[76:79], v9 offset:7168
  v_mov_b64 v[80:81], 0
  v_mov_b64 v[82:83], 0
  v_mov_b64 v[84:85], 0
  v_mov_b64 v[86:87], 0
  v_mov_b64 v[88:89], 0
  v_mov_b64 v[90:91], 0
  v_mov_b64 v[92:93], 0
  v_mov_b64 v[94:95], 0
  v_mov_b64 v[96:97], 0
  v_mov_b64 v[98:99], 0
  v_mov_b64 v[100:101], 0
  v_mov_b64 v[102:103], 0
  v_mov_b64 v[126:127], 0
L_poll2_s:
  buffer_load_dwordx4 v[112:115], v1, s[4:7], s57 offen sc1
  s_add_u32 s62, s60, s23
  s_xor_b32 s60, s60, 0x40000
  s_add_u32 s61, s60, s22
  s_mov_b32 s78, s77
  s_add_u32 s59, s78, s20
  s_add_u32 s77, s77, 0x2000
  s_and_b32 s77, s77, 0xffff7fff
  s_add_u32 s58, s77, s20
  s_nop 15
  s_nop 1
  buffer_load_dwordx4 v[120:123], v1, s[4:7], s57 offen sc1
L_p2loop_s:
  s_waitcnt vmcnt(1)
  s_waitcnt lgkmcnt(14)
  ds_write_b128 v2, v[112:115]
  v_max3_u32 v15, v112, v113, v114
  v_max_u32 v15, v15, v115
  v_cmp_eq_u32 vcc, -1, v15
  s_nop 0
  s_cbranch_vccnz L_p2n0_s
L_got2_s:
  s_add_u32 s72, s57, 4096
  buffer_load_dwordx4 v[116:119], v1, s[4:7], s72 offen sc1
  s_waitcnt lgkmcnt(0)
  s_barrier
  ds_read_b128 v[16:19], v3 offset:0
  ds_read_b128 v[20:23], v3 offset:1024
  ds_read_b128 v[24:27], v3 offset:2048
  ds_read_b128 v[28:31], v3 offset:3072
  s_waitcnt lgkmcnt(3)
  v_smfmac_f32_16x16x64_bf16 v[80:83], v[16:19], a[0:7], v13
  v_smfmac_f32_16x16x64_bf16 v[84:87], v[16:19], a[8:15], v13
  s_waitcnt lgkmcnt(2)
  buffer_load_dwordx4 v[104:107], v1, s[4:7], s63 offen sc1
  v_smfmac_f32_16x16x64_bf16 v[80:83], v[20:23], a[16:23], v13
  v_smfmac_f32_16x16x64_bf16 v[84:87], v[20:23], a[24:31], v13
  s_waitcnt lgkmcnt(1)
  buffer_load_dwordx4 v[108:111], v1, s[4:7], s63 offen offset:1024 sc1
  v_smfmac_f32_16x16x64_bf16 v[80:83], v[24:27], v[48:55], v13
  ds_read_b128 v[48:51], v9 offset:8192
  ds_read_b128 v[52:55], v9 offset:9216
  v_smfmac_f32_16x16x64_bf16 v[84:87], v[24:27], v[56:63], v13
  s_waitcnt lgkmcnt(2)
  ds_read_b128 v[56:59], v9 offset:10240
  ds_read_b128 v[60:63], v9 offset:11264
  v_smfmac_f32_16x16x64_bf16 v[80:83], v[28:31], v[64:71], v13
  ds_read_b128 v[64:67], v9 offset:12288
  ds_read_b128 v[68:71], v9 offset:13312
  v_smfmac_f32_16x16x64_bf16 v[84:87], v[28:31], v[72:79], v13
  ds_read_b128 v[72:75], v9 offset:14336
  ds_read_b128 v[76:79], v9 offset:15360
  v_smfmac_f32_16x16x64_bf16 v[88:91], v[16:19], a[64:71], v13
  s_waitcnt vmcnt(2)
L_check2b_s:
  v_max3_u32 v15, v116, v117, v118
  v_max_u32 v15, v15, v119
  v_smfmac_f32_16x16x64_bf16 v[92:95], v[16:19], a[72:79], v13
  v_cmp_eq_u32 vcc, -1, v15
  s_nop 0
  s_cbranch_vccnz L_retry2b_s
L_got2b_s:
  ds_write_b128 v2, v[116:119] offset:4096
  v_smfmac_f32_16x16x64_bf16 v[88:91], v[20:23], a[80:87], v13
  v_smfmac_f32_16x16x64_bf16 v[92:95], v[20:23], a[88:95], v13
  v_mov_b64 v[122:123], -1
  s_waitcnt lgkmcnt(0)
  s_barrier
  v_smfmac_f32_16x16x64_bf16 v[88:91], v[24:27], v[48:55], v13
  ds_read_b128 v[32:35], v3 offset:4096
  v_mov_b64 v[124:125], -1
  v_smfmac_f32_16x16x64_bf16 v[92:95], v[24:27], v[56:63], v13
  ds_read_b128 v[36:39], v3 offset:5120
  ds_read_b128 v[48:51], v9 offset:16384
  v_smfmac_f32_16x16x64_bf16 v[88:91], v[28:31], v[64:71], v13
  s_sub_u32 s72, s75, s56
  s_cmp_lt_u32 s72, 6
  s_cbranch_scc0 L_nokvpf_s
  v_readfirstlane_b32 s72, v126
  v_readfirstlane_b32 s73, v127
  s_nop 3
  s_lshl_b32 s72, s72, 1
  s_lshl_b32 s73, s73, 1
  s_add_u32 s73, s73, 1
  s_min_u32 s72, s72, s73
  s_max_u32 s75, s75, s72
  buffer_load_dwordx2 v[126:127], off, s[4:7], s67 sc1
L_nokvpf_s:
  ds_read_b128 v[52:55], v9 offset:17408
  ds_read_b128 v[40:43], v3 offset:6144
  ds_read_b128 v[56:59], v9 offset:18432
  v_smfmac_f32_16x16x64_bf16 v[92:95], v[28:31], v[72:79], v13
  ds_read_b128 v[60:63], v9 offset:19456
  ds_read_b128 v[64:67], v9 offset:20480
  v_smfmac_f32_16x16x64_bf16 v[96:99], v[16:19], a[160:167], v13
  ds_read_b128 v[68:71], v9 offset:21504
  ds_read_b128 v[44:47], v3 offset:7168
  v_smfmac_f32_16x16x64_bf16 v[100:103], v[16:19], a[168:175], v13
  s_waitcnt lgkmcnt(9)
  buffer_store_dwordx4 v[122:125], v1, s[4:7], s62 offen sc1
  ds_read_b128 v[72:75], v9 offset:22528
  v_smfmac_f32_16x16x64_bf16 v[80:83], v[32:35], a[32:39], v13
  ds_read_b128 v[76:79], v9 offset:23552
  v_smfmac_f32_16x16x64_bf16 v[84:87], v[32:35], a[40:47], v13
  s_waitcnt lgkmcnt(10)
  v_smfmac_f32_16x16x64_bf16 v[80:83], v[36:39], a[48:55], v13
  s_add_u32 s74, s56, 1
  s_cmp_lt_u32 s74, s75
  s_cbranch_scc0 L_kvspin_s
L_kvok_s:
  s_mov_b32 m0, s69
  s_nop 0
  buffer_load_dwordx4 v1, s[4:7], s64 offen sc1 lds
  v_smfmac_f32_16x16x64_bf16 v[84:87], v[36:39], a[56:63], v13
  s_waitcnt lgkmcnt(7)
  v_smfmac_f32_16x16x64_bf16 v[80:83], v[40:43], v[48:55], v13
  s_waitcnt lgkmcnt(5)
  v_smfmac_f32_16x16x64_bf16 v[84:87], v[40:43], v[56:63], v13
  s_waitcnt lgkmcnt(2)
  v_mov_b32 v15, s56
  v_smfmac_f32_16x16x64_bf16 v[80:83], v[44:47], v[64:71], v13
  s_waitcnt lgkmcnt(0)
  s_cmp_eq_u32 s54, 2
  s_cselect_b64 exec, 1, 0
  buffer_store_dword v15, off, s[4:7], s68 sc1
  s_mov_b64 exec, -1
  v_smfmac_f32_16x16x64_bf16 v[84:87], v[44:47], v[72:79], v13
  v_smfmac_f32_16x16x64_bf16 v[88:91], v[32:35], a[96:103], v13
  s_nop 2
  v_smfmac_f32_16x16x64_bf16 v[92:95], v[32:35], a[104:111], v13
  s_nop 2
  v_smfmac_f32_16x16x64_bf16 v[88:91], v[36:39], a[112:119], v13
  buffer_store_dwordx4 v[122:125], v1, s[4:7], s62 offen offset:1024 sc1
  v_add_f32 v80, v80, v82
  v_smfmac_f32_16x16x64_bf16 v[92:95], v[36:39], a[120:127], v13
  v_add_f32 v81, v81, v83
  v_cvt_pk_bf16_f32 v80, v80, v81
  v_smfmac_f32_16x16x64_bf16 v[88:91], v[40:43], a[128:135], v13
  v_add_f32 v84, v84, v86
  v_add_f32 v85, v85, v87
  v_smfmac_f32_16x16x64_bf16 v[92:95], v[40:43], a[136:143], v13
  v_cvt_pk_bf16_f32 v84, v84, v85
  ds_write2_b32 v4, v80, v80 offset0:0 offset1:1
  v_smfmac_f32_16x16x64_bf16 v[88:91], v[44:47], a[144:151], v13
  s_add_u32 m0, s69, 1024
  s_add_u32 s73, s64, 1024
  buffer_load_dwordx4 v1, s[4:7], s73 offen sc1 lds
  ds_write2_b32 v4, v84, v84 offset0:128 offset1:129
  v_smfmac_f32_16x16x64_bf16 v[92:95], v[44:47], a[152:159], v13
  ds_read_b128 v[16:19], v10 offset:0
  v_smfmac_f32_16x16x64_bf16 v[96:99], v[20:23], a[176:183], v13
  s_nop 2
  v_smfmac_f32_16x16x64_bf16 v[100:103], v[20:23], a[184:191], v13
  s_nop 2
  v_smfmac_f32_16x16x64_bf16 v[96:99], v[24:27], a[192:199], v13
  v_add_f32 v88, v88, v90
  v_add_f32 v89, v89, v91
  v_cvt_pk_bf16_f32 v88, v88, v89
  v_add_f32 v92, v92, v94
  v_smfmac_f32_16x16x64_bf16 v[100:103], v[24:27], a[200:207], v13
  v_add_f32 v93, v93, v95
  v_cvt_pk_bf16_f32 v92, v92, v93
  ds_write2_b32 v5, v88, v92 offset0:0 offset1:64
  v_smfmac_f32_16x16x64_bf16 v[96:99], v[28:31], a[208:215], v13
  s_waitcnt lgkmcnt(0)
  s_barrier
  v_smfmac_f32_16x16x64_bf16 v[100:103], v[28:31], a[216:223], v13
  ds_read_b64_tr_b16 v[64:65], v0 offset:0
  ds_read_b64_tr_b16 v[66:67], v0 offset:512
  v_smfmac_f32_16x16x64_bf16 v[96:99], v[32:35], a[224:231], v13
  ds_read_b64_tr_b16 v[48:49], v6 offset:0
  ds_read_b64_tr_b16 v[50:51], v6 offset:256
  v_smfmac_f32_16x16x64_bf16 v[100:103], v[32:35], a[232:239], v13
  ds_read_b64_tr_b16 v[68:69], v0 offset:1024
  ds_read_b64_tr_b16 v[70:71], v0 offset:1536
  v_smfmac_f32_16x16x64_bf16 v[96:99], v[36:39], a[240:247], v13
  ds_read_b64_tr_b16 v[52:53], v6 offset:512
  ds_read_b64_tr_b16 v[54:55], v6 offset:768
  v_smfmac_f32_16x16x64_bf16 v[100:103], v[36:39], a[248:255], v13
  ds_read_b64_tr_b16 v[72:73], v0 offset:2048
  ds_read_b64_tr_b16 v[74:75], v0 offset:2560
  v_smfmac_f32_16x16x64_bf16 v[96:99], v[40:43], v[128:135], v13
  ds_read_b64_tr_b16 v[56:57], v6 offset:1024
  ds_read_b64_tr_b16 v[58:59], v6 offset:1280
  v_smfmac_f32_16x16x64_bf16 v[100:103], v[40:43], v[136:143], v13
  ds_read_b64_tr_b16 v[76:77], v0 offset:3072
  ds_read_b64_tr_b16 v[78:79], v0 offset:3584
  v_smfmac_f32_16x16x64_bf16 v[96:99], v[44:47], v[144:151], v13
  ds_read_b64_tr_b16 v[60:61], v6 offset:1536
  v_smfmac_f32_16x16x64_bf16 v[100:103], v[44:47], v[152:159], v13
  s_waitcnt lgkmcnt(14)
  ds_read_b64_tr_b16 v[62:63], v6 offset:1792
  s_waitcnt lgkmcnt(12)
  v_mfma_f32_16x16x32_bf16 v[80:83], v[64:67], v[48:51], 0
  s_waitcnt lgkmcnt(8)
  ds_read_b128 v[20:23], v10 offset:1024
  ds_read_b128 v[24:27], v10 offset:2048
  s_lshl_b32 s72, s54, 10
  v_mfma_f32_16x16x32_bf16 v[80:83], v[68:71], v[52:55], v[80:83]
  s_waitcnt lgkmcnt(6)
  v_add_u32 v15, s72, v0
  ds_read_b128 v[28:31], v10 offset:3072
  v_mfma_f32_16x16x32_bf16 v[80:83], v[72:75], v[56:59], v[80:83]
  s_waitcnt lgkmcnt(3)
  ds_read_b64_tr_b16 v[122:123], v15 offset:0
  ds_read_b64_tr_b16 v[124:125], v15 offset:512
  v_mfma_f32_16x16x32_bf16 v[80:83], v[76:79], v[60:63], v[80:83]
  ds_read_b128 v[32:35], v10 offset:4096
  ds_read_b128 v[36:39], v10 offset:5120
  v_mfma_f32_16x16x32_bf16 v[84:87], v[16:19], v[48:51], 0
  s_waitcnt lgkmcnt(6)
  ds_read_b128 v[40:43], v10 offset:6144
  v_cvt_pk_bf16_f32 v118, v96, v97
  v_mfma_f32_16x16x32_bf16 v[84:87], v[20:23], v[52:55], v[84:87]
  s_waitcnt lgkmcnt(3)
  buffer_store_dwordx4 v[122:125], v1, s[4:7], s65 offen sc1
  v_cvt_pk_bf16_f32 v119, v98, v99
  v_mfma_f32_16x16x32_bf16 v[84:87], v[24:27], v[56:59], v[84:87]
  v_cvt_pk_bf16_f32 v120, v100, v101
  v_cvt_pk_bf16_f32 v121, v102, v103
  v_mfma_f32_16x16x32_bf16 v[84:87], v[28:31], v[60:63], v[84:87]
  s_waitcnt lgkmcnt(2)
  ds_read_b128 v[44:47], v10 offset:7168
  v_mfma_f32_16x16x32_bf16 v[88:91], v[32:35], v[48:51], 0
  s_waitcnt lgkmcnt(2)
  buffer_store_dwordx4 v[118:121], v1, s[4:7], s66 offen sc1
  v_mfma_f32_16x16x32_bf16 v[88:91], v[36:39], v[52:55], v[88:91]
  s_waitcnt lgkmcnt(1)
  v_max3_f32 v92, v80, v81, v80
  v_mfma_f32_16x16x32_bf16 v[88:91], v[40:43], v[56:59], v[88:91]
  s_waitcnt lgkmcnt(0)
  v_max3_f32 v92, v92, v84, v85
  v_mfma_f32_16x16x32_bf16 v[88:91], v[44:47], v[60:63], v[88:91]
  v_max3_f32 v92, v92, v86, v87
  s_cmp_eq_u32 s56, 63
  s_cbranch_scc1 L_chain_last_s
  s_nop 4
  v_max3_f32 v92, v92, v88, v89
  v_max3_f32 v92, v92, v90, v91
  v_mov_b32 v93, v92
  s_nop 1
  v_permlane16_swap_b32 v92, v93
  v_max_f32 v92, v92, v93
  v_mov_b32 v93, v92
  s_nop 1
  v_permlane32_swap_b32 v92, v93
  v_max_f32 v92, v92, v93
  v_mul_f32 v92, s71, v92
  v_pk_fma_f32 v[84:85], v[84:85], s[2:3], v[92:93] op_sel_hi:[1,1,0] neg_lo:[0,0,1] neg_hi:[0,0,1]
  v_pk_fma_f32 v[86:87], v[86:87], s[2:3], v[92:93] op_sel_hi:[1,1,0] neg_lo:[0,0,1] neg_hi:[0,0,1]
  v_pk_fma_f32 v[88:89], v[88:89], s[2:3], v[92:93] op_sel_hi:[1,1,0] neg_lo:[0,0,1] neg_hi:[0,0,1]
  v_pk_fma_f32 v[90:91], v[90:91], s[2:3], v[92:93] op_sel_hi:[1,1,0] neg_lo:[0,0,1] neg_hi:[0,0,1]
  v_pk_fma_f32 v[80:81], v[80:81], s[2:3], v[92:93] op_sel_hi:[1,1,0] neg_lo:[0,0,1] neg_hi:[0,0,1]
  v_exp_f32 v84, v84
  v_exp_f32 v85, v85
  v_exp_f32 v86, v86
  v_cvt_pk_bf16_f32 v112, v84, v85
  v_exp_f32 v87, v87
  v_exp_f32 v88, v88
  v_cvt_pk_bf16_f32 v113, v86, v87
  v_exp_f32 v89, v89
  v_exp_f32 v90, v90
  v_cvt_pk_bf16_f32 v114, v88, v89
  v_exp_f32 v91, v91
  v_exp_f32 v80, v80
  v_cvt_pk_bf16_f32 v115, v90, v91
  v_exp_f32 v81, v81
  v_add_f32 v93, v84, v85
  s_waitcnt vmcnt(8)
  v_mfma_f32_16x16x32_bf16 v[96:99], v[104:107], v[112:115], 0
  s_waitcnt vmcnt(7)
  v_cvt_pk_bf16_f32 v116, v80, v81
  v_cvt_pk_bf16_f32 v117, v80, v81
  v_mfma_f32_16x16x32_bf16 v[100:103], v[108:111], v[112:115], 0
  v_add_f32 v92, v86, v87
  v_add_f32 v93, v93, v88
  v_add_f32 v92, v92, v89
  v_add_f32 v93, v93, v90
  v_add_f32 v92, v92, v91
  v_mfma_f32_16x16x16_bf16 v[96:99], v[118:119], v[116:117], v[96:99]
  v_add_f32 v93, v93, v80
  v_add_f32 v92, v92, v81
  v_mfma_f32_16x16x16_bf16 v[100:103], v[120:121], v[116:117], v[100:103]
  v_add_f32 v92, v92, v93
  v_mov_b32 v93, v92
  s_nop 1
  v_permlane16_swap_b32 v92, v93
  v_add_f32 v92, v92, v93
  v_mov_b32 v93, v92
  s_nop 1
  v_permlane32_swap_b32 v92, v93
  v_add_f32 v92, v92, v93
  v_rcp_f32 v92, v92
  s_nop 0
  v_pk_mul_f32 v[96:97], v[96:97], v[92:93] op_sel_hi:[1,0]
  v_pk_mul_f32 v[98:99], v[98:99], v[92:93] op_sel_hi:[1,0]
  v_pk_mul_f32 v[100:101], v[100:101], v[92:93] op_sel_hi:[1,0]
  v_pk_mul_f32 v[102:103], v[102:103], v[92:93] op_sel_hi:[1,0]
  v_cvt_pk_bf16_f32 v96, v96, v97
  v_cvt_pk_bf16_f32 v97, v98, v99
  v_cvt_pk_bf16_f32 v98, v100, v101
  v_cvt_pk_bf16_f32 v99, v102, v103
  ds_write_b64 v7, v[96:97]
  ds_write_b64 v7, v[98:99] offset:256
  v_mov_b64 v[16:17], 0
  v_mov_b64 v[18:19], 0
  v_mov_b64 v[20:21], 0
  v_mov_b64 v[22:23], 0
  v_mov_b64 v[24:25], 0
  v_mov_b64 v[26:27], 0
  s_waitcnt lgkmcnt(0) vmcnt(3)
  s_barrier
  ds_read_b128 v[112:115], v8
  ds_read_b128 v[116:119], v8 offset:1024
  v_mov_b64 v[28:29], 0
  v_mov_b64 v[30:31], 0
  v_mov_b64 v[32:33], 0
  v_mov_b64 v[34:35], 0
  v_mov_b64 v[36:37], 0
  v_mov_b64 v[38:39], 0
  v_mov_b64 v[40:41], 0
  v_mov_b64 v[42:43], 0
  v_mov_b64 v[44:45], 0
  v_mov_b64 v[46:47], 0
  s_waitcnt lgkmcnt(1)
  v_smfmac_f32_16x16x64_bf16 v[16:19], v[112:115], v[160:167], v13
  ds_read_b128 v[48:51], v9 offset:24576
  ds_read_b128 v[52:55], v9 offset:25600
  v_smfmac_f32_16x16x64_bf16 v[20:23], v[112:115], v[168:175], v13
  s_waitcnt lgkmcnt(2)
  ds_read_b128 v[56:59], v9 offset:26624
  ds_read_b128 v[60:63], v9 offset:27648
  v_smfmac_f32_16x16x64_bf16 v[16:19], v[116:119], v[224:231], v13
  ds_read_b128 v[64:67], v9 offset:28672
  ds_read_b128 v[68:71], v9 offset:29696
  v_smfmac_f32_16x16x64_bf16 v[20:23], v[116:119], v[232:239], v13
  ds_read_b128 v[72:75], v9 offset:30720
  ds_read_b128 v[76:79], v9 offset:31744
  v_smfmac_f32_16x16x64_bf16 v[24:27], v[112:115], v[176:183], v13
  v_smfmac_f32_16x16x64_bf16 v[28:31], v[112:115], v[184:191], v13
  s_nop 0
  v_add_f32 v16, v16, v18
  v_add_f32 v17, v17, v19
  v_smfmac_f32_16x16x64_bf16 v[24:27], v[116:119], v[240:247], v13
  v_add_f32 v20, v20, v22
  v_add_f32 v21, v21, v23
  v_smfmac_f32_16x16x64_bf16 v[28:31], v[116:119], v[248:255], v13
  v_cvt_pk_bf16_f32 v80, v16, v20
  v_cvt_pk_bf16_f32 v82, v17, v21
  v_smfmac_f32_16x16x64_bf16 v[32:35], v[112:115], v[192:199], v13
  v_smfmac_f32_16x16x64_bf16 v[36:39], v[112:115], v[200:207], v13
  s_waitcnt lgkmcnt(6)
  v_add_f32 v24, v24, v26
  v_add_f32 v25, v25, v27
  v_smfmac_f32_16x16x64_bf16 v[32:35], v[116:119], v[48:55], v13
  s_waitcnt lgkmcnt(4)
  v_add_f32 v28, v28, v30
  v_add_f32 v29, v29, v31
  v_smfmac_f32_16x16x64_bf16 v[36:39], v[116:119], v[56:63], v13
  v_cvt_pk_bf16_f32 v81, v24, v28
  v_cvt_pk_bf16_f32 v83, v25, v29
  v_smfmac_f32_16x16x64_bf16 v[40:43], v[112:115], v[208:215], v13
  s_add_u32 s72, s60, 0x20000
  buffer_store_dwordx4 v[80:83], v11, s[4:7], s60 offen sc1
  v_smfmac_f32_16x16x64_bf16 v[44:47], v[112:115], v[216:223], v13
  s_waitcnt lgkmcnt(2)
  v_add_f32 v32, v32, v34
  v_add_f32 v33, v33, v35
  v_smfmac_f32_16x16x64_bf16 v[40:43], v[116:119], v[64:71], v13
  s_waitcnt lgkmcnt(0)
  v_add_f32 v36, v36, v38
  v_add_f32 v37, v37, v39
  v_smfmac_f32_16x16x64_bf16 v[44:47], v[116:119], v[72:79], v13
  v_cvt_pk_bf16_f32 v84, v32, v36
  v_cvt_pk_bf16_f32 v86, v33, v37
  s_nop 1
  v_add_f32 v40, v40, v42
  v_add_f32 v41, v41, v43
  s_nop 1
  v_add_f32 v44, v44, v46
  v_add_f32 v45, v45, v47
  v_cvt_pk_bf16_f32 v85, v40, v44
  v_cvt_pk_bf16_f32 v87, v41, v45
  buffer_store_dwordx4 v[84:87], v11, s[4:7], s72 offen sc1
  s_cmp_lt_u32 s54, 2
  s_cbranch_scc0 L_nored_s
  v_lshrrev_b32 v15, 5, v1
  v_and_b32 v15, 7, v15
  v_cmp_eq_u32 vcc, 0, v15
  v_cmp_eq_u32 s[96:97], 1, v15
  v_cmp_eq_u32 s[98:99], 2, v15
  v_cmp_eq_u32 s[100:101], 3, v15
  v_cndmask_b32 v104, 0, v14, vcc
  v_cndmask_b32 v105, 0, v14, s[96:97]
  v_cndmask_b32 v106, 0, v14, s[98:99]
  v_cndmask_b32 v107, 0, v14, s[100:101]
  s_nop 15
  s_nop 15
  s_nop 5
  s_cmp_eq_u32 s54, 0
  s_cbranch_scc1 L_nod1b_s
  s_nop 15
  s_nop 9
L_nod1b_s:
  buffer_load_dwordx4 v[16:19], v1, s[4:7], s61 offen offset:0 sc1
  buffer_load_dwordx4 v[20:23], v1, s[4:7], s61 offen offset:1024 sc1
  buffer_load_dwordx4 v[24:27], v1, s[4:7], s61 offen offset:2048 sc1
  buffer_load_dwordx4 v[28:31], v1, s[4:7], s61 offen offset:3072 sc1
  v_xor_b32 v10, 0x2000, v10
  ds_read_b128 v[48:51], v9 offset:0
  ds_read_b128 v[52:55], v9 offset:1024
  ds_read_b128 v[56:59], v9 offset:2048
  ds_read_b128 v[60:63], v9 offset:3072
  ds_read_b128 v[64:67], v9 offset:4096
  ds_read_b128 v[68:71], v9 offset:5120
  ds_read_b128 v[72:75], v9 offset:6144
  ds_read_b128 v[76:79], v9 offset:7168
  v_mov_b64 v[80:81], 0
  v_mov_b64 v[82:83], 0
  v_mov_b64 v[84:85], 0
  v_mov_b64 v[86:87], 0
  v_mov_b64 v[88:89], 0
  v_mov_b64 v[90:91], 0
  v_mov_b64 v[92:93], 0
  v_mov_b64 v[94:95], 0
  v_mov_b64 v[96:97], 0
  v_mov_b64 v[98:99], 0
  v_mov_b64 v[100:101], 0
  v_mov_b64 v[102:103], 0
  s_add_u32 s56, s56, 1
  s_add_u32 s63, s63, 262144
  s_add_u32 s64, s64, 262144
  s_add_u32 s65, s65, 131072
  s_add_u32 s66, s66, 131072
  s_xor_b32 s69, s69, 0x2000
  s_add_u32 s76, s76, 128
  buffer_load_dwordx4 v[32:35], v1, s[4:7], s61 offen offset:0 sc1
  buffer_load_dwordx4 v[36:39], v1, s[4:7], s61 offen offset:1024 sc1
  buffer_load_dwordx4 v[40:43], v1, s[4:7], s61 offen offset:2048 sc1
  buffer_load_dwordx4 v[44:47], v1, s[4:7], s61 offen offset:3072 sc1
L_check1_s:
  s_waitcnt vmcnt(7)
  v_max3_u32 v15, v16, v17, v18
  v_max_u32 v15, v15, v19
  v_mfma_f32_16x16x32_bf16 v[108:111], v[104:107], v[16:19], 0
  s_waitcnt vmcnt(6)
  v_max3_u32 v15, v15, v20, v21
  v_max3_u32 v15, v15, v22, v23
  v_mfma_f32_16x16x32_bf16 v[108:111], v[104:107], v[20:23], v[108:111]
  s_waitcnt vmcnt(5)
  v_max3_u32 v15, v15, v24, v25
  v_max3_u32 v15, v15, v26, v27
  v_mfma_f32_16x16x32_bf16 v[108:111], v[104:107], v[24:27], v[108:111]
  s_waitcnt vmcnt(4)
  v_max3_u32 v15, v15, v28, v29
  v_max3_u32 v15, v15, v30, v31
  v_mfma_f32_16x16x32_bf16 v[108:111], v[104:107], v[28:31], v[108:111]
  v_cmp_eq_u32 vcc, -1, v15
  s_nop 0
  s_cbranch_vccnz L_retry1_s
L_got1_s:
  v_mov_b64 v[124:125], -1
  s_mov_b32 exec_hi, 0
  s_nop 2
  v_add_f32_dpp v108, v108, v108 row_ror:8 row_mask:0xf bank_mask:0xf
  v_add_f32_dpp v109, v109, v109 row_ror:8 row_mask:0xf bank_mask:0xf
  v_add_f32_dpp v110, v110, v110 row_ror:8 row_mask:0xf bank_mask:0xf
  v_add_f32_dpp v111, v111, v111 row_ror:8 row_mask:0xf bank_mask:0xf
  s_mov_b32 exec_lo, 0x00ff00ff
  v_cvt_pk_bf16_f32 v122, v108, v109
  v_cvt_pk_bf16_f32 v123, v110, v111
  buffer_store_dwordx2 v[122:123], v12, s[4:7], s58 offen sc1
  buffer_store_dwordx2 v[124:125], v12, s[4:7], s59 offen sc1
  s_mov_b64 exec, -1
  s_branch L_red_done_s
L_nored_s:
  v_xor_b32 v10, 0x2000, v10
  ds_read_b128 v[48:51], v9 offset:0
  ds_read_b128 v[52:55], v9 offset:1024
  ds_read_b128 v[56:59], v9 offset:2048
  ds_read_b128 v[60:63], v9 offset:3072
  ds_read_b128 v[64:67], v9 offset:4096
  ds_read_b128 v[68:71], v9 offset:5120
  ds_read_b128 v[72:75], v9 offset:6144
  s_waitcnt lgkmcnt(14)
  ds_read_b128 v[76:79], v9 offset:7168
  v_mov_b64 v[80:81], 0
  v_mov_b64 v[82:83], 0
  v_mov_b64 v[84:85], 0
  v_mov_b64 v[86:87], 0
  v_mov_b64 v[88:89], 0
  v_mov_b64 v[90:91], 0
  v_mov_b64 v[92:93], 0
  v_mov_b64 v[94:95], 0
  v_mov_b64 v[96:97], 0
  v_mov_b64 v[98:99], 0
  v_mov_b64 v[100:101], 0
  v_mov_b64 v[102:103], 0
  s_add_u32 s56, s56, 1
  s_add_u32 s63, s63, 262144
  s_add_u32 s64, s64, 262144
  s_add_u32 s65, s65, 131072
  s_add_u32 s66, s66, 131072
  s_xor_b32 s69, s69, 0x2000
  s_add_u32 s76, s76, 128
  s_waitcnt vmcnt(0)
L_red_done_s:
  s_barrier
  s_add_u32 s57, s77, s21
  s_branch L_poll2_s
L_p2s_s:
  buffer_load_dwordx4 v[112:115], v1, s[4:7], s57 offen sc1
  s_sub_u32 s70, s70, 1
  s_cbranch_scc0 L_p2loop_s
  s_mov_b32 s70, 0
  s_waitcnt vmcnt(0)
  ds_write_b128 v2, v[112:115]
  s_branch L_got2_s
L_p2n0_s:
  buffer_load_dwordx4 v[112:115], v1, s[4:7], s57 offen sc1
  s_waitcnt vmcnt(1)
  ds_write_b128 v2, v[120:123]
  v_max3_u32 v15, v120, v121, v122
  v_max_u32 v15, v15, v123
  v_cmp_eq_u32 vcc, -1, v15
  s_nop 0
  s_cbranch_vccnz L_p2n1_s
  s_branch L_got2_s
L_p2n1_s:
  buffer_load_dwordx4 v[120:123], v1, s[4:7], s57 offen sc1
  s_sub_u32 s70, s70, 1
  s_cbranch_scc0 L_p2loop_s
  s_mov_b32 s70, 0
  s_waitcnt vmcnt(0)
  ds_write_b128 v2, v[112:115]
  s_branch L_got2_s
L_retry2b_s:
  s_sub_u32 s70, s70, 1
  s_cbranch_scc1 L_giveup2b_s
  s_add_u32 s72, s57, 4096
  buffer_load_dwordx4 v[116:119], v1, s[4:7], s72 offen sc1
  s_waitcnt vmcnt(0)
  v_max3_u32 v15, v116, v117, v118
  v_max_u32 v15, v15, v119
  v_cmp_eq_u32 vcc, -1, v15
  s_nop 0
  s_cbranch_vccnz L_retry2b_s
  s_branch L_got2b_s
L_giveup2b_s:
  s_mov_b32 s70, 0
  s_branch L_got2b_s
L_retry1s_s:
  buffer_load_dwordx4 v[16:19], v1, s[4:7], s61 offen offset:0 sc1
  buffer_load_dwordx4 v[20:23], v1, s[4:7], s61 offen offset:1024 sc1
  buffer_load_dwordx4 v[24:27], v1, s[4:7], s61 offen offset:2048 sc1
  buffer_load_dwordx4 v[28:31], v1, s[4:7], s61 offen offset:3072 sc1
  s_sub_u32 s70, s70, 1
  s_nop 0
  s_mov_b32 s70, 0
  s_waitcnt vmcnt(0)
  s_branch L_got1_s
L_retry1_s:
  buffer_load_dwordx4 v[16:19], v1, s[4:7], s61 offen offset:0 sc1
  buffer_load_dwordx4 v[20:23], v1, s[4:7], s61 offen offset:1024 sc1
  buffer_load_dwordx4 v[24:27], v1, s[4:7], s61 offen offset:2048 sc1
  buffer_load_dwordx4 v[28:31], v1, s[4:7], s61 offen offset:3072 sc1
  s_waitcnt vmcnt(7)
  v_max3_u32 v15, v32, v33, v34
  v_max_u32 v15, v15, v35
  v_mfma_f32_16x16x32_bf16 v[108:111], v[104:107], v[32:35], 0
  s_waitcnt vmcnt(6)
  v_max3_u32 v15, v15, v36, v37
  v_max3_u32 v15, v15, v38, v39
  v_mfma_f32_16x16x32_bf16 v[108:111], v[104:107], v[36:39], v[108:111]
  s_waitcnt vmcnt(5)
  v_max3_u32 v15, v15, v40, v41
  v_max3_u32 v15, v15, v42, v43
  v_mfma_f32_16x16x32_bf16 v[108:111], v[104:107], v[40:43], v[108:111]
  s_waitcnt vmcnt(4)
  v_max3_u32 v15, v15, v44, v45
  v_max3_u32 v15, v15, v46, v47
  v_mfma_f32_16x16x32_bf16 v[108:111], v[104:107], v[44:47], v[108:111]
  v_cmp_eq_u32 vcc, -1, v15
  s_nop 0
  s_cbranch_vccz L_got1_s
  buffer_load_dwordx4 v[32:35], v1, s[4:7], s61 offen offset:0 sc1
  buffer_load_dwordx4 v[36:39], v1, s[4:7], s61 offen offset:1024 sc1
  buffer_load_dwordx4 v[40:43], v1, s[4:7], s61 offen offset:2048 sc1
  buffer_load_dwordx4 v[44:47], v1, s[4:7], s61 offen offset:3072 sc1
  s_sub_u32 s70, s70, 1
  s_cbranch_scc0 L_check1_s
  s_mov_b32 s70, 0
  s_waitcnt vmcnt(0)
  s_branch L_got1_s
L_kvspin_s:
  s_min_u32 s74, s74, 63
L_kvspin_l_s:
  buffer_load_dwordx2 v[112:113], off, s[4:7], s67 sc1
  s_waitcnt vmcnt(0)
  v_readfirstlane_b32 s72, v112
  v_readfirstlane_b32 s73, v113
  s_nop 3
  s_lshl_b32 s72, s72, 1
  s_lshl_b32 s73, s73, 1
  s_add_u32 s73, s73, 1
  s_min_u32 s75, s72, s73
  s_cmp_lt_u32 s74, s75
  s_cbranch_scc1 L_kvspin_l_s_ok
  s_sub_u32 s70, s70, 16
  s_cselect_b32 s70, 0, s70
  s_cbranch_scc1 L_kvspin_l_s_ok
  s_branch L_kvspin_l_s
L_kvspin_l_s_ok:
  s_branch L_kvok_s
L_chain_last_s:
  v_mov_b32 v15, 0
  v_mov_b32 v127, 64
  s_waitcnt vmcnt(0)
  s_barrier
  s_cmp_eq_u32 s54, 0
  s_cbranch_scc0 L_end
  s_mov_b64 exec, 1
  buffer_store_dword v127, v15, s[4:7], s68 offen sc1
  s_branch L_end
L_overflow:
  s_cmp_eq_u32 s54, 0
  s_cbranch_scc0 L_ovf_clr_ok
  s_mov_b64 exec, 0xff
  v_lshlrev_b32 v12, 4, v0
  v_add_u32 v12, 112, v12
  v_cmp_eq_u32 vcc, 0, v0
  s_nop 1
  v_cndmask_b32 v12, v12, 0, vcc
L_ovf_clr:
  buffer_load_dwordx2 v[14:15], v12, s[16:19], 0 offen sc1
  s_waitcnt vmcnt(0)
  v_readlane_b32 s96, v15, 0
  v_readlane_b32 s97, v15, 1
  v_readlane_b32 s98, v15, 2
  v_readlane_b32 s99, v15, 3
  v_readlane_b32 s100, v15, 4
  v_readlane_b32 s101, v15, 5
  v_readlane_b32 s22, v15, 6
  v_readlane_b32 s23, v15, 7
  s_nop 3
  s_add_u32 s3, s96, s97
  s_add_u32 s3, s3, s98
  s_add_u32 s3, s3, s99
  s_add_u32 s3, s3, s100
  s_add_u32 s3, s3, s101
  s_add_u32 s3, s3, s22
  s_add_u32 s3, s3, s23
  s_cmp_ge_u32 s3, 0x100
  s_cbranch_scc1 L_ovf_clr_d
  s_sub_u32 s70, s70, 64
  s_cselect_b32 s70, 0, s70
  s_cbranch_scc1 L_ovf_clr_d
  s_sleep 4
  s_branch L_ovf_clr
L_ovf_clr_d:
  s_mov_b64 exec, -1
L_ovf_clr_ok:
L_fallback:
  s_waitcnt vmcnt(0) lgkmcnt(0)
  s_barrier
  s_cmp_eq_u32 s54, 0
  s_cbranch_scc0 L_fb_bc
  s_mov_b64 exec, 1
  v_mov_b32 v2, 12
  v_mov_b32 v3, 1
  buffer_atomic_add v3, v2, s[16:19], 0 offen sc0
  s_waitcnt vmcnt(0)
  v_readfirstlane_b32 s3, v3
  s_mov_b64 exec, -1
  s_nop 3
  v_mov_b32 v2, 0x27ff0
  v_mov_b32 v3, s3
  ds_write_b32 v2, v3
  s_waitcnt lgkmcnt(0)
L_fb_bc:
  s_barrier
  v_mov_b32 v2, 0x27ff0
  ds_read_b32 v3, v2
  s_waitcnt lgkmcnt(0)
  v_readfirstlane_b32 s3, v3
  s_nop 3
  s_lshr_b32 s53, s3, 5
  s_and_b32 s53, s53, 7
  s_and_b32 s52, s3, 31
  s_mov_b32 s55, 1
  s_barrier
  s_branch L_dispatch
L_end:
  s_endpgm
.section .rodata,"a"
.p2align 6
.amdhsa_kernel recurrent_scan__memory_aug_recurrent_mem_tr__dense_activation_mish__prompt_kernel
  .amdhsa_next_free_vgpr 512
  .amdhsa_next_free_sgpr 102
  .amdhsa_accum_offset 256
  .amdhsa_group_segment_fixed_size 0
  .amdhsa_kernarg_size 112
  .amdhsa_user_sgpr_count 2
  .amdhsa_user_sgpr_kernarg_segment_ptr 1
  .amdhsa_system_sgpr_workgroup_id_x 1
.end_amdhsa_kernel
```
